```python
import torch

def _softmax(x, axis=-1):
    return torch.softmax(x, dim=axis)

def _gelu(x):
    return torch.nn.functional.gelu(x, approximate='tanh')

def _silu(x):
    return torch.nn.functional.silu(x)

def _sigmoid(x):
    return torch.sigmoid(x)

def _layernorm(x, axis=-1, eps=1e-05):
    m = x.mean(dim=axis, keepdim=True)
    v = x.var(dim=axis, keepdim=True, unbiased=False)
    return (x - m) / torch.sqrt(v + eps)

def _scatter_add(tgt, idx, src, axis=0):
    return tgt.clone().index_add_(axis, idx, src)

def _segment_sum(src, seg, n):
    out = torch.zeros((n,) + src.shape[1:], dtype=src.dtype)
    return out.index_add_(0, seg, src)

def _pad(x, pw):
    flat = tuple((v for pair in reversed(pw) for v in pair))
    return torch.nn.functional.pad(x, flat)
kernel_name = 'adaLN_cond__linear_kernel_hedgehog__mixer_gmlp__prompt'

def setup_inputs():

    _w = lambda a: (lambda t: t.to(torch.bfloat16) if t.is_floating_point() else t)(torch.as_tensor(a))

    def _A_setup():
        B, S, D, H = (1, 2048, 1024, 32)
        Dh = D // H
        return {'x': _w((lambda *s: torch.randn(*s, dtype=torch.bfloat16) * 0.05)(B, S, D)), 'wqkv': _w((lambda *s: torch.randn(*s, dtype=torch.bfloat16) * 0.4)(D, 3 * D)), 'w_phi': _w((lambda *s: torch.randn(*s, dtype=torch.bfloat16) * 0.4)(H, Dh, Dh) * Dh ** (-0.5)), 'wo': _w((lambda *s: torch.randn(*s, dtype=torch.bfloat16) * 0.05)(D, D))}
    _A_in = _A_setup()

    def _B_setup():
        B, S, D, F = (1, 2048, 1024, 3584)
        Fh = F // 2
        return {'x': _w((lambda *s: torch.randn(*s, dtype=torch.bfloat16) * 0.05)(B, S, D)), 'w_in': _w((lambda *s: torch.randn(*s, dtype=torch.bfloat16) * 0.2)(D, 2 * Fh)), 'w_sp': _w(0.01 * (lambda *s: torch.randn(*s, dtype=torch.bfloat16) * 0.2)(S, S)), 'b_sp': _w(1.0 + 0.01 * (lambda *s: torch.randn(*s, dtype=torch.bfloat16) * 0.05)(S)), 'w_out': _w((lambda *s: torch.randn(*s, dtype=torch.bfloat16) * 0.05)(Fh, D))}
    _B_in = _B_setup()
    return {'A_x': _A_in['x'], 'A_wqkv': _A_in['wqkv'], 'A_w_phi': _A_in['w_phi'], 'A_wo': _A_in['wo'], 'B_x': _B_in['x'], 'B_w_in': _B_in['w_in'], 'B_w_sp': _B_in['w_sp'], 'B_b_sp': _B_in['b_sp'], 'B_w_out': _B_in['w_out'], 'c': _w((lambda *s: torch.randn(*s, dtype=torch.bfloat16) * 0.1)(1, 1024) * 8.0), 'w_mod': _w((lambda *s: torch.randn(*s, dtype=torch.bfloat16) * 0.1)(1024, 6 * 1024) * 1024 ** (-0.5) * 8.0)}

def reference(A_x, A_wqkv, A_w_phi, A_wo, B_x, B_w_in, B_w_sp, B_b_sp, B_w_out, c, w_mod):

    def _A_ref(x, wqkv, w_phi, wo):
        B, S, D = x.shape
        H = 32
        Dh = D // H
        qkv = (lambda x, *d: x.permute(*d))((x @ wqkv).reshape(B, S, 3, H, Dh), 2, 0, 3, 1, 4)
        q, k, v = (qkv[0], qkv[1], qkv[2])
        pq = torch.einsum('bhsd,hdf->bhsf', q, w_phi)
        pk = torch.einsum('bhsd,hdf->bhsf', k, w_phi)
        phi_q = torch.concatenate([_softmax(pq, axis=-1), _softmax(-pq, axis=-1)], axis=-1)
        phi_k = torch.concatenate([_softmax(pk, axis=-1), _softmax(-pk, axis=-1)], axis=-1)
        kv = torch.einsum('bhsf,bhsd->bhfd', phi_k, v)
        z = torch.einsum('bhsf->bhf', phi_k)
        num = torch.einsum('bhqf,bhfd->bhqd', phi_q, kv)
        den = torch.einsum('bhqf,bhf->bhq', phi_q, z)[..., None] + 1e-06
        o = num / den
        return (lambda x, *d: x.permute(*d))(o, 0, 2, 1, 3).reshape(B, S, D) @ wo

    def _B_ref(x, w_in, w_sp, b_sp, w_out):
        B, S, D = x.shape
        F = w_in.shape[-1]
        Fh = F // 2
        z = _gelu(torch.einsum('bsd,df->bsf', x, w_in))
        z1 = z[..., :Fh].clone()
        z2 = _layernorm(z[..., Fh:], axis=-1)
        g = torch.einsum('ts,bsf->btf', w_sp, z2) + b_sp[None, :, None]
        return torch.einsum('bsf,fd->bsd', z1 * g, w_out)
    x = A_x
    mod = (_silu(c) @ w_mod).reshape(c.shape[0], 6, 1, -1)
    sa, ca, ga, sb, cb, gb = (mod[:, 0].clone(), mod[:, 1].clone(), mod[:, 2].clone(), mod[:, 3].clone(), mod[:, 4].clone(), mod[:, 5].clone())
    h = _layernorm(x, axis=-1) * (1 + ca) + sa
    x = x + ga * _A_ref(h, A_wqkv, A_w_phi, A_wo)
    h = _layernorm(x, axis=-1) * (1 + cb) + sb
    x = x + gb * _B_ref(h, B_w_in, B_w_sp, B_b_sp, B_w_out)
    return x
```

```asm
; @launch grid=(256,1,1) block=(512,1,1) lds=163840
.amdgcn_target "amdgcn-amd-amdhsa--gfx950"
.text
.p2align 8
.globl adaLN_cond__linear_kernel_hedgehog__mixer_gmlp__prompt_kernel
.p2align 8
.type adaLN_cond__linear_kernel_hedgehog__mixer_gmlp__prompt_kernel,@function
adaLN_cond__linear_kernel_hedgehog__mixer_gmlp__prompt_kernel:
    s_cmp_ge_u32 s2, 256
    s_cbranch_scc1 L_k1_end_1
    s_load_dwordx16 s[36:51], s[0:1], 0
    s_load_dwordx8 s[52:59], s[0:1], 64
    s_load_dwordx4 s[60:63], s[0:1], 96
    v_lshrrev_b32 v1, 6, v0
    v_and_b32 v2, 63, v0
    v_readfirstlane_b32 s3, v1
    s_lshr_b32 s6, s2, 3
    s_and_b32 s4, s6, 7
    s_and_b32 s7, s2, 1
    s_lshl_b32 s7, s7, 3
    s_add_u32 s4, s4, s7
    s_lshr_b32 s5, s6, 3
    s_bfe_u32 s7, s2, 0x20001
    s_lshl_b32 s7, s7, 2
    s_add_u32 s5, s5, s7
    v_lshlrev_b32 v3, 4, v2
    s_lshl_b32 s7, s4, 4
    s_add_u32 s7, s7, s5
    s_lshl_b32 s7, s7, 3
    s_add_u32 s32, s7, s3
    s_lshl_b32 s32, s32, 11
    s_and_b32 s34, s4, 1
    s_lshl_b32 s34, s34, 4
    s_add_u32 s34, s34, s5
    s_lshl_b32 s34, s34, 7
    s_lshr_b32 s35, s4, 1
    s_lshl_b32 s35, s35, 7
    v_lshlrev_b32 v4, 4, v0
    v_mov_b32 v64, -1
    v_mov_b32 v65, -1
    v_mov_b32 v66, -1
    v_mov_b32 v67, -1
    v_mov_b32 v68, 0
    v_mov_b32 v69, 0
    v_mov_b32 v70, 0
    v_mov_b32 v71, 0
    s_waitcnt lgkmcnt(0)
    s_load_dword s33, s[62:63], 0xc8000
    s_mov_b32 s16, s36
    s_mov_b32 s17, s37
    s_mov_b32 s18, 0x400000
    s_mov_b32 s19, 0x00020000
    buffer_load_dwordx4 v[8:11], v3, s[16:19], s32 offen
    buffer_load_dwordx4 v[12:15], v3, s[16:19], s32 offen offset:1024
    s_mul_i32 s6, s2, 1024
    s_add_u32 s6, s6, 0x80000
    s_add_u32 s28, s62, s6
    s_addc_u32 s29, s63, 0
    s_mov_b32 s30, 0x400
    s_mov_b32 s31, 0x00020000
    buffer_store_dwordx4 v[64:67], v4, s[28:31], 0 offen sc1
    s_mul_i32 s6, s2, 1040
    s_add_u32 s6, s6, 0x500000
    s_add_u32 s28, s62, s6
    s_addc_u32 s29, s63, 0
    s_mov_b32 s30, 0x410
    s_mov_b32 s31, 0x00020000
    buffer_store_dwordx4 v[64:67], v4, s[28:31], 0 offen sc1
    s_mul_i32 s6, s2, 64
    s_add_u32 s6, s6, 0xc0000
    s_add_u32 s28, s62, s6
    s_addc_u32 s29, s63, 0
    s_mov_b32 s30, 0x40
    s_mov_b32 s31, 0x00020000
    buffer_store_dwordx4 v[64:67], v4, s[28:31], 0 offen sc1
    s_mul_i32 s6, s2, 256
    s_add_u32 s6, s6, 0xc000
    s_add_u32 s28, s62, s6
    s_addc_u32 s29, s63, 0
    s_mov_b32 s30, 0x100
    s_mov_b32 s31, 0x00020000
    buffer_store_dwordx4 v[68:71], v4, s[28:31], 0 offen sc1
    s_mov_b32 s8, s56
    s_mov_b32 s9, s57
    s_mov_b32 s10, 0xc00000
    s_mov_b32 s11, 0x00020000
    s_mov_b32 s12, s54
    s_mov_b32 s13, s55
    s_mov_b32 s14, 0x800
    s_mov_b32 s15, 0x00020000
    v_lshrrev_b32 v100, 3, v0
    v_add_u32 v100, s35, v100
    s_movk_i32 s6, 0x3000
    v_mul_lo_u32 v101, s6, v100
    v_lshlrev_b32 v100, 1, v100
    v_and_b32 v84, 7, v0
    v_lshl_add_u32 v101, v84, 4, v101
    buffer_load_ushort v72, v100, s[12:15], 0 offen offset:0
    buffer_load_ushort v73, v100, s[12:15], 0 offen offset:128
    s_add_u32 s20, s34, 0
    buffer_load_dwordx4 v[76:79], v101, s[8:11], s20 offen nt
    s_add_u32 s21, s34, 786432
    buffer_load_dwordx4 v[80:83], v101, s[8:11], s21 offen nt
    v_lshrrev_b32 v5, 3, v0
    v_and_b32 v7, 7, v0
    v_lshlrev_b32 v6, 4, v5
    v_lshlrev_b32 v33, 12, v5
    v_lshl_add_u32 v33, v7, 4, v33
    v_lshlrev_b32 v5, 11, v5
    v_lshl_add_u32 v5, v7, 4, v5
    s_lshl_b32 s6, s4, 18
    s_lshl_b32 s32, s5, 7
    s_add_u32 s32, s32, s6
    s_cmp_lt_u32 s3, 4
    s_cselect_b32 s6, 260224, 0
    s_add_u32 s8, s36, s32
    s_addc_u32 s9, s37, 0
    s_mov_b32 s10, s6
    s_mov_b32 s11, 0x00020000
    s_mov_b32 s6, 0
    buffer_load_dwordx4 v[112:115], v5, s[8:11], s6 offen
    s_mov_b32 s6, 65536
    buffer_load_dwordx4 v[116:119], v5, s[8:11], s6 offen
    s_mov_b32 s6, 131072
    buffer_load_dwordx4 v[120:123], v5, s[8:11], s6 offen
    s_mov_b32 s6, 196608
    buffer_load_dwordx4 v[124:127], v5, s[8:11], s6 offen
    v_lshrrev_b32 v32, 3, v2
    v_and_b32 v34, 7, v2
    v_lshlrev_b32 v32, 10, v32
    v_lshl_add_u32 v32, v34, 4, v32
    v_add_u32 v32, 384, v32
    s_cmp_eq_u32 s3, 4
    s_cselect_b32 s32, 24576, 0
    s_mul_i32 s6, s2, 24576
    s_add_u32 s24, s38, s6
    s_addc_u32 s25, s39, 0
    s_mov_b32 s26, s32
    s_mov_b32 s27, 0x00020000
    s_movk_i32 s6, 0
    buffer_load_dwordx4 v[144:147], v32, s[24:27], s6 offen nt
    s_movk_i32 s6, 8192
    buffer_load_dwordx4 v[148:151], v32, s[24:27], s6 offen nt
    s_movk_i32 s6, 16384
    buffer_load_dwordx4 v[152:155], v32, s[24:27], s6 offen nt
    s_cmp_eq_u32 s3, 4
    s_cselect_b32 s32, 8192, 0
    s_mul_i32 s6, s2, 8192
    s_add_u32 s24, s42, s6
    s_addc_u32 s25, s43, 0
    s_mov_b32 s26, s32
    s_mov_b32 s27, 0x00020000
    s_movk_i32 s6, 0
    buffer_load_dwordx4 v[156:159], v32, s[24:27], s6 offen nt
    s_cmp_eq_u32 s3, 4
    s_cselect_b32 s32, 14336, 0
    s_mul_i32 s6, s2, 14336
    s_add_u32 s24, s52, s6
    s_addc_u32 s25, s53, 0
    s_mov_b32 s26, s32
    s_mov_b32 s27, 0x00020000
    s_movk_i32 s6, 0
    buffer_load_dwordx4 v[160:163], v32, s[24:27], s6 offen nt
    s_movk_i32 s6, 8192
    buffer_load_dwordx4 v[164:167], v32, s[24:27], s6 offen nt
    s_sub_u32 s6, s3, 5
    s_lshl_b32 s6, s6, 11
    v_lshl_add_u32 v40, v2, 7, s6
    v_bfrev_b32 v41, 1
    v_cmp_gt_u32 vcc, 16, v2
    s_cmp_ge_u32 s3, 5
    s_cselect_b32 s32, 4724736, 0
    v_cndmask_b32 v40, v41, v40, vcc
    s_mul_i32 s6, s2, 6144
    s_add_u32 s96, s38, s6
    s_addc_u32 s97, s39, 0
    s_mov_b32 s98, s32
    s_mov_b32 s99, 0x00020000
    s_mov_b32 s6, 0
    buffer_load_dword v250, v40, s[96:99], s6 offen
    s_add_u32 s68, s62, 0x20000
    s_addc_u32 s69, s63, 0
    s_mov_b32 s70, 0x20000
    s_mov_b32 s71, 0x00020000
    s_lshl_b32 s6, s7, 4
    s_add_u32 s6, s6, 0x40000
    s_add_u32 s72, s62, s6
    s_addc_u32 s73, s63, 0
    s_mov_b32 s74, 0x80
    s_mov_b32 s75, 0x00020000
    s_waitcnt vmcnt(19)
    v_lshlrev_b32 v16, 16, v8
    v_and_b32 v17, 0xffff0000, v8
    v_lshlrev_b32 v18, 16, v9
    v_and_b32 v19, 0xffff0000, v9
    v_lshlrev_b32 v20, 16, v10
    v_and_b32 v21, 0xffff0000, v10
    v_lshlrev_b32 v22, 16, v11
    v_and_b32 v23, 0xffff0000, v11
    v_lshlrev_b32 v24, 16, v12
    v_and_b32 v25, 0xffff0000, v12
    v_lshlrev_b32 v26, 16, v13
    v_and_b32 v27, 0xffff0000, v13
    v_lshlrev_b32 v28, 16, v14
    v_and_b32 v29, 0xffff0000, v14
    v_lshlrev_b32 v30, 16, v15
    v_and_b32 v31, 0xffff0000, v15
    v_pk_add_f32 v[64:65], v[16:17], v[18:19]
    v_pk_add_f32 v[66:67], v[20:21], v[22:23]
    v_pk_add_f32 v[68:69], v[24:25], v[26:27]
    v_pk_add_f32 v[70:71], v[28:29], v[30:31]
    v_pk_add_f32 v[64:65], v[64:65], v[66:67]
    v_pk_add_f32 v[68:69], v[68:69], v[70:71]
    v_pk_add_f32 v[64:65], v[64:65], v[68:69]
    v_add_f32 v64, v64, v65
    s_nop 1
    v_add_f32_dpp v64, v64, v64 row_ror:1 row_mask:0xf bank_mask:0xf
    s_nop 1
    v_add_f32_dpp v64, v64, v64 row_ror:2 row_mask:0xf bank_mask:0xf
    s_nop 1
    v_add_f32_dpp v64, v64, v64 row_ror:4 row_mask:0xf bank_mask:0xf
    s_nop 1
    v_add_f32_dpp v64, v64, v64 row_ror:8 row_mask:0xf bank_mask:0xf
    v_mov_b32 v65, v64
    s_nop 1
    v_permlane16_swap_b32 v64, v65
    v_add_f32 v64, v64, v65
    v_mov_b32 v65, v64
    s_nop 1
    v_permlane32_swap_b32 v64, v65
    v_add_f32 v64, v64, v65
    s_mov_b32 s6, 0x3a800000
    v_mul_f32 v64, s6, v64
    v_pk_add_f32 v[16:17], v[16:17], v[64:65] op_sel_hi:[1,0] neg_lo:[0,1] neg_hi:[0,1]
    v_pk_add_f32 v[18:19], v[18:19], v[64:65] op_sel_hi:[1,0] neg_lo:[0,1] neg_hi:[0,1]
    v_pk_add_f32 v[20:21], v[20:21], v[64:65] op_sel_hi:[1,0] neg_lo:[0,1] neg_hi:[0,1]
    v_pk_add_f32 v[22:23], v[22:23], v[64:65] op_sel_hi:[1,0] neg_lo:[0,1] neg_hi:[0,1]
    v_pk_add_f32 v[24:25], v[24:25], v[64:65] op_sel_hi:[1,0] neg_lo:[0,1] neg_hi:[0,1]
    v_pk_add_f32 v[26:27], v[26:27], v[64:65] op_sel_hi:[1,0] neg_lo:[0,1] neg_hi:[0,1]
    v_pk_add_f32 v[28:29], v[28:29], v[64:65] op_sel_hi:[1,0] neg_lo:[0,1] neg_hi:[0,1]
    v_pk_add_f32 v[30:31], v[30:31], v[64:65] op_sel_hi:[1,0] neg_lo:[0,1] neg_hi:[0,1]
    v_pk_mul_f32 v[66:67], v[16:17], v[16:17]
    v_pk_mul_f32 v[68:69], v[18:19], v[18:19]
    v_pk_fma_f32 v[66:67], v[20:21], v[20:21], v[66:67]
    v_pk_fma_f32 v[68:69], v[22:23], v[22:23], v[68:69]
    v_pk_fma_f32 v[66:67], v[24:25], v[24:25], v[66:67]
    v_pk_fma_f32 v[68:69], v[26:27], v[26:27], v[68:69]
    v_pk_fma_f32 v[66:67], v[28:29], v[28:29], v[66:67]
    v_pk_fma_f32 v[68:69], v[30:31], v[30:31], v[68:69]
    v_pk_add_f32 v[66:67], v[66:67], v[68:69]
    v_add_f32 v66, v66, v67
    s_nop 1
    v_add_f32_dpp v66, v66, v66 row_ror:1 row_mask:0xf bank_mask:0xf
    s_nop 1
    v_add_f32_dpp v66, v66, v66 row_ror:2 row_mask:0xf bank_mask:0xf
    s_nop 1
    v_add_f32_dpp v66, v66, v66 row_ror:4 row_mask:0xf bank_mask:0xf
    s_nop 1
    v_add_f32_dpp v66, v66, v66 row_ror:8 row_mask:0xf bank_mask:0xf
    v_mov_b32 v67, v66
    s_nop 1
    v_permlane16_swap_b32 v66, v67
    v_add_f32 v66, v66, v67
    v_mov_b32 v67, v66
    s_nop 1
    v_permlane32_swap_b32 v66, v67
    v_add_f32 v66, v66, v67
    v_mov_b32 v68, 0x3727c5ac
    v_fma_f32 v66, v66, s6, v68
    v_rsq_f32 v66, v66
    s_lshl_b32 s6, s3, 3
    s_add_u32 s6, s6, 2048
    v_mov_b32 v68, s6
    v_mul_f32 v67, -v64, v66
    ds_write_b64 v68, v[66:67]
    s_mov_b32 s6, 0xbfb8aa3b
    s_waitcnt vmcnt(13)
    v_lshlrev_b32 v72, 16, v72
    v_lshlrev_b32 v73, 16, v73
    v_mul_f32 v74, s6, v72
    v_mul_f32 v75, s6, v73
    v_exp_f32 v74, v74
    v_exp_f32 v75, v75
    s_nop 0
    v_add_f32 v74, 1.0, v74
    v_add_f32 v75, 1.0, v75
    v_rcp_f32 v74, v74
    v_rcp_f32 v75, v75
    s_nop 0
    v_mul_f32 v72, v72, v74
    v_mul_f32 v73, v73, v75
    v_cvt_pk_bf16_f32 v72, v72, v72
    v_cvt_pk_bf16_f32 v73, v73, v73
    v_lshlrev_b32 v72, 16, v72
    v_lshlrev_b32 v73, 16, v73
    s_waitcnt vmcnt(12)
    v_lshlrev_b32 v84, 16, v76
    v_and_b32 v85, 0xffff0000, v76
    v_lshlrev_b32 v86, 16, v77
    v_and_b32 v87, 0xffff0000, v77
    v_lshlrev_b32 v88, 16, v78
    v_and_b32 v89, 0xffff0000, v78
    v_lshlrev_b32 v90, 16, v79
    v_and_b32 v91, 0xffff0000, v79
    v_mul_f32 v92, v72, v84
    v_mul_f32 v93, v72, v85
    v_mul_f32 v94, v72, v86
    v_mul_f32 v95, v72, v87
    v_mul_f32 v96, v72, v88
    v_mul_f32 v97, v72, v89
    v_mul_f32 v98, v72, v90
    v_mul_f32 v99, v72, v91
    s_waitcnt vmcnt(11)
    v_lshlrev_b32 v84, 16, v80
    v_and_b32 v85, 0xffff0000, v80
    v_lshlrev_b32 v86, 16, v81
    v_and_b32 v87, 0xffff0000, v81
    v_lshlrev_b32 v88, 16, v82
    v_and_b32 v89, 0xffff0000, v82
    v_lshlrev_b32 v90, 16, v83
    v_and_b32 v91, 0xffff0000, v83
    v_fmac_f32 v92, v73, v84
    v_fmac_f32 v93, v73, v85
    v_fmac_f32 v94, v73, v86
    v_fmac_f32 v95, v73, v87
    v_fmac_f32 v96, v73, v88
    v_fmac_f32 v97, v73, v89
    v_fmac_f32 v98, v73, v90
    v_fmac_f32 v99, v73, v91
    v_add_f32_dpp v92, v92, v92 row_ror:8 row_mask:0xf bank_mask:0xf
    v_add_f32_dpp v93, v93, v93 row_ror:8 row_mask:0xf bank_mask:0xf
    v_add_f32_dpp v94, v94, v94 row_ror:8 row_mask:0xf bank_mask:0xf
    v_add_f32_dpp v95, v95, v95 row_ror:8 row_mask:0xf bank_mask:0xf
    v_add_f32_dpp v96, v96, v96 row_ror:8 row_mask:0xf bank_mask:0xf
    v_add_f32_dpp v97, v97, v97 row_ror:8 row_mask:0xf bank_mask:0xf
    v_add_f32_dpp v98, v98, v98 row_ror:8 row_mask:0xf bank_mask:0xf
    v_add_f32_dpp v99, v99, v99 row_ror:8 row_mask:0xf bank_mask:0xf
    v_mov_b32 v84, v92
    v_mov_b32 v85, v93
    v_mov_b32 v86, v94
    v_mov_b32 v87, v95
    v_mov_b32 v88, v96
    v_mov_b32 v89, v97
    v_mov_b32 v90, v98
    v_mov_b32 v91, v99
    v_permlane16_swap_b32 v92, v84
    v_permlane16_swap_b32 v93, v85
    v_permlane16_swap_b32 v94, v86
    v_permlane16_swap_b32 v95, v87
    v_permlane16_swap_b32 v96, v88
    v_permlane16_swap_b32 v97, v89
    v_permlane16_swap_b32 v98, v90
    v_permlane16_swap_b32 v99, v91
    v_add_f32 v92, v92, v84
    v_add_f32 v93, v93, v85
    v_add_f32 v94, v94, v86
    v_add_f32 v95, v95, v87
    v_add_f32 v96, v96, v88
    v_add_f32 v97, v97, v89
    v_add_f32 v98, v98, v90
    v_add_f32 v99, v99, v91
    v_mov_b32 v84, v92
    v_mov_b32 v85, v93
    v_mov_b32 v86, v94
    v_mov_b32 v87, v95
    v_mov_b32 v88, v96
    v_mov_b32 v89, v97
    v_mov_b32 v90, v98
    v_mov_b32 v91, v99
    v_permlane32_swap_b32 v92, v84
    v_permlane32_swap_b32 v93, v85
    v_permlane32_swap_b32 v94, v86
    v_permlane32_swap_b32 v95, v87
    v_permlane32_swap_b32 v96, v88
    v_permlane32_swap_b32 v97, v89
    v_permlane32_swap_b32 v98, v90
    v_permlane32_swap_b32 v99, v91
    v_add_f32 v92, v92, v84
    v_add_f32 v93, v93, v85
    v_add_f32 v94, v94, v86
    v_add_f32 v95, v95, v87
    v_add_f32 v96, v96, v88
    v_add_f32 v97, v97, v89
    v_add_f32 v98, v98, v90
    v_add_f32 v99, v99, v91
    s_lshl_b32 s6, s3, 8
    s_add_u32 s6, s6, 0
    v_and_b32 v100, 7, v0
    v_lshl_add_u32 v100, v100, 5, s6
    s_mov_b64 exec, 0xff
    ds_write_b128 v100, v[92:95]
    ds_write_b128 v100, v[96:99] offset:16
    s_mov_b64 exec, -1
    s_waitcnt lgkmcnt(0)
    s_mul_i32 s33, s33, 0x9E3779B1
    s_add_u32 s33, s33, 0x7F4A7C15
    s_and_b32 s33, s33, -2
    v_mov_b32 v253, s33
    s_add_u32 s24, s62, 0xc0000
    s_addc_u32 s25, s63, 0
    s_mov_b32 s26, 0x6000
    s_mov_b32 s27, 0x00020000
    s_barrier
    s_cmp_ge_u32 s3, 4
    s_cbranch_scc1 L_k1_ldr_2
    s_cmp_lg_u32 s3, 0
    s_cbranch_scc1 L_k1_nf_3
    v_lshlrev_b32 v34, 3, v2
    v_lshlrev_b32 v35, 2, v2
    ds_read_b64 v[36:37], v34 offset:2048
    ds_read_b32 v84, v35 offset:0
    ds_read_b32 v85, v35 offset:256
    ds_read_b32 v86, v35 offset:512
    ds_read_b32 v87, v35 offset:768
    ds_read_b32 v88, v35 offset:1024
    ds_read_b32 v89, v35 offset:1280
    ds_read_b32 v90, v35 offset:1536
    ds_read_b32 v91, v35 offset:1792
    s_lshl_b32 s35, s35, 7
    s_lshl_b32 s34, s34, 2
    s_add_u32 s34, s34, s35
    v_mov_b32 v38, v253
    v_mov_b32 v39, v253
    s_waitcnt lgkmcnt(8)
    buffer_store_dwordx4 v[36:39], v3, s[72:75], 0 offen sc1
    s_waitcnt lgkmcnt(0)
    v_add_f32 v84, v84, v85
    v_add_f32 v86, v86, v87
    v_add_f32 v88, v88, v89
    v_add_f32 v90, v90, v91
    v_add_f32 v84, v84, v86
    v_add_f32 v88, v88, v90
    v_add_f32 v84, v84, v88
    v_mov_b32 v85, v253
    buffer_store_dwordx2 v[84:85], v34, s[68:71], s34 offen sc1
    s_lshl_b32 s6, s4, 7
    s_lshl_b32 s32, s5, 2
    s_add_u32 s32, s32, s6
    s_add_u32 s32, s32, 16384
    s_lshl_b32 s6, s5, 7
    s_lshl_b32 s33, s4, 2
    s_add_u32 s33, s33, s6
    s_add_u32 s33, s33, 18432
    v_mov_b32 v34, s32
    v_writelane_b32 v34, s33, 1
    s_mov_b64 exec, 3
    buffer_store_dword v253, v34, s[24:27], 0 offen sc1
    s_mov_b64 exec, -1
L_k1_nf_3:
    s_lshl_b32 s6, s4, 7
    s_add_u32 s6, s6, 16384
    s_lshl_b32 s32, s5, 7
    s_add_u32 s32, s32, 18368
    v_and_b32 v34, 31, v2
    v_mov_b32 v35, s6
    v_mov_b32 v36, s32
    v_cmp_gt_u32 vcc, 16, v34
    s_lshl_b32 s33, s5, 9
    s_add_u32 s33, s33, 0x20000
    v_cndmask_b32 v35, v36, v35, vcc
    v_lshl_add_u32 v34, v34, 2, v35
    s_add_u32 s16, s62, s33
    s_addc_u32 s17, s63, 0
    s_mov_b32 s18, 0x20000
    s_mov_b32 s19, 0x00020000
    s_lshl_b32 s34, s4, 11
    s_add_u32 s34, s34, 0x40000
    s_add_u32 s12, s62, s34
    s_addc_u32 s13, s63, 0
    s_mov_b32 s14, 0x800
    s_mov_b32 s15, 0x00020000
    s_add_u32 s6, s5, 4
    s_mul_i32 s6, s6, 37
    s_lshr_b32 s6, s6, 8
    s_add_u32 s32, s5, s6
    s_lshl_b32 s32, s32, 7
    s_lshl_b32 s6, s4, 19
    s_add_u32 s32, s32, s6
    s_add_u32 s32, s32, 0x3000000
    s_add_u32 s28, s62, s32
    s_addc_u32 s29, s63, 0
    s_mov_b32 s30, 0x80000
    s_mov_b32 s31, 0x00020000
    s_lshl_b32 s100, s4, 7
    s_lshl_b32 s6, s5, 2
    s_add_u32 s100, s100, s6
    s_add_u32 s100, s100, 20480
    s_mov_b32 s68, 0
    s_mov_b32 s69, 16384
    s_mov_b32 s70, 32768
    s_mov_b32 s71, 49152
    s_mov_b32 s72, 65536
    s_mov_b32 s73, 81920
    s_mov_b32 s74, 98304
    s_mov_b32 s75, 114688
    v_lshlrev_b32 v8, 3, v2
    v_add_u32 v9, 8192, v8
    v_lshlrev_b32 v3, 2, v2
    s_lshl_b32 s6, s3, 9
    s_add_u32 s6, s6, 4096
    v_add_u32 v4, s6, v3
    v_lshl_add_u32 v7, v7, 5, s6
    s_waitcnt vmcnt(7)
    v_lshlrev_b32 v48, 16, v112
    v_and_b32 v49, 0xffff0000, v112
    v_lshlrev_b32 v50, 16, v113
    v_and_b32 v51, 0xffff0000, v113
    v_lshlrev_b32 v52, 16, v114
    v_and_b32 v53, 0xffff0000, v114
    v_lshlrev_b32 v54, 16, v115
    v_and_b32 v55, 0xffff0000, v115
    v_lshlrev_b32 v56, 16, v116
    v_and_b32 v57, 0xffff0000, v116
    v_lshlrev_b32 v58, 16, v117
    v_and_b32 v59, 0xffff0000, v117
    v_lshlrev_b32 v60, 16, v118
    v_and_b32 v61, 0xffff0000, v118
    v_lshlrev_b32 v62, 16, v119
    v_and_b32 v63, 0xffff0000, v119
    v_lshlrev_b32 v128, 16, v120
    v_and_b32 v129, 0xffff0000, v120
    v_lshlrev_b32 v130, 16, v121
    v_and_b32 v131, 0xffff0000, v121
    v_lshlrev_b32 v132, 16, v122
    v_and_b32 v133, 0xffff0000, v122
    v_lshlrev_b32 v134, 16, v123
    v_and_b32 v135, 0xffff0000, v123
    v_lshlrev_b32 v136, 16, v124
    v_and_b32 v137, 0xffff0000, v124
    v_lshlrev_b32 v138, 16, v125
    v_and_b32 v139, 0xffff0000, v125
    v_lshlrev_b32 v140, 16, v126
    v_and_b32 v141, 0xffff0000, v126
    v_lshlrev_b32 v142, 16, v127
    v_and_b32 v143, 0xffff0000, v127
    s_cmp_lg_u32 s3, 1
    s_cbranch_scc1 L_k1_np_4
    s_sleep 16
    s_mov_b32 s66, 262144
L_k1_a_l_5:
    buffer_load_dword v35, v34, s[24:27], 0 offen sc1
    s_waitcnt vmcnt(0)
    v_cmp_ne_u32 vcc, v35, v253
    s_sub_u32 s66, s66, 1
    s_cbranch_scc1 L_k1_a_d_6
    s_cbranch_vccz L_k1_a_d_6
    s_sleep 1
    s_branch L_k1_a_l_5
L_k1_a_d_6:
L_k1_np_4:
    s_barrier
    s_mov_b32 s66, 262144
L_k1_d_l_7:
    buffer_load_dwordx2 v[72:73], v8, s[16:19], s68 offen sc1
    buffer_load_dwordx2 v[74:75], v8, s[16:19], s69 offen sc1
    buffer_load_dwordx2 v[76:77], v8, s[16:19], s70 offen sc1
    buffer_load_dwordx2 v[78:79], v8, s[16:19], s71 offen sc1
    buffer_load_dwordx2 v[80:81], v8, s[16:19], s72 offen sc1
    buffer_load_dwordx2 v[82:83], v8, s[16:19], s73 offen sc1
    buffer_load_dwordx2 v[84:85], v8, s[16:19], s74 offen sc1
    buffer_load_dwordx2 v[86:87], v8, s[16:19], s75 offen sc1
    buffer_load_dwordx2 v[88:89], v9, s[16:19], s68 offen sc1
    buffer_load_dwordx2 v[90:91], v9, s[16:19], s69 offen sc1
    buffer_load_dwordx2 v[92:93], v9, s[16:19], s70 offen sc1
    buffer_load_dwordx2 v[94:95], v9, s[16:19], s71 offen sc1
    buffer_load_dwordx2 v[96:97], v9, s[16:19], s72 offen sc1
    buffer_load_dwordx2 v[98:99], v9, s[16:19], s73 offen sc1
    buffer_load_dwordx2 v[100:101], v9, s[16:19], s74 offen sc1
    buffer_load_dwordx2 v[102:103], v9, s[16:19], s75 offen sc1
    buffer_load_dwordx4 v[16:19], v6, s[12:15], 0 offen offset:0 sc1
    buffer_load_dwordx4 v[20:23], v6, s[12:15], 0 offen offset:512 sc1
    buffer_load_dwordx4 v[24:27], v6, s[12:15], 0 offen offset:1024 sc1
    buffer_load_dwordx4 v[28:31], v6, s[12:15], 0 offen offset:1536 sc1
    s_waitcnt vmcnt(18)
    v_min3_u32 v10, v253, v73, v75
    v_max3_u32 v11, v253, v73, v75
    s_waitcnt vmcnt(16)
    v_min3_u32 v10, v10, v77, v79
    v_max3_u32 v11, v11, v77, v79
    s_waitcnt vmcnt(14)
    v_min3_u32 v10, v10, v81, v83
    v_max3_u32 v11, v11, v81, v83
    s_waitcnt vmcnt(12)
    v_min3_u32 v10, v10, v85, v87
    v_max3_u32 v11, v11, v85, v87
    s_waitcnt vmcnt(10)
    v_min3_u32 v10, v10, v89, v91
    v_max3_u32 v11, v11, v89, v91
    s_waitcnt vmcnt(8)
    v_min3_u32 v10, v10, v93, v95
    v_max3_u32 v11, v11, v93, v95
    s_waitcnt vmcnt(6)
    v_min3_u32 v10, v10, v97, v99
    v_max3_u32 v11, v11, v97, v99
    s_waitcnt vmcnt(4)
    v_min3_u32 v10, v10, v101, v103
    v_max3_u32 v11, v11, v101, v103
    s_waitcnt vmcnt(2)
    v_min3_u32 v10, v10, v18, v22
    v_max3_u32 v11, v11, v18, v22
    s_waitcnt vmcnt(0)
    v_min3_u32 v10, v10, v26, v30
    v_max3_u32 v11, v11, v26, v30
    v_cmp_ne_u32 vcc, v10, v11
    s_sub_u32 s66, s66, 1
    s_cbranch_scc1 L_k1_d_d_8
    s_cbranch_vccz L_k1_d_d_8
    s_branch L_k1_d_l_7
L_k1_d_d_8:
    v_add_f32 v72, v72, v74
    v_add_f32 v76, v76, v78
    v_add_f32 v80, v80, v82
    v_add_f32 v84, v84, v86
    v_add_f32 v72, v72, v76
    v_add_f32 v80, v80, v84
    v_add_f32 v72, v72, v80
    v_cvt_pk_bf16_f32 v72, v72, v72
    v_lshlrev_b32 v72, 16, v72
    ds_write_b32 v4, v72 offset:0
    v_add_f32 v88, v88, v90
    v_add_f32 v92, v92, v94
    v_add_f32 v96, v96, v98
    v_add_f32 v100, v100, v102
    v_add_f32 v88, v88, v92
    v_add_f32 v96, v96, v100
    v_add_f32 v88, v88, v96
    v_cvt_pk_bf16_f32 v88, v88, v88
    v_lshlrev_b32 v88, 16, v88
    v_add_f32 v88, 1.0, v88
    v_cvt_pk_bf16_f32 v88, v88, v88
    v_lshlrev_b32 v88, 16, v88
    ds_write_b32 v4, v88 offset:256
    ds_read_b128 v[144:147], v7
    ds_read_b128 v[148:151], v7 offset:16
    ds_read_b128 v[152:155], v7 offset:256
    ds_read_b128 v[156:159], v7 offset:272
    v_pk_fma_f32 v[48:49], v[48:49], v[16:17], v[16:17] op_sel:[0,0,1] op_sel_hi:[1,0,1]
    v_pk_fma_f32 v[50:51], v[50:51], v[16:17], v[16:17] op_sel:[0,0,1] op_sel_hi:[1,0,1]
    v_pk_fma_f32 v[52:53], v[52:53], v[16:17], v[16:17] op_sel:[0,0,1] op_sel_hi:[1,0,1]
    v_pk_fma_f32 v[54:55], v[54:55], v[16:17], v[16:17] op_sel:[0,0,1] op_sel_hi:[1,0,1]
    v_pk_fma_f32 v[56:57], v[56:57], v[20:21], v[20:21] op_sel:[0,0,1] op_sel_hi:[1,0,1]
    v_pk_fma_f32 v[58:59], v[58:59], v[20:21], v[20:21] op_sel:[0,0,1] op_sel_hi:[1,0,1]
    v_pk_fma_f32 v[60:61], v[60:61], v[20:21], v[20:21] op_sel:[0,0,1] op_sel_hi:[1,0,1]
    v_pk_fma_f32 v[62:63], v[62:63], v[20:21], v[20:21] op_sel:[0,0,1] op_sel_hi:[1,0,1]
    v_pk_fma_f32 v[128:129], v[128:129], v[24:25], v[24:25] op_sel:[0,0,1] op_sel_hi:[1,0,1]
    v_pk_fma_f32 v[130:131], v[130:131], v[24:25], v[24:25] op_sel:[0,0,1] op_sel_hi:[1,0,1]
    v_pk_fma_f32 v[132:133], v[132:133], v[24:25], v[24:25] op_sel:[0,0,1] op_sel_hi:[1,0,1]
    v_pk_fma_f32 v[134:135], v[134:135], v[24:25], v[24:25] op_sel:[0,0,1] op_sel_hi:[1,0,1]
    v_pk_fma_f32 v[136:137], v[136:137], v[28:29], v[28:29] op_sel:[0,0,1] op_sel_hi:[1,0,1]
    v_pk_fma_f32 v[138:139], v[138:139], v[28:29], v[28:29] op_sel:[0,0,1] op_sel_hi:[1,0,1]
    v_pk_fma_f32 v[140:141], v[140:141], v[28:29], v[28:29] op_sel:[0,0,1] op_sel_hi:[1,0,1]
    v_pk_fma_f32 v[142:143], v[142:143], v[28:29], v[28:29] op_sel:[0,0,1] op_sel_hi:[1,0,1]
    s_waitcnt lgkmcnt(0)
    v_pk_fma_f32 v[48:49], v[48:49], v[152:153], v[144:145]
    v_pk_fma_f32 v[50:51], v[50:51], v[154:155], v[146:147]
    v_pk_fma_f32 v[52:53], v[52:53], v[156:157], v[148:149]
    v_pk_fma_f32 v[54:55], v[54:55], v[158:159], v[150:151]
    v_cvt_pk_bf16_f32 v112, v48, v49
    v_cvt_pk_bf16_f32 v113, v50, v51
    v_cvt_pk_bf16_f32 v114, v52, v53
    v_cvt_pk_bf16_f32 v115, v54, v55
    s_mov_b32 s6, 0
    buffer_store_dwordx4 v[112:115], v33, s[28:31], s6 offen sc1
    v_pk_fma_f32 v[56:57], v[56:57], v[152:153], v[144:145]
    v_pk_fma_f32 v[58:59], v[58:59], v[154:155], v[146:147]
    v_pk_fma_f32 v[60:61], v[60:61], v[156:157], v[148:149]
    v_pk_fma_f32 v[62:63], v[62:63], v[158:159], v[150:151]
    v_cvt_pk_bf16_f32 v116, v56, v57
    v_cvt_pk_bf16_f32 v117, v58, v59
    v_cvt_pk_bf16_f32 v118, v60, v61
    v_cvt_pk_bf16_f32 v119, v62, v63
    s_mov_b32 s6, 131072
    buffer_store_dwordx4 v[116:119], v33, s[28:31], s6 offen sc1
    v_pk_fma_f32 v[128:129], v[128:129], v[152:153], v[144:145]
    v_pk_fma_f32 v[130:131], v[130:131], v[154:155], v[146:147]
    v_pk_fma_f32 v[132:133], v[132:133], v[156:157], v[148:149]
    v_pk_fma_f32 v[134:135], v[134:135], v[158:159], v[150:151]
    v_cvt_pk_bf16_f32 v120, v128, v129
    v_cvt_pk_bf16_f32 v121, v130, v131
    v_cvt_pk_bf16_f32 v122, v132, v133
    v_cvt_pk_bf16_f32 v123, v134, v135
    s_mov_b32 s6, 262144
    buffer_store_dwordx4 v[120:123], v33, s[28:31], s6 offen sc1
    v_pk_fma_f32 v[136:137], v[136:137], v[152:153], v[144:145]
    v_pk_fma_f32 v[138:139], v[138:139], v[154:155], v[146:147]
    v_pk_fma_f32 v[140:141], v[140:141], v[156:157], v[148:149]
    v_pk_fma_f32 v[142:143], v[142:143], v[158:159], v[150:151]
    v_cvt_pk_bf16_f32 v124, v136, v137
    v_cvt_pk_bf16_f32 v125, v138, v139
    v_cvt_pk_bf16_f32 v126, v140, v141
    v_cvt_pk_bf16_f32 v127, v142, v143
    s_mov_b32 s6, 393216
    buffer_store_dwordx4 v[124:127], v33, s[28:31], s6 offen sc1
    s_branch L_phase_k2
L_k1_ldr_2:
    s_cmp_eq_u32 s3, 4
    s_cbranch_scc1 L_k1_l4_9
    v_subrev_u32 v4, 320, v0
    v_lshlrev_b32 v4, 7, v4
    s_getpc_b64 s[8:9]
L_pc_10:
    s_add_u32 s8, s8, L_code_k2-L_pc_10
    s_addc_u32 s9, s9, 0
    s_mov_b32 s10, L_code_k4-L_code_k2
    s_mov_b32 s11, 0x00020000
    buffer_load_dword v251, v4, s[8:11], 0 offen
    s_mov_b32 s6, 1572864
    buffer_load_dword v250, v40, s[96:99], s6 offen
    s_waitcnt vmcnt(0)
    s_mov_b32 s6, 3145728
    buffer_load_dword v250, v40, s[96:99], s6 offen
    s_barrier
    s_waitcnt vmcnt(0)
    s_mov_b32 s6, 4718592
    buffer_load_dword v250, v40, s[96:99], s6 offen
    s_branch L_phase_k2
L_k1_l4_9:
    s_waitcnt vmcnt(0)
    s_mul_i32 s6, s2, 24576
    s_add_u32 s6, s6, 0x5000080
    s_add_u32 s8, s62, s6
    s_addc_u32 s9, s63, 0
    s_mov_b32 s10, 0x6000
    s_mov_b32 s11, 0x00020000
    s_movk_i32 s6, 0
    buffer_store_dwordx4 v[144:147], v32, s[8:11], s6 offen sc1
    s_movk_i32 s6, 8192
    buffer_store_dwordx4 v[148:151], v32, s[8:11], s6 offen sc1
    s_movk_i32 s6, 16384
    buffer_store_dwordx4 v[152:155], v32, s[8:11], s6 offen sc1
    s_mul_i32 s6, s2, 8192
    s_add_u32 s6, s6, 0x5800080
    s_add_u32 s8, s62, s6
    s_addc_u32 s9, s63, 0
    s_mov_b32 s10, 0x2000
    s_mov_b32 s11, 0x00020000
    s_movk_i32 s6, 0
    buffer_store_dwordx4 v[156:159], v32, s[8:11], s6 offen sc1
    s_mul_i32 s6, s2, 14336
    s_add_u32 s6, s6, 0x5c00080
    s_add_u32 s8, s62, s6
    s_addc_u32 s9, s63, 0
    s_mov_b32 s10, 0x3800
    s_mov_b32 s11, 0x00020000
    s_movk_i32 s6, 0
    buffer_store_dwordx4 v[160:163], v32, s[8:11], s6 offen sc1
    s_movk_i32 s6, 8192
    buffer_store_dwordx4 v[164:167], v32, s[8:11], s6 offen sc1
    s_lshl_b32 s6, s2, 2
    s_add_u32 s6, s6, 22528
    v_mov_b32 v34, 0
    s_mov_b64 exec, 1
    s_waitcnt vmcnt(0)
    buffer_store_dword v253, v34, s[24:27], s6 offen sc1
    s_barrier
.p2align 3
L_code_k2:
L_phase_k2:
    s_mov_b64 exec, -1
    s_lshr_b32 s6, s2, 3
    s_and_b32 s4, s6, 7
    s_and_b32 s7, s2, 1
    s_lshl_b32 s7, s7, 3
    s_add_u32 s4, s4, s7
    s_lshr_b32 s5, s6, 3
    s_bfe_u32 s7, s2, 0x20001
    s_lshl_b32 s7, s7, 2
    s_add_u32 s5, s5, s7
    s_mul_i32 s6, s4, 524288
    s_add_u32 s6, s6, 0x3000000
    s_add_u32 s8, s62, s6
    s_addc_u32 s9, s63, 0
    s_mov_b32 s10, 0x80000
    s_mov_b32 s11, 0x00020000
    s_mul_i32 s6, s5, 128
    s_sub_u32 s7, 0x600000, s6
    s_and_b32 s14, s5, 7
    s_cmp_eq_u32 s14, 3
    s_cselect_b64 s[12:13], s[62:63], s[38:39]
    s_cselect_b32 s14, 0x5000080, 0
    s_add_u32 s6, s6, s14
    s_add_u32 s12, s12, s6
    s_addc_u32 s13, s13, 0
    s_mov_b32 s14, s7
    s_mov_b32 s15, 0x00020000
    s_lshl_b32 s6, s5, 12
    s_add_u32 s24, s40, s6
    s_addc_u32 s25, s41, 0
    s_mov_b32 s26, 0x1000
    s_mov_b32 s27, 0x00020000
    s_mul_i32 s6, s5, 262144
    s_add_u32 s6, s6, 0x100000
    s_add_u32 s16, s62, s6
    s_addc_u32 s17, s63, 0
    s_mov_b32 s18, 0x40000
    s_mov_b32 s19, 0x00020000
    s_mul_i32 s6, s5, 16640
    s_add_u32 s6, s6, 0x500000
    s_add_u32 s20, s62, s6
    s_addc_u32 s21, s63, 0
    s_mov_b32 s22, 0x4100
    s_mov_b32 s23, 0x00020000
    s_cmp_ge_u32 s3, 4
    s_cbranch_scc1 L_k2_ldr_11
    s_setprio 2
    v_and_b32 v1, 63, v0
    s_lshr_b32 s34, s3, 1
    s_mul_i32 s34, s34, 64
    s_and_b32 s35, s3, 1
    v_and_b32 v10, 31, v1
    v_bfe_u32 v11, v1, 1, 3
    v_lshrrev_b32 v12, 5, v1
    v_xor_b32 v11, v11, v12
    v_add_u32 v10, s34, v10
    v_lshlrev_b32 v10, 7, v10
    v_lshl_add_u32 v2, v11, 4, v10
    v_xor_b32 v3, 32, v2
    v_xor_b32 v4, 64, v2
    v_xor_b32 v5, 96, v2
    v_bfe_u32 v10, v1, 2, 2
    v_lshl_add_u32 v10, v12, 3, v10
    v_bfe_u32 v11, v1, 4, 1
    v_lshlrev_b32 v11, 5, v11
    v_and_b32 v13, 1, v1
    v_lshl_add_u32 v11, v13, 4, v11
    v_bfe_u32 v13, v1, 1, 1
    v_lshl_add_u32 v11, v13, 3, v11
    v_bfe_u32 v13, v1, 3, 1
    v_lshl_add_u32 v11, v13, 6, v11
    v_lshl_add_u32 v6, v10, 7, v11
    s_lshl_b32 s6, s35, 6
    v_xor_b32 v6, s6, v6
    s_add_u32 s6, s5, 4
    s_mul_i32 s6, s6, 37
    s_lshr_b32 s6, s6, 8
    s_add_u32 s32, s5, s6
    s_lshl_b32 s32, s32, 7
    s_lshl_b32 s6, s4, 19
    s_add_u32 s32, s32, s6
    s_add_u32 s32, s32, 0x1000000
    s_add_u32 s28, s62, s32
    s_addc_u32 s29, s63, 0
    s_mov_b32 s30, 0x80000
    s_mov_b32 s31, 0x00020000
    v_bfe_u32 v10, v1, 2, 2
    v_lshrrev_b32 v13, 5, v1
    v_lshl_add_u32 v10, v13, 3, v10
    v_bfe_u32 v11, v1, 4, 1
    v_lshlrev_b32 v11, 5, v11
    v_and_b32 v12, 1, v1
    v_lshl_add_u32 v11, v12, 4, v11
    v_bfe_u32 v12, v1, 1, 1
    v_lshl_add_u32 v11, v12, 3, v11
    s_lshr_b32 s33, s3, 1
    s_lshl_b32 s6, s35, 13
    s_add_u32 s6, s6, 49152
    v_lshl_add_u32 v160, v10, 6, v11
    v_add_u32 v160, s6, v160
    s_mul_i32 s6, s35, 24576
    s_lshl_b32 s7, s33, 6
    s_add_u32 s6, s6, s7
    v_mul_u32_u24 v10, 192, v10
    v_add3_u32 v161, v10, v11, s6
    v_lshlrev_b32 v162, 4, v1
    s_lshl_b32 s6, s35, 1
    s_add_u32 s6, s6, s33
    s_lshl_b32 s7, s6, 15
    s_lshl_b32 s32, s4, 10
    s_add_u32 s72, s7, s32
    s_add_u32 s73, s72, 16384
    s_lshl_b32 s6, s6, 7
    s_lshl_b32 s7, s4, 9
    s_add_u32 s74, s6, s7
    s_add_u32 s74, s74, 8192
    v_and_b32 v10, 0x13, v1
    v_bfe_u32 v11, v1, 2, 1
    v_lshl_add_u32 v10, v11, 3, v10
    v_bfe_u32 v11, v1, 3, 1
    v_lshl_add_u32 v10, v11, 2, v10
    v_lshlrev_b32 v163, 2, v10
    s_lshl_b32 s96, s4, 2
    s_add_u32 s96, s96, 16384
    s_cmp_eq_u32 s3, 0
    s_cselect_b64 s[98:99], 1, 0
    v_mov_b32 v14, 0
    v_lshrrev_b32 v240, 0, v1
    v_min_u32 v240, 15, v240
    s_lshl_b32 s6, s4, 7
    s_add_u32 s6, s6, 20480
    v_lshl_add_u32 v240, v240, 2, s6
    v_mov_b32 v56, 0
    v_mov_b32 v57, 0
    v_mov_b32 v58, 0
    v_mov_b32 v59, 0
    v_mov_b32 v60, 0
    v_mov_b32 v61, 0
    v_mov_b32 v62, 0
    v_mov_b32 v63, 0
    v_mov_b32 v64, 0
    v_mov_b32 v65, 0
    v_mov_b32 v66, 0
    v_mov_b32 v67, 0
    v_mov_b32 v68, 0
    v_mov_b32 v69, 0
    v_mov_b32 v70, 0
    v_mov_b32 v71, 0
    v_mov_b32 v72, 0
    v_mov_b32 v73, 0
    v_mov_b32 v74, 0
    v_mov_b32 v75, 0
    v_mov_b32 v76, 0
    v_mov_b32 v77, 0
    v_mov_b32 v78, 0
    v_mov_b32 v79, 0
    v_mov_b32 v80, 0
    v_mov_b32 v81, 0
    v_mov_b32 v82, 0
    v_mov_b32 v83, 0
    v_mov_b32 v84, 0
    v_mov_b32 v85, 0
    v_mov_b32 v86, 0
    v_mov_b32 v87, 0
    v_mov_b32 v88, 0
    v_mov_b32 v89, 0
    v_mov_b32 v90, 0
    v_mov_b32 v91, 0
    v_mov_b32 v92, 0
    v_mov_b32 v93, 0
    v_mov_b32 v94, 0
    v_mov_b32 v95, 0
    v_mov_b32 v96, 0
    v_mov_b32 v97, 0
    v_mov_b32 v98, 0
    v_mov_b32 v99, 0
    v_mov_b32 v100, 0
    v_mov_b32 v101, 0
    v_mov_b32 v102, 0
    v_mov_b32 v103, 0
    v_mov_b32 v104, 0
    v_mov_b32 v105, 0
    v_mov_b32 v106, 0
    v_mov_b32 v107, 0
    v_mov_b32 v108, 0
    v_mov_b32 v109, 0
    v_mov_b32 v110, 0
    v_mov_b32 v111, 0
    v_mov_b32 v112, 0
    v_mov_b32 v113, 0
    v_mov_b32 v114, 0
    v_mov_b32 v115, 0
    v_mov_b32 v116, 0
    v_mov_b32 v117, 0
    v_mov_b32 v118, 0
    v_mov_b32 v119, 0
    v_mov_b32 v120, 0
    v_mov_b32 v121, 0
    v_mov_b32 v122, 0
    v_mov_b32 v123, 0
    v_mov_b32 v124, 0
    v_mov_b32 v125, 0
    v_mov_b32 v126, 0
    v_mov_b32 v127, 0
    v_mov_b32 v128, 0
    v_mov_b32 v129, 0
    v_mov_b32 v130, 0
    v_mov_b32 v131, 0
    v_mov_b32 v132, 0
    v_mov_b32 v133, 0
    v_mov_b32 v134, 0
    v_mov_b32 v135, 0
    v_mov_b32 v136, 0
    v_mov_b32 v137, 0
    v_mov_b32 v138, 0
    v_mov_b32 v139, 0
    v_mov_b32 v140, 0
    v_mov_b32 v141, 0
    v_mov_b32 v142, 0
    v_mov_b32 v143, 0
    v_mov_b32 v144, 0
    v_mov_b32 v145, 0
    v_mov_b32 v146, 0
    v_mov_b32 v147, 0
    v_mov_b32 v148, 0
    v_mov_b32 v149, 0
    v_mov_b32 v150, 0
    v_mov_b32 v151, 0
    s_waitcnt vmcnt(0)
    s_barrier
    s_add_u32 s68, s62, 0xc0000
    s_addc_u32 s69, s63, 0
    s_mov_b32 s70, 0x6000
    s_mov_b32 s71, 0x00020000
    v_mov_b32 v10, 0
    s_cmp_eq_u32 s3, 0
    s_cselect_b64 exec, 1, 0
    buffer_store_dword v253, v10, s[68:71], s100 offen sc1
    s_mov_b64 exec, -1
    s_cmp_lg_u32 s3, 1
    s_cbranch_scc1 L_k2_np_13
    s_mov_b32 s66, 262144
L_k2_dl_14:
    buffer_load_dword v242, v240, s[68:71], 0 offen sc1
    s_waitcnt vmcnt(0)
    v_cmp_eq_u32 vcc, v253, v242
    s_and_b32 s67, vcc_lo, 0xffff
    s_sub_u32 s66, s66, 1
    s_cselect_b32 s67, 0xffff, s67
    s_bcnt1_i32_b32 s6, s67
    s_cmp_ge_u32 s6, 8
    s_cbranch_scc1 L_k2_dd_15
    s_sleep 1
    s_branch L_k2_dl_14
L_k2_dd_15:
    v_mov_b32 v240, s67
    v_mov_b32 v241, 163832
    ds_write_b32 v241, v240
    s_waitcnt lgkmcnt(0)
L_k2_np_13:
    s_barrier
    s_lshl_b32 s100, s4, 7
    s_lshl_b32 s6, s5, 2
    s_add_u32 s100, s100, s6
    s_add_u32 s100, s100, 0
    s_mov_b32 s64, 0
    s_mov_b32 s67, 40960
    s_mov_b32 s6, 16
    s_barrier
    ds_read_b64_tr_b16 v[24:25], v6 offset:16384
    ds_read_b64_tr_b16 v[26:27], v6 offset:16896
    ds_read_b128 v[16:19], v2 offset:0
    ds_read_b128 v[20:23], v2 offset:4096
    ds_read_b64_tr_b16 v[28:29], v6 offset:24576
    ds_read_b64_tr_b16 v[30:31], v6 offset:25088
    ds_read_b64_tr_b16 v[32:33], v6 offset:32768
    ds_read_b64_tr_b16 v[34:35], v6 offset:33280
    v_and_b32 v10, 0x13, v1
    v_bfe_u32 v11, v1, 2, 1
    v_lshl_add_u32 v10, v11, 3, v10
    v_bfe_u32 v11, v1, 3, 1
    v_lshl_add_u32 v10, v11, 2, v10
    v_lshlrev_b32 v10, 1, v10
    v_lshrrev_b32 v11, 5, v1
    v_lshl_add_u32 v10, v11, 9, v10
    s_lshl_b32 s32, s35, 11
    buffer_load_ushort v164, v10, s[24:27], s32 offen offset:0
    buffer_load_ushort v165, v10, s[24:27], s32 offen offset:64
    buffer_load_ushort v166, v10, s[24:27], s32 offen offset:128
    buffer_load_ushort v167, v10, s[24:27], s32 offen offset:192
    buffer_load_ushort v168, v10, s[24:27], s32 offen offset:256
    buffer_load_ushort v169, v10, s[24:27], s32 offen offset:320
    buffer_load_ushort v170, v10, s[24:27], s32 offen offset:384
    buffer_load_ushort v171, v10, s[24:27], s32 offen offset:448
    buffer_load_ushort v172, v10, s[24:27], s32 offen offset:1024
    buffer_load_ushort v173, v10, s[24:27], s32 offen offset:1088
    buffer_load_ushort v174, v10, s[24:27], s32 offen offset:1152
    buffer_load_ushort v175, v10, s[24:27], s32 offen offset:1216
    buffer_load_ushort v176, v10, s[24:27], s32 offen offset:1280
    buffer_load_ushort v177, v10, s[24:27], s32 offen offset:1344
    buffer_load_ushort v178, v10, s[24:27], s32 offen offset:1408
    buffer_load_ushort v179, v10, s[24:27], s32 offen offset:1472
    s_mov_b32 s97, 8
.p2align 4
L_k2_cl_16:
    s_add_u32 s64, s64, 40960
    s_cmp_eq_u32 s64, 163840
    s_cselect_b32 s65, 0xfffe2000, s67
    s_cselect_b32 s64, 0, s64
    s_waitcnt lgkmcnt(0)
    v_mfma_f32_32x32x16_bf16 v[56:71], v[24:27], v[16:19], v[56:71]
    ds_read_b64_tr_b16 v[44:45], v6 offset:18432
    ds_read_b64_tr_b16 v[46:47], v6 offset:18944
    v_mfma_f32_32x32x16_bf16 v[72:87], v[24:27], v[20:23], v[72:87]
    ds_read_b128 v[36:39], v3 offset:0
    ds_read_b128 v[40:43], v3 offset:4096
    v_mfma_f32_32x32x16_bf16 v[88:103], v[28:31], v[16:19], v[88:103]
    ds_read_b64_tr_b16 v[48:49], v6 offset:26624
    ds_read_b64_tr_b16 v[50:51], v6 offset:27136
    v_mfma_f32_32x32x16_bf16 v[104:119], v[28:31], v[20:23], v[104:119]
    ds_read_b64_tr_b16 v[52:53], v6 offset:34816
    ds_read_b64_tr_b16 v[54:55], v6 offset:35328
    v_mfma_f32_32x32x16_bf16 v[120:135], v[32:35], v[16:19], v[120:135]
    v_add_u32 v3, s65, v3
    v_add_u32 v2, s65, v2
    v_mfma_f32_32x32x16_bf16 v[136:151], v[32:35], v[20:23], v[136:151]
    s_waitcnt lgkmcnt(0)
    v_mfma_f32_32x32x16_bf16 v[56:71], v[44:47], v[36:39], v[56:71]
    ds_read_b64_tr_b16 v[24:25], v6 offset:20480
    ds_read_b64_tr_b16 v[26:27], v6 offset:20992
    v_mfma_f32_32x32x16_bf16 v[72:87], v[44:47], v[40:43], v[72:87]
    ds_read_b128 v[16:19], v4 offset:0
    ds_read_b128 v[20:23], v4 offset:4096
    v_mfma_f32_32x32x16_bf16 v[88:103], v[48:51], v[36:39], v[88:103]
    ds_read_b64_tr_b16 v[28:29], v6 offset:28672
    ds_read_b64_tr_b16 v[30:31], v6 offset:29184
    v_mfma_f32_32x32x16_bf16 v[104:119], v[48:51], v[40:43], v[104:119]
    ds_read_b64_tr_b16 v[32:33], v6 offset:36864
    ds_read_b64_tr_b16 v[34:35], v6 offset:37376
    v_mfma_f32_32x32x16_bf16 v[120:135], v[52:55], v[36:39], v[120:135]
    v_add_u32 v4, s65, v4
    v_mfma_f32_32x32x16_bf16 v[136:151], v[52:55], v[40:43], v[136:151]
    s_waitcnt lgkmcnt(0)
    v_mfma_f32_32x32x16_bf16 v[56:71], v[24:27], v[16:19], v[56:71]
    ds_read_b64_tr_b16 v[44:45], v6 offset:22528
    ds_read_b64_tr_b16 v[46:47], v6 offset:23040
    v_mfma_f32_32x32x16_bf16 v[72:87], v[24:27], v[20:23], v[72:87]
    ds_read_b128 v[36:39], v5 offset:0
    ds_read_b128 v[40:43], v5 offset:4096
    v_mfma_f32_32x32x16_bf16 v[88:103], v[28:31], v[16:19], v[88:103]
    ds_read_b64_tr_b16 v[48:49], v6 offset:30720
    ds_read_b64_tr_b16 v[50:51], v6 offset:31232
    v_mfma_f32_32x32x16_bf16 v[104:119], v[28:31], v[20:23], v[104:119]
    ds_read_b64_tr_b16 v[52:53], v6 offset:38912
    ds_read_b64_tr_b16 v[54:55], v6 offset:39424
    v_mfma_f32_32x32x16_bf16 v[120:135], v[32:35], v[16:19], v[120:135]
    v_add_u32 v5, s65, v5
    v_add_u32 v6, s65, v6
    v_mfma_f32_32x32x16_bf16 v[136:151], v[32:35], v[20:23], v[136:151]
    s_waitcnt lgkmcnt(0)
    v_mfma_f32_32x32x16_bf16 v[56:71], v[44:47], v[36:39], v[56:71]
    s_sub_u32 s6, s6, 1
    s_barrier
    ds_read_b64_tr_b16 v[24:25], v6 offset:16384
    ds_read_b64_tr_b16 v[26:27], v6 offset:16896
    v_mfma_f32_32x32x16_bf16 v[72:87], v[44:47], v[40:43], v[72:87]
    ds_read_b128 v[16:19], v2 offset:0
    ds_read_b128 v[20:23], v2 offset:4096
    v_mfma_f32_32x32x16_bf16 v[88:103], v[48:51], v[36:39], v[88:103]
    ds_read_b64_tr_b16 v[28:29], v6 offset:24576
    ds_read_b64_tr_b16 v[30:31], v6 offset:25088
    v_mfma_f32_32x32x16_bf16 v[104:119], v[48:51], v[40:43], v[104:119]
    ds_read_b64_tr_b16 v[32:33], v6 offset:32768
    ds_read_b64_tr_b16 v[34:35], v6 offset:33280
    v_mfma_f32_32x32x16_bf16 v[120:135], v[52:55], v[36:39], v[120:135]
    v_mfma_f32_32x32x16_bf16 v[136:151], v[52:55], v[40:43], v[136:151]
    s_cmp_lg_u32 s6, s97
    s_cbranch_scc1 L_k2_cl_16
    s_cmp_eq_u32 s6, 0
    s_cbranch_scc1 L_k2_cx_17
    v_mov_b32 v240, -1
    v_mov_b32 v241, -1
    v_mov_b32 v242, -1
    v_mov_b32 v243, -1
    buffer_store_dwordx4 v[240:243], v162, s[16:19], s72 offen sc1
    buffer_store_dwordx4 v[240:243], v162, s[16:19], s73 offen sc1
    s_mov_b32 s97, 0
    s_branch L_k2_cl_16
L_k2_cx_17:
    s_waitcnt lgkmcnt(0)
    s_waitcnt vmcnt(0)
    v_lshl_or_b32 v152, v165, 16, v164
    v_lshl_or_b32 v153, v167, 16, v166
    v_lshl_or_b32 v154, v169, 16, v168
    v_lshl_or_b32 v155, v171, 16, v170
    v_lshl_or_b32 v156, v173, 16, v172
    v_lshl_or_b32 v157, v175, 16, v174
    v_lshl_or_b32 v158, v177, 16, v176
    v_lshl_or_b32 v159, v179, 16, v178
    s_lshr_b32 s32, s2, 6
    s_lshl_b32 s32, s32, 2
    s_add_u32 s32, s32, s3
    s_lshl_b32 s32, s32, 6
    s_lshl_b32 s66, s32, 1
    s_add_u32 s24, s54, s66
    s_addc_u32 s25, s55, 0
    s_mov_b32 s26, 0x80
    s_mov_b32 s27, 0x00020000
    v_lshrrev_b32 v10, 3, v1
    v_lshlrev_b32 v11, 1, v10
    buffer_load_ushort v216, v11, s[24:27], 0 offen offset:0
    buffer_load_ushort v217, v11, s[24:27], 0 offen offset:16
    buffer_load_ushort v218, v11, s[24:27], 0 offen offset:32
    buffer_load_ushort v219, v11, s[24:27], 0 offen offset:48
    buffer_load_ushort v220, v11, s[24:27], 0 offen offset:64
    buffer_load_ushort v221, v11, s[24:27], 0 offen offset:80
    buffer_load_ushort v222, v11, s[24:27], 0 offen offset:96
    buffer_load_ushort v223, v11, s[24:27], 0 offen offset:112
    s_mul_i32 s32, s32, 12288
    s_and_b32 s66, s2, 63
    s_lshl_b32 s66, s66, 7
    s_add_u32 s32, s32, s66
    s_add_u32 s32, s32, 4096
    s_add_u32 s24, s56, s32
    s_addc_u32 s25, s57, 0
    s_mov_b32 s26, 0xbd080
    s_mov_b32 s27, 0x00020000
    v_mul_u32_u24 v10, 0x3000, v10
    v_and_b32 v11, 7, v1
    v_lshl_add_u32 v10, v11, 4, v10
    s_mov_b32 s32, 0
    buffer_load_dwordx4 v[184:187], v10, s[24:27], s32 offen nt
    s_mov_b32 s32, 98304
    buffer_load_dwordx4 v[188:191], v10, s[24:27], s32 offen nt
    s_mov_b32 s32, 196608
    buffer_load_dwordx4 v[192:195], v10, s[24:27], s32 offen nt
    s_mov_b32 s32, 294912
    buffer_load_dwordx4 v[196:199], v10, s[24:27], s32 offen nt
    s_mov_b32 s32, 393216
    buffer_load_dwordx4 v[200:203], v10, s[24:27], s32 offen nt
    s_mov_b32 s32, 491520
    buffer_load_dwordx4 v[204:207], v10, s[24:27], s32 offen nt
    s_mov_b32 s32, 589824
    buffer_load_dwordx4 v[208:211], v10, s[24:27], s32 offen nt
    s_mov_b32 s32, 688128
    buffer_load_dwordx4 v[212:215], v10, s[24:27], s32 offen nt
    s_mov_b32 s70, 0x3fb8aa3b
    s_mov_b32 s71, s70
    v_and_b32 v4, 31, v1
    v_add_u32 v4, s34, v4
    v_lshrrev_b32 v5, 5, v1
    v_lshlrev_b32 v5, 4, v5
    s_mul_i32 s32, s35, 24576
    s_lshl_b32 s33, s35, 13
    s_add_u32 s33, s33, 49152
    v_mul_u32_u24 v6, 192, v4
    v_add3_u32 v6, v6, v5, s32
    v_lshl_add_u32 v7, v4, 6, v5
    v_add_u32 v7, s33, v7
    v_cvt_pk_bf16_f32 v16, v56, v57
    v_cvt_pk_bf16_f32 v17, v58, v59
    v_cvt_pk_bf16_f32 v18, v60, v61
    v_cvt_pk_bf16_f32 v19, v62, v63
    v_cvt_pk_bf16_f32 v20, v64, v65
    v_cvt_pk_bf16_f32 v21, v66, v67
    v_cvt_pk_bf16_f32 v22, v68, v69
    v_cvt_pk_bf16_f32 v23, v70, v71
    v_cvt_pk_bf16_f32 v24, v72, v73
    v_cvt_pk_bf16_f32 v25, v74, v75
    v_cvt_pk_bf16_f32 v26, v76, v77
    v_cvt_pk_bf16_f32 v27, v78, v79
    v_cvt_pk_bf16_f32 v28, v80, v81
    v_cvt_pk_bf16_f32 v29, v82, v83
    v_cvt_pk_bf16_f32 v30, v84, v85
    v_cvt_pk_bf16_f32 v31, v86, v87
    v_cvt_pk_bf16_f32 v32, v88, v89
    v_cvt_pk_bf16_f32 v33, v90, v91
    v_cvt_pk_bf16_f32 v34, v92, v93
    v_cvt_pk_bf16_f32 v35, v94, v95
    v_cvt_pk_bf16_f32 v36, v96, v97
    v_cvt_pk_bf16_f32 v37, v98, v99
    v_cvt_pk_bf16_f32 v38, v100, v101
    v_cvt_pk_bf16_f32 v39, v102, v103
    v_cvt_pk_bf16_f32 v40, v104, v105
    v_cvt_pk_bf16_f32 v41, v106, v107
    v_cvt_pk_bf16_f32 v42, v108, v109
    v_cvt_pk_bf16_f32 v43, v110, v111
    v_cvt_pk_bf16_f32 v44, v112, v113
    v_cvt_pk_bf16_f32 v45, v114, v115
    v_cvt_pk_bf16_f32 v46, v116, v117
    v_cvt_pk_bf16_f32 v47, v118, v119
    v_mfma_f32_32x32x16_bf16 v[88:103], v[152:155], v[32:35], 0
    v_mfma_f32_32x32x16_bf16 v[88:103], v[156:159], v[36:39], v[88:103]
    v_mfma_f32_32x32x16_bf16 v[104:119], v[152:155], v[40:43], 0
    v_mfma_f32_32x32x16_bf16 v[104:119], v[156:159], v[44:47], v[104:119]
    v_mfma_f32_32x32x16_bf16 v[56:71], v[152:155], v[16:19], 0
    v_mfma_f32_32x32x16_bf16 v[56:71], v[156:159], v[20:23], v[56:71]
    v_mfma_f32_32x32x16_bf16 v[72:87], v[152:155], v[24:27], 0
    v_mfma_f32_32x32x16_bf16 v[72:87], v[156:159], v[28:31], v[72:87]
    v_cvt_pk_bf16_f32 v48, v120, v121
    v_cvt_pk_bf16_f32 v49, v122, v123
    v_cvt_pk_bf16_f32 v50, v124, v125
    v_cvt_pk_bf16_f32 v51, v126, v127
    v_cvt_pk_bf16_f32 v52, v128, v129
    v_cvt_pk_bf16_f32 v53, v130, v131
    v_cvt_pk_bf16_f32 v54, v132, v133
    v_cvt_pk_bf16_f32 v55, v134, v135
    ds_write_b128 v7, v[48:51] offset:0
    ds_write_b128 v7, v[52:55] offset:32
    s_nop 1
    v_cvt_pk_bf16_f32 v48, v136, v137
    v_cvt_pk_bf16_f32 v49, v138, v139
    v_cvt_pk_bf16_f32 v50, v140, v141
    v_cvt_pk_bf16_f32 v51, v142, v143
    v_cvt_pk_bf16_f32 v52, v144, v145
    v_cvt_pk_bf16_f32 v53, v146, v147
    v_cvt_pk_bf16_f32 v54, v148, v149
    v_cvt_pk_bf16_f32 v55, v150, v151
    ds_write_b128 v7, v[48:51] offset:2048
    ds_write_b128 v7, v[52:55] offset:2080
    v_max3_f32 v10, v88, v89, v90
    v_min3_f32 v12, v88, v89, v90
    v_max3_f32 v10, v10, v91, v92
    v_min3_f32 v12, v12, v91, v92
    v_max3_f32 v10, v10, v93, v94
    v_min3_f32 v12, v12, v93, v94
    v_max3_f32 v10, v10, v95, v96
    v_min3_f32 v12, v12, v95, v96
    v_max3_f32 v10, v10, v97, v98
    v_min3_f32 v12, v12, v97, v98
    v_max3_f32 v10, v10, v99, v100
    v_min3_f32 v12, v12, v99, v100
    v_max3_f32 v10, v10, v101, v102
    v_min3_f32 v12, v12, v101, v102
    v_max_f32 v10, v10, v103
    v_min_f32 v12, v12, v103
    v_mov_b32 v11, v10
    v_mov_b32 v13, v12
    s_nop 1
    v_permlane32_swap_b32 v10, v11
    v_permlane32_swap_b32 v12, v13
    v_max_f32 v10, v10, v11
    v_min_f32 v12, v12, v13
    v_mul_f32 v10, s70, v10
    v_mul_f32 v12, s70, v12
    v_pk_fma_f32 v[120:121], v[88:89], s[70:71], v[12:13] op_sel_hi:[1,1,0] neg_lo:[0,1,0] neg_hi:[0,1,0]
    v_pk_fma_f32 v[88:89], v[88:89], s[70:71], v[10:11] op_sel_hi:[1,1,0] neg_lo:[0,0,1] neg_hi:[0,0,1]
    v_pk_fma_f32 v[122:123], v[90:91], s[70:71], v[12:13] op_sel_hi:[1,1,0] neg_lo:[0,1,0] neg_hi:[0,1,0]
    v_pk_fma_f32 v[90:91], v[90:91], s[70:71], v[10:11] op_sel_hi:[1,1,0] neg_lo:[0,0,1] neg_hi:[0,0,1]
    v_pk_fma_f32 v[124:125], v[92:93], s[70:71], v[12:13] op_sel_hi:[1,1,0] neg_lo:[0,1,0] neg_hi:[0,1,0]
    v_pk_fma_f32 v[92:93], v[92:93], s[70:71], v[10:11] op_sel_hi:[1,1,0] neg_lo:[0,0,1] neg_hi:[0,0,1]
    v_pk_fma_f32 v[126:127], v[94:95], s[70:71], v[12:13] op_sel_hi:[1,1,0] neg_lo:[0,1,0] neg_hi:[0,1,0]
    v_pk_fma_f32 v[94:95], v[94:95], s[70:71], v[10:11] op_sel_hi:[1,1,0] neg_lo:[0,0,1] neg_hi:[0,0,1]
    v_pk_fma_f32 v[128:129], v[96:97], s[70:71], v[12:13] op_sel_hi:[1,1,0] neg_lo:[0,1,0] neg_hi:[0,1,0]
    v_pk_fma_f32 v[96:97], v[96:97], s[70:71], v[10:11] op_sel_hi:[1,1,0] neg_lo:[0,0,1] neg_hi:[0,0,1]
    v_pk_fma_f32 v[130:131], v[98:99], s[70:71], v[12:13] op_sel_hi:[1,1,0] neg_lo:[0,1,0] neg_hi:[0,1,0]
    v_pk_fma_f32 v[98:99], v[98:99], s[70:71], v[10:11] op_sel_hi:[1,1,0] neg_lo:[0,0,1] neg_hi:[0,0,1]
    v_pk_fma_f32 v[132:133], v[100:101], s[70:71], v[12:13] op_sel_hi:[1,1,0] neg_lo:[0,1,0] neg_hi:[0,1,0]
    v_pk_fma_f32 v[100:101], v[100:101], s[70:71], v[10:11] op_sel_hi:[1,1,0] neg_lo:[0,0,1] neg_hi:[0,0,1]
    v_pk_fma_f32 v[134:135], v[102:103], s[70:71], v[12:13] op_sel_hi:[1,1,0] neg_lo:[0,1,0] neg_hi:[0,1,0]
    v_pk_fma_f32 v[102:103], v[102:103], s[70:71], v[10:11] op_sel_hi:[1,1,0] neg_lo:[0,0,1] neg_hi:[0,0,1]
    v_exp_f32 v88, v88
    v_exp_f32 v120, v120
    v_exp_f32 v89, v89
    v_exp_f32 v121, v121
    v_exp_f32 v90, v90
    v_exp_f32 v122, v122
    v_exp_f32 v91, v91
    v_exp_f32 v123, v123
    v_exp_f32 v92, v92
    v_exp_f32 v124, v124
    v_exp_f32 v93, v93
    v_exp_f32 v125, v125
    v_exp_f32 v94, v94
    v_exp_f32 v126, v126
    v_exp_f32 v95, v95
    v_exp_f32 v127, v127
    v_exp_f32 v96, v96
    v_exp_f32 v128, v128
    v_exp_f32 v97, v97
    v_exp_f32 v129, v129
    v_exp_f32 v98, v98
    v_exp_f32 v130, v130
    v_exp_f32 v99, v99
    v_exp_f32 v131, v131
    v_exp_f32 v100, v100
    v_exp_f32 v132, v132
    v_exp_f32 v101, v101
    v_exp_f32 v133, v133
    v_exp_f32 v102, v102
    v_exp_f32 v134, v134
    v_exp_f32 v103, v103
    v_exp_f32 v135, v135
    v_pk_add_f32 v[10:11], v[88:89], v[90:91]
    v_pk_add_f32 v[12:13], v[120:121], v[122:123]
    v_pk_add_f32 v[10:11], v[10:11], v[92:93]
    v_pk_add_f32 v[12:13], v[12:13], v[124:125]
    v_pk_add_f32 v[10:11], v[10:11], v[94:95]
    v_pk_add_f32 v[12:13], v[12:13], v[126:127]
    v_pk_add_f32 v[10:11], v[10:11], v[96:97]
    v_pk_add_f32 v[12:13], v[12:13], v[128:129]
    v_pk_add_f32 v[10:11], v[10:11], v[98:99]
    v_pk_add_f32 v[12:13], v[12:13], v[130:131]
    v_pk_add_f32 v[10:11], v[10:11], v[100:101]
    v_pk_add_f32 v[12:13], v[12:13], v[132:133]
    v_pk_add_f32 v[10:11], v[10:11], v[102:103]
    v_pk_add_f32 v[12:13], v[12:13], v[134:135]
    v_add_f32 v10, v10, v11
    v_add_f32 v12, v12, v13
    v_mov_b32 v11, v10
    v_mov_b32 v13, v12
    s_nop 1
    v_permlane32_swap_b32 v10, v11
    v_permlane32_swap_b32 v12, v13
    v_add_f32 v10, v10, v11
    v_add_f32 v12, v12, v13
    v_rcp_f32 v10, v10
    v_rcp_f32 v12, v12
    s_nop 0
    v_pk_mul_f32 v[88:89], v[88:89], v[10:11] op_sel_hi:[1,0]
    v_pk_mul_f32 v[120:121], v[120:121], v[12:13] op_sel_hi:[1,0]
    v_pk_mul_f32 v[90:91], v[90:91], v[10:11] op_sel_hi:[1,0]
    v_pk_mul_f32 v[122:123], v[122:123], v[12:13] op_sel_hi:[1,0]
    v_pk_mul_f32 v[92:93], v[92:93], v[10:11] op_sel_hi:[1,0]
    v_pk_mul_f32 v[124:125], v[124:125], v[12:13] op_sel_hi:[1,0]
    v_pk_mul_f32 v[94:95], v[94:95], v[10:11] op_sel_hi:[1,0]
    v_pk_mul_f32 v[126:127], v[126:127], v[12:13] op_sel_hi:[1,0]
    v_pk_mul_f32 v[96:97], v[96:97], v[10:11] op_sel_hi:[1,0]
    v_pk_mul_f32 v[128:129], v[128:129], v[12:13] op_sel_hi:[1,0]
    v_pk_mul_f32 v[98:99], v[98:99], v[10:11] op_sel_hi:[1,0]
    v_pk_mul_f32 v[130:131], v[130:131], v[12:13] op_sel_hi:[1,0]
    v_pk_mul_f32 v[100:101], v[100:101], v[10:11] op_sel_hi:[1,0]
    v_pk_mul_f32 v[132:133], v[132:133], v[12:13] op_sel_hi:[1,0]
    v_pk_mul_f32 v[102:103], v[102:103], v[10:11] op_sel_hi:[1,0]
    v_pk_mul_f32 v[134:135], v[134:135], v[12:13] op_sel_hi:[1,0]
    v_cvt_pk_bf16_f32 v32, v88, v89
    v_cvt_pk_bf16_f32 v33, v90, v91
    v_cvt_pk_bf16_f32 v34, v92, v93
    v_cvt_pk_bf16_f32 v35, v94, v95
    v_cvt_pk_bf16_f32 v36, v96, v97
    v_cvt_pk_bf16_f32 v37, v98, v99
    v_cvt_pk_bf16_f32 v38, v100, v101
    v_cvt_pk_bf16_f32 v39, v102, v103
    v_cvt_pk_bf16_f32 v88, v120, v121
    v_cvt_pk_bf16_f32 v89, v122, v123
    v_cvt_pk_bf16_f32 v90, v124, v125
    v_cvt_pk_bf16_f32 v91, v126, v127
    v_cvt_pk_bf16_f32 v92, v128, v129
    v_cvt_pk_bf16_f32 v93, v130, v131
    v_cvt_pk_bf16_f32 v94, v132, v133
    v_cvt_pk_bf16_f32 v95, v134, v135
    ds_write_b128 v6, v[32:35] offset:0
    ds_write_b128 v6, v[36:39] offset:32
    ds_write_b128 v6, v[88:91] offset:64
    ds_write_b128 v6, v[92:95] offset:96
    v_max3_f32 v10, v104, v105, v106
    v_min3_f32 v12, v104, v105, v106
    v_max3_f32 v10, v10, v107, v108
    v_min3_f32 v12, v12, v107, v108
    v_max3_f32 v10, v10, v109, v110
    v_min3_f32 v12, v12, v109, v110
    v_max3_f32 v10, v10, v111, v112
    v_min3_f32 v12, v12, v111, v112
    v_max3_f32 v10, v10, v113, v114
    v_min3_f32 v12, v12, v113, v114
    v_max3_f32 v10, v10, v115, v116
    v_min3_f32 v12, v12, v115, v116
    v_max3_f32 v10, v10, v117, v118
    v_min3_f32 v12, v12, v117, v118
    v_max_f32 v10, v10, v119
    v_min_f32 v12, v12, v119
    v_mov_b32 v11, v10
    v_mov_b32 v13, v12
    s_nop 1
    v_permlane32_swap_b32 v10, v11
    v_permlane32_swap_b32 v12, v13
    v_max_f32 v10, v10, v11
    v_min_f32 v12, v12, v13
    v_mul_f32 v10, s70, v10
    v_mul_f32 v12, s70, v12
    v_pk_fma_f32 v[120:121], v[104:105], s[70:71], v[12:13] op_sel_hi:[1,1,0] neg_lo:[0,1,0] neg_hi:[0,1,0]
    v_pk_fma_f32 v[104:105], v[104:105], s[70:71], v[10:11] op_sel_hi:[1,1,0] neg_lo:[0,0,1] neg_hi:[0,0,1]
    v_pk_fma_f32 v[122:123], v[106:107], s[70:71], v[12:13] op_sel_hi:[1,1,0] neg_lo:[0,1,0] neg_hi:[0,1,0]
    v_pk_fma_f32 v[106:107], v[106:107], s[70:71], v[10:11] op_sel_hi:[1,1,0] neg_lo:[0,0,1] neg_hi:[0,0,1]
    v_pk_fma_f32 v[124:125], v[108:109], s[70:71], v[12:13] op_sel_hi:[1,1,0] neg_lo:[0,1,0] neg_hi:[0,1,0]
    v_pk_fma_f32 v[108:109], v[108:109], s[70:71], v[10:11] op_sel_hi:[1,1,0] neg_lo:[0,0,1] neg_hi:[0,0,1]
    v_pk_fma_f32 v[126:127], v[110:111], s[70:71], v[12:13] op_sel_hi:[1,1,0] neg_lo:[0,1,0] neg_hi:[0,1,0]
    v_pk_fma_f32 v[110:111], v[110:111], s[70:71], v[10:11] op_sel_hi:[1,1,0] neg_lo:[0,0,1] neg_hi:[0,0,1]
    v_pk_fma_f32 v[128:129], v[112:113], s[70:71], v[12:13] op_sel_hi:[1,1,0] neg_lo:[0,1,0] neg_hi:[0,1,0]
    v_pk_fma_f32 v[112:113], v[112:113], s[70:71], v[10:11] op_sel_hi:[1,1,0] neg_lo:[0,0,1] neg_hi:[0,0,1]
    v_pk_fma_f32 v[130:131], v[114:115], s[70:71], v[12:13] op_sel_hi:[1,1,0] neg_lo:[0,1,0] neg_hi:[0,1,0]
    v_pk_fma_f32 v[114:115], v[114:115], s[70:71], v[10:11] op_sel_hi:[1,1,0] neg_lo:[0,0,1] neg_hi:[0,0,1]
    v_pk_fma_f32 v[132:133], v[116:117], s[70:71], v[12:13] op_sel_hi:[1,1,0] neg_lo:[0,1,0] neg_hi:[0,1,0]
    v_pk_fma_f32 v[116:117], v[116:117], s[70:71], v[10:11] op_sel_hi:[1,1,0] neg_lo:[0,0,1] neg_hi:[0,0,1]
    v_pk_fma_f32 v[134:135], v[118:119], s[70:71], v[12:13] op_sel_hi:[1,1,0] neg_lo:[0,1,0] neg_hi:[0,1,0]
    v_pk_fma_f32 v[118:119], v[118:119], s[70:71], v[10:11] op_sel_hi:[1,1,0] neg_lo:[0,0,1] neg_hi:[0,0,1]
    v_exp_f32 v104, v104
    v_exp_f32 v120, v120
    v_exp_f32 v105, v105
    v_exp_f32 v121, v121
    v_exp_f32 v106, v106
    v_exp_f32 v122, v122
    v_exp_f32 v107, v107
    v_exp_f32 v123, v123
    v_exp_f32 v108, v108
    v_exp_f32 v124, v124
    v_exp_f32 v109, v109
    v_exp_f32 v125, v125
    v_exp_f32 v110, v110
    v_exp_f32 v126, v126
    v_exp_f32 v111, v111
    v_exp_f32 v127, v127
    v_exp_f32 v112, v112
    v_exp_f32 v128, v128
    v_exp_f32 v113, v113
    v_exp_f32 v129, v129
    v_exp_f32 v114, v114
    v_exp_f32 v130, v130
    v_exp_f32 v115, v115
    v_exp_f32 v131, v131
    v_exp_f32 v116, v116
    v_exp_f32 v132, v132
    v_exp_f32 v117, v117
    v_exp_f32 v133, v133
    v_exp_f32 v118, v118
    v_exp_f32 v134, v134
    v_exp_f32 v119, v119
    v_exp_f32 v135, v135
    v_pk_add_f32 v[10:11], v[104:105], v[106:107]
    v_pk_add_f32 v[12:13], v[120:121], v[122:123]
    v_pk_add_f32 v[10:11], v[10:11], v[108:109]
    v_pk_add_f32 v[12:13], v[12:13], v[124:125]
    v_pk_add_f32 v[10:11], v[10:11], v[110:111]
    v_pk_add_f32 v[12:13], v[12:13], v[126:127]
    v_pk_add_f32 v[10:11], v[10:11], v[112:113]
    v_pk_add_f32 v[12:13], v[12:13], v[128:129]
    v_pk_add_f32 v[10:11], v[10:11], v[114:115]
    v_pk_add_f32 v[12:13], v[12:13], v[130:131]
    v_pk_add_f32 v[10:11], v[10:11], v[116:117]
    v_pk_add_f32 v[12:13], v[12:13], v[132:133]
    v_pk_add_f32 v[10:11], v[10:11], v[118:119]
    v_pk_add_f32 v[12:13], v[12:13], v[134:135]
    v_add_f32 v10, v10, v11
    v_add_f32 v12, v12, v13
    v_mov_b32 v11, v10
    v_mov_b32 v13, v12
    s_nop 1
    v_permlane32_swap_b32 v10, v11
    v_permlane32_swap_b32 v12, v13
    v_add_f32 v10, v10, v11
    v_add_f32 v12, v12, v13
    v_rcp_f32 v10, v10
    v_rcp_f32 v12, v12
    s_nop 0
    v_pk_mul_f32 v[104:105], v[104:105], v[10:11] op_sel_hi:[1,0]
    v_pk_mul_f32 v[120:121], v[120:121], v[12:13] op_sel_hi:[1,0]
    v_pk_mul_f32 v[106:107], v[106:107], v[10:11] op_sel_hi:[1,0]
    v_pk_mul_f32 v[122:123], v[122:123], v[12:13] op_sel_hi:[1,0]
    v_pk_mul_f32 v[108:109], v[108:109], v[10:11] op_sel_hi:[1,0]
    v_pk_mul_f32 v[124:125], v[124:125], v[12:13] op_sel_hi:[1,0]
    v_pk_mul_f32 v[110:111], v[110:111], v[10:11] op_sel_hi:[1,0]
    v_pk_mul_f32 v[126:127], v[126:127], v[12:13] op_sel_hi:[1,0]
    v_pk_mul_f32 v[112:113], v[112:113], v[10:11] op_sel_hi:[1,0]
    v_pk_mul_f32 v[128:129], v[128:129], v[12:13] op_sel_hi:[1,0]
    v_pk_mul_f32 v[114:115], v[114:115], v[10:11] op_sel_hi:[1,0]
    v_pk_mul_f32 v[130:131], v[130:131], v[12:13] op_sel_hi:[1,0]
    v_pk_mul_f32 v[116:117], v[116:117], v[10:11] op_sel_hi:[1,0]
    v_pk_mul_f32 v[132:133], v[132:133], v[12:13] op_sel_hi:[1,0]
    v_pk_mul_f32 v[118:119], v[118:119], v[10:11] op_sel_hi:[1,0]
    v_pk_mul_f32 v[134:135], v[134:135], v[12:13] op_sel_hi:[1,0]
    v_cvt_pk_bf16_f32 v40, v104, v105
    v_cvt_pk_bf16_f32 v41, v106, v107
    v_cvt_pk_bf16_f32 v42, v108, v109
    v_cvt_pk_bf16_f32 v43, v110, v111
    v_cvt_pk_bf16_f32 v44, v112, v113
    v_cvt_pk_bf16_f32 v45, v114, v115
    v_cvt_pk_bf16_f32 v46, v116, v117
    v_cvt_pk_bf16_f32 v47, v118, v119
    v_cvt_pk_bf16_f32 v104, v120, v121
    v_cvt_pk_bf16_f32 v105, v122, v123
    v_cvt_pk_bf16_f32 v106, v124, v125
    v_cvt_pk_bf16_f32 v107, v126, v127
    v_cvt_pk_bf16_f32 v108, v128, v129
    v_cvt_pk_bf16_f32 v109, v130, v131
    v_cvt_pk_bf16_f32 v110, v132, v133
    v_cvt_pk_bf16_f32 v111, v134, v135
    ds_write_b128 v6, v[40:43] offset:6144
    ds_write_b128 v6, v[44:47] offset:6176
    ds_write_b128 v6, v[104:107] offset:6208
    ds_write_b128 v6, v[108:111] offset:6240
    s_waitcnt lgkmcnt(0)
    s_barrier
    ds_read_b64_tr_b16 v[120:121], v161 offset:0
    ds_read_b64_tr_b16 v[124:125], v160 offset:0
    ds_read_b64_tr_b16 v[122:123], v161 offset:768
    ds_read_b64_tr_b16 v[126:127], v160 offset:256
    ds_read_b64_tr_b16 v[128:129], v161 offset:3072
    ds_read_b64_tr_b16 v[132:133], v160 offset:1024
    ds_read_b64_tr_b16 v[130:131], v161 offset:3840
    ds_read_b64_tr_b16 v[134:135], v160 offset:1280
    ds_read_b64_tr_b16 v[136:137], v161 offset:6144
    ds_read_b64_tr_b16 v[140:141], v160 offset:2048
    ds_read_b64_tr_b16 v[138:139], v161 offset:6912
    ds_read_b64_tr_b16 v[142:143], v160 offset:2304
    ds_read_b64_tr_b16 v[144:145], v161 offset:9216
    ds_read_b64_tr_b16 v[148:149], v160 offset:3072
    ds_read_b64_tr_b16 v[146:147], v161 offset:9984
    ds_read_b64_tr_b16 v[150:151], v160 offset:3328
    v_mov_b32 v164, 0x3f803f80
    v_mov_b32 v165, 0x3f803f80
    v_mov_b32 v166, 0x3f803f80
    v_mov_b32 v167, 0x3f803f80
    s_waitcnt lgkmcnt(12)
    v_mfma_f32_32x32x16_bf16 v[88:103], v[120:123], v[124:127], 0
    v_mfma_f32_32x32x16_bf16 v[104:119], v[164:167], v[120:123], 0
    s_waitcnt lgkmcnt(8)
    v_mfma_f32_32x32x16_bf16 v[88:103], v[128:131], v[132:135], v[88:103]
    v_mfma_f32_32x32x16_bf16 v[104:119], v[164:167], v[128:131], v[104:119]
    s_waitcnt lgkmcnt(4)
    v_mfma_f32_32x32x16_bf16 v[88:103], v[136:139], v[140:143], v[88:103]
    v_mfma_f32_32x32x16_bf16 v[104:119], v[164:167], v[136:139], v[104:119]
    s_waitcnt lgkmcnt(0)
    v_mfma_f32_32x32x16_bf16 v[88:103], v[144:147], v[148:151], v[88:103]
    v_mfma_f32_32x32x16_bf16 v[104:119], v[164:167], v[144:147], v[104:119]
    ds_read_b64_tr_b16 v[120:121], v161 offset:12288
    ds_read_b64_tr_b16 v[124:125], v160 offset:4096
    ds_read_b64_tr_b16 v[122:123], v161 offset:13056
    ds_read_b64_tr_b16 v[126:127], v160 offset:4352
    ds_read_b64_tr_b16 v[128:129], v161 offset:15360
    ds_read_b64_tr_b16 v[132:133], v160 offset:5120
    ds_read_b64_tr_b16 v[130:131], v161 offset:16128
    ds_read_b64_tr_b16 v[134:135], v160 offset:5376
    ds_read_b64_tr_b16 v[136:137], v161 offset:18432
    ds_read_b64_tr_b16 v[140:141], v160 offset:6144
    ds_read_b64_tr_b16 v[138:139], v161 offset:19200
    ds_read_b64_tr_b16 v[142:143], v160 offset:6400
    ds_read_b64_tr_b16 v[144:145], v161 offset:21504
    ds_read_b64_tr_b16 v[148:149], v160 offset:7168
    ds_read_b64_tr_b16 v[146:147], v161 offset:22272
    ds_read_b64_tr_b16 v[150:151], v160 offset:7424
    s_waitcnt lgkmcnt(12)
    v_mfma_f32_32x32x16_bf16 v[88:103], v[120:123], v[124:127], v[88:103]
    v_mfma_f32_32x32x16_bf16 v[104:119], v[164:167], v[120:123], v[104:119]
    s_waitcnt lgkmcnt(8)
    v_mfma_f32_32x32x16_bf16 v[88:103], v[128:131], v[132:135], v[88:103]
    v_mfma_f32_32x32x16_bf16 v[104:119], v[164:167], v[128:131], v[104:119]
    s_waitcnt lgkmcnt(4)
    v_mfma_f32_32x32x16_bf16 v[88:103], v[136:139], v[140:143], v[88:103]
    v_mfma_f32_32x32x16_bf16 v[104:119], v[164:167], v[136:139], v[104:119]
    s_waitcnt lgkmcnt(0)
    v_mfma_f32_32x32x16_bf16 v[88:103], v[144:147], v[148:151], v[88:103]
    v_mfma_f32_32x32x16_bf16 v[104:119], v[164:167], v[144:147], v[104:119]
    s_mov_b64 exec, s[98:99]
    buffer_store_dword v14, v14, s[20:23], s96 offen sc1
    s_mov_b64 exec, -1
    s_nop 10
    v_cvt_pk_bf16_f32 v120, v88, v89
    v_cvt_pk_bf16_f32 v121, v90, v91
    v_cvt_pk_bf16_f32 v122, v92, v93
    v_cvt_pk_bf16_f32 v123, v94, v95
    buffer_store_dwordx4 v[120:123], v162, s[16:19], s72 offen sc1
    v_cvt_pk_bf16_f32 v124, v96, v97
    v_cvt_pk_bf16_f32 v125, v98, v99
    v_cvt_pk_bf16_f32 v126, v100, v101
    v_cvt_pk_bf16_f32 v127, v102, v103
    buffer_store_dwordx4 v[124:127], v162, s[16:19], s73 offen sc1
    s_mov_b32 exec_hi, 0
    buffer_store_dword v104, v163, s[20:23], s74 offen sc1
    s_mov_b64 exec, -1
    v_max3_f32 v10, v56, v57, v58
    v_min3_f32 v12, v56, v57, v58
    v_max3_f32 v10, v10, v59, v60
    v_min3_f32 v12, v12, v59, v60
    v_max3_f32 v10, v10, v61, v62
    v_min3_f32 v12, v12, v61, v62
    v_max3_f32 v10, v10, v63, v64
    v_min3_f32 v12, v12, v63, v64
    v_max3_f32 v10, v10, v65, v66
    v_min3_f32 v12, v12, v65, v66
    v_max3_f32 v10, v10, v67, v68
    v_min3_f32 v12, v12, v67, v68
    v_max3_f32 v10, v10, v69, v70
    v_min3_f32 v12, v12, v69, v70
    v_max_f32 v10, v10, v71
    v_min_f32 v12, v12, v71
    v_mov_b32 v11, v10
    v_mov_b32 v13, v12
    s_nop 1
    v_permlane32_swap_b32 v10, v11
    v_permlane32_swap_b32 v12, v13
    v_max_f32 v10, v10, v11
    v_min_f32 v12, v12, v13
    v_mul_f32 v10, s70, v10
    v_mul_f32 v12, s70, v12
    v_pk_fma_f32 v[120:121], v[56:57], s[70:71], v[12:13] op_sel_hi:[1,1,0] neg_lo:[0,1,0] neg_hi:[0,1,0]
    v_pk_fma_f32 v[56:57], v[56:57], s[70:71], v[10:11] op_sel_hi:[1,1,0] neg_lo:[0,0,1] neg_hi:[0,0,1]
    v_pk_fma_f32 v[122:123], v[58:59], s[70:71], v[12:13] op_sel_hi:[1,1,0] neg_lo:[0,1,0] neg_hi:[0,1,0]
    v_pk_fma_f32 v[58:59], v[58:59], s[70:71], v[10:11] op_sel_hi:[1,1,0] neg_lo:[0,0,1] neg_hi:[0,0,1]
    v_pk_fma_f32 v[124:125], v[60:61], s[70:71], v[12:13] op_sel_hi:[1,1,0] neg_lo:[0,1,0] neg_hi:[0,1,0]
    v_pk_fma_f32 v[60:61], v[60:61], s[70:71], v[10:11] op_sel_hi:[1,1,0] neg_lo:[0,0,1] neg_hi:[0,0,1]
    v_pk_fma_f32 v[126:127], v[62:63], s[70:71], v[12:13] op_sel_hi:[1,1,0] neg_lo:[0,1,0] neg_hi:[0,1,0]
    v_pk_fma_f32 v[62:63], v[62:63], s[70:71], v[10:11] op_sel_hi:[1,1,0] neg_lo:[0,0,1] neg_hi:[0,0,1]
    v_pk_fma_f32 v[128:129], v[64:65], s[70:71], v[12:13] op_sel_hi:[1,1,0] neg_lo:[0,1,0] neg_hi:[0,1,0]
    v_pk_fma_f32 v[64:65], v[64:65], s[70:71], v[10:11] op_sel_hi:[1,1,0] neg_lo:[0,0,1] neg_hi:[0,0,1]
    v_pk_fma_f32 v[130:131], v[66:67], s[70:71], v[12:13] op_sel_hi:[1,1,0] neg_lo:[0,1,0] neg_hi:[0,1,0]
    v_pk_fma_f32 v[66:67], v[66:67], s[70:71], v[10:11] op_sel_hi:[1,1,0] neg_lo:[0,0,1] neg_hi:[0,0,1]
    v_pk_fma_f32 v[132:133], v[68:69], s[70:71], v[12:13] op_sel_hi:[1,1,0] neg_lo:[0,1,0] neg_hi:[0,1,0]
    v_pk_fma_f32 v[68:69], v[68:69], s[70:71], v[10:11] op_sel_hi:[1,1,0] neg_lo:[0,0,1] neg_hi:[0,0,1]
    v_pk_fma_f32 v[134:135], v[70:71], s[70:71], v[12:13] op_sel_hi:[1,1,0] neg_lo:[0,1,0] neg_hi:[0,1,0]
    v_pk_fma_f32 v[70:71], v[70:71], s[70:71], v[10:11] op_sel_hi:[1,1,0] neg_lo:[0,0,1] neg_hi:[0,0,1]
    v_exp_f32 v56, v56
    v_exp_f32 v120, v120
    v_exp_f32 v57, v57
    v_exp_f32 v121, v121
    v_exp_f32 v58, v58
    v_exp_f32 v122, v122
    v_exp_f32 v59, v59
    v_exp_f32 v123, v123
    v_exp_f32 v60, v60
    v_exp_f32 v124, v124
    v_exp_f32 v61, v61
    v_exp_f32 v125, v125
    v_exp_f32 v62, v62
    v_exp_f32 v126, v126
    v_exp_f32 v63, v63
    v_exp_f32 v127, v127
    v_exp_f32 v64, v64
    v_exp_f32 v128, v128
    v_exp_f32 v65, v65
    v_exp_f32 v129, v129
    v_exp_f32 v66, v66
    v_exp_f32 v130, v130
    v_exp_f32 v67, v67
    v_exp_f32 v131, v131
    v_exp_f32 v68, v68
    v_exp_f32 v132, v132
    v_exp_f32 v69, v69
    v_exp_f32 v133, v133
    v_exp_f32 v70, v70
    v_exp_f32 v134, v134
    v_exp_f32 v71, v71
    v_exp_f32 v135, v135
    v_pk_add_f32 v[10:11], v[56:57], v[58:59]
    v_pk_add_f32 v[12:13], v[120:121], v[122:123]
    v_pk_add_f32 v[10:11], v[10:11], v[60:61]
    v_pk_add_f32 v[12:13], v[12:13], v[124:125]
    v_pk_add_f32 v[10:11], v[10:11], v[62:63]
    v_pk_add_f32 v[12:13], v[12:13], v[126:127]
    v_pk_add_f32 v[10:11], v[10:11], v[64:65]
    v_pk_add_f32 v[12:13], v[12:13], v[128:129]
    v_pk_add_f32 v[10:11], v[10:11], v[66:67]
    v_pk_add_f32 v[12:13], v[12:13], v[130:131]
    v_pk_add_f32 v[10:11], v[10:11], v[68:69]
    v_pk_add_f32 v[12:13], v[12:13], v[132:133]
    v_pk_add_f32 v[10:11], v[10:11], v[70:71]
    v_pk_add_f32 v[12:13], v[12:13], v[134:135]
    v_add_f32 v10, v10, v11
    v_add_f32 v12, v12, v13
    v_mov_b32 v11, v10
    v_mov_b32 v13, v12
    s_nop 1
    v_permlane32_swap_b32 v10, v11
    v_permlane32_swap_b32 v12, v13
    v_add_f32 v10, v10, v11
    v_add_f32 v12, v12, v13
    v_rcp_f32 v10, v10
    v_rcp_f32 v12, v12
    s_nop 0
    v_pk_mul_f32 v[56:57], v[56:57], v[10:11] op_sel_hi:[1,0]
    v_pk_mul_f32 v[120:121], v[120:121], v[12:13] op_sel_hi:[1,0]
    v_pk_mul_f32 v[58:59], v[58:59], v[10:11] op_sel_hi:[1,0]
    v_pk_mul_f32 v[122:123], v[122:123], v[12:13] op_sel_hi:[1,0]
    v_pk_mul_f32 v[60:61], v[60:61], v[10:11] op_sel_hi:[1,0]
    v_pk_mul_f32 v[124:125], v[124:125], v[12:13] op_sel_hi:[1,0]
    v_pk_mul_f32 v[62:63], v[62:63], v[10:11] op_sel_hi:[1,0]
    v_pk_mul_f32 v[126:127], v[126:127], v[12:13] op_sel_hi:[1,0]
    v_pk_mul_f32 v[64:65], v[64:65], v[10:11] op_sel_hi:[1,0]
    v_pk_mul_f32 v[128:129], v[128:129], v[12:13] op_sel_hi:[1,0]
    v_pk_mul_f32 v[66:67], v[66:67], v[10:11] op_sel_hi:[1,0]
    v_pk_mul_f32 v[130:131], v[130:131], v[12:13] op_sel_hi:[1,0]
    v_pk_mul_f32 v[68:69], v[68:69], v[10:11] op_sel_hi:[1,0]
    v_pk_mul_f32 v[132:133], v[132:133], v[12:13] op_sel_hi:[1,0]
    v_pk_mul_f32 v[70:71], v[70:71], v[10:11] op_sel_hi:[1,0]
    v_pk_mul_f32 v[134:135], v[134:135], v[12:13] op_sel_hi:[1,0]
    v_cvt_pk_bf16_f32 v16, v56, v57
    v_cvt_pk_bf16_f32 v17, v58, v59
    v_cvt_pk_bf16_f32 v18, v60, v61
    v_cvt_pk_bf16_f32 v19, v62, v63
    v_cvt_pk_bf16_f32 v20, v64, v65
    v_cvt_pk_bf16_f32 v21, v66, v67
    v_cvt_pk_bf16_f32 v22, v68, v69
    v_cvt_pk_bf16_f32 v23, v70, v71
    v_cvt_pk_bf16_f32 v56, v120, v121
    v_cvt_pk_bf16_f32 v57, v122, v123
    v_cvt_pk_bf16_f32 v58, v124, v125
    v_cvt_pk_bf16_f32 v59, v126, v127
    v_cvt_pk_bf16_f32 v60, v128, v129
    v_cvt_pk_bf16_f32 v61, v130, v131
    v_cvt_pk_bf16_f32 v62, v132, v133
    v_cvt_pk_bf16_f32 v63, v134, v135
    v_max3_f32 v10, v72, v73, v74
    v_min3_f32 v12, v72, v73, v74
    v_max3_f32 v10, v10, v75, v76
    v_min3_f32 v12, v12, v75, v76
    v_max3_f32 v10, v10, v77, v78
    v_min3_f32 v12, v12, v77, v78
    v_max3_f32 v10, v10, v79, v80
    v_min3_f32 v12, v12, v79, v80
    v_max3_f32 v10, v10, v81, v82
    v_min3_f32 v12, v12, v81, v82
    v_max3_f32 v10, v10, v83, v84
    v_min3_f32 v12, v12, v83, v84
    v_max3_f32 v10, v10, v85, v86
    v_min3_f32 v12, v12, v85, v86
    v_max_f32 v10, v10, v87
    v_min_f32 v12, v12, v87
    v_mov_b32 v11, v10
    v_mov_b32 v13, v12
    s_nop 1
    v_permlane32_swap_b32 v10, v11
    v_permlane32_swap_b32 v12, v13
    v_max_f32 v10, v10, v11
    v_min_f32 v12, v12, v13
    v_mul_f32 v10, s70, v10
    v_mul_f32 v12, s70, v12
    v_pk_fma_f32 v[120:121], v[72:73], s[70:71], v[12:13] op_sel_hi:[1,1,0] neg_lo:[0,1,0] neg_hi:[0,1,0]
    v_pk_fma_f32 v[72:73], v[72:73], s[70:71], v[10:11] op_sel_hi:[1,1,0] neg_lo:[0,0,1] neg_hi:[0,0,1]
    v_pk_fma_f32 v[122:123], v[74:75], s[70:71], v[12:13] op_sel_hi:[1,1,0] neg_lo:[0,1,0] neg_hi:[0,1,0]
    v_pk_fma_f32 v[74:75], v[74:75], s[70:71], v[10:11] op_sel_hi:[1,1,0] neg_lo:[0,0,1] neg_hi:[0,0,1]
    v_pk_fma_f32 v[124:125], v[76:77], s[70:71], v[12:13] op_sel_hi:[1,1,0] neg_lo:[0,1,0] neg_hi:[0,1,0]
    v_pk_fma_f32 v[76:77], v[76:77], s[70:71], v[10:11] op_sel_hi:[1,1,0] neg_lo:[0,0,1] neg_hi:[0,0,1]
    v_pk_fma_f32 v[126:127], v[78:79], s[70:71], v[12:13] op_sel_hi:[1,1,0] neg_lo:[0,1,0] neg_hi:[0,1,0]
    v_pk_fma_f32 v[78:79], v[78:79], s[70:71], v[10:11] op_sel_hi:[1,1,0] neg_lo:[0,0,1] neg_hi:[0,0,1]
    v_pk_fma_f32 v[128:129], v[80:81], s[70:71], v[12:13] op_sel_hi:[1,1,0] neg_lo:[0,1,0] neg_hi:[0,1,0]
    v_pk_fma_f32 v[80:81], v[80:81], s[70:71], v[10:11] op_sel_hi:[1,1,0] neg_lo:[0,0,1] neg_hi:[0,0,1]
    v_pk_fma_f32 v[130:131], v[82:83], s[70:71], v[12:13] op_sel_hi:[1,1,0] neg_lo:[0,1,0] neg_hi:[0,1,0]
    v_pk_fma_f32 v[82:83], v[82:83], s[70:71], v[10:11] op_sel_hi:[1,1,0] neg_lo:[0,0,1] neg_hi:[0,0,1]
    v_pk_fma_f32 v[132:133], v[84:85], s[70:71], v[12:13] op_sel_hi:[1,1,0] neg_lo:[0,1,0] neg_hi:[0,1,0]
    v_pk_fma_f32 v[84:85], v[84:85], s[70:71], v[10:11] op_sel_hi:[1,1,0] neg_lo:[0,0,1] neg_hi:[0,0,1]
    v_pk_fma_f32 v[134:135], v[86:87], s[70:71], v[12:13] op_sel_hi:[1,1,0] neg_lo:[0,1,0] neg_hi:[0,1,0]
    v_pk_fma_f32 v[86:87], v[86:87], s[70:71], v[10:11] op_sel_hi:[1,1,0] neg_lo:[0,0,1] neg_hi:[0,0,1]
    v_exp_f32 v72, v72
    v_exp_f32 v120, v120
    v_exp_f32 v73, v73
    v_exp_f32 v121, v121
    v_exp_f32 v74, v74
    v_exp_f32 v122, v122
    v_exp_f32 v75, v75
    v_exp_f32 v123, v123
    v_exp_f32 v76, v76
    v_exp_f32 v124, v124
    v_exp_f32 v77, v77
    v_exp_f32 v125, v125
    v_exp_f32 v78, v78
    v_exp_f32 v126, v126
    v_exp_f32 v79, v79
    v_exp_f32 v127, v127
    v_exp_f32 v80, v80
    v_exp_f32 v128, v128
    v_exp_f32 v81, v81
    v_exp_f32 v129, v129
    v_exp_f32 v82, v82
    v_exp_f32 v130, v130
    v_exp_f32 v83, v83
    v_exp_f32 v131, v131
    v_exp_f32 v84, v84
    v_exp_f32 v132, v132
    v_exp_f32 v85, v85
    v_exp_f32 v133, v133
    v_exp_f32 v86, v86
    v_exp_f32 v134, v134
    v_exp_f32 v87, v87
    v_exp_f32 v135, v135
    v_pk_add_f32 v[10:11], v[72:73], v[74:75]
    v_pk_add_f32 v[12:13], v[120:121], v[122:123]
    v_pk_add_f32 v[10:11], v[10:11], v[76:77]
    v_pk_add_f32 v[12:13], v[12:13], v[124:125]
    v_pk_add_f32 v[10:11], v[10:11], v[78:79]
    v_pk_add_f32 v[12:13], v[12:13], v[126:127]
    v_pk_add_f32 v[10:11], v[10:11], v[80:81]
    v_pk_add_f32 v[12:13], v[12:13], v[128:129]
    v_pk_add_f32 v[10:11], v[10:11], v[82:83]
    v_pk_add_f32 v[12:13], v[12:13], v[130:131]
    v_pk_add_f32 v[10:11], v[10:11], v[84:85]
    v_pk_add_f32 v[12:13], v[12:13], v[132:133]
    v_pk_add_f32 v[10:11], v[10:11], v[86:87]
    v_pk_add_f32 v[12:13], v[12:13], v[134:135]
    v_add_f32 v10, v10, v11
    v_add_f32 v12, v12, v13
    v_mov_b32 v11, v10
    v_mov_b32 v13, v12
    s_nop 1
    v_permlane32_swap_b32 v10, v11
    v_permlane32_swap_b32 v12, v13
    v_add_f32 v10, v10, v11
    v_add_f32 v12, v12, v13
    v_rcp_f32 v10, v10
    v_rcp_f32 v12, v12
    s_nop 0
    v_pk_mul_f32 v[72:73], v[72:73], v[10:11] op_sel_hi:[1,0]
    v_pk_mul_f32 v[120:121], v[120:121], v[12:13] op_sel_hi:[1,0]
    v_pk_mul_f32 v[74:75], v[74:75], v[10:11] op_sel_hi:[1,0]
    v_pk_mul_f32 v[122:123], v[122:123], v[12:13] op_sel_hi:[1,0]
    v_pk_mul_f32 v[76:77], v[76:77], v[10:11] op_sel_hi:[1,0]
    v_pk_mul_f32 v[124:125], v[124:125], v[12:13] op_sel_hi:[1,0]
    v_pk_mul_f32 v[78:79], v[78:79], v[10:11] op_sel_hi:[1,0]
    v_pk_mul_f32 v[126:127], v[126:127], v[12:13] op_sel_hi:[1,0]
    v_pk_mul_f32 v[80:81], v[80:81], v[10:11] op_sel_hi:[1,0]
    v_pk_mul_f32 v[128:129], v[128:129], v[12:13] op_sel_hi:[1,0]
    v_pk_mul_f32 v[82:83], v[82:83], v[10:11] op_sel_hi:[1,0]
    v_pk_mul_f32 v[130:131], v[130:131], v[12:13] op_sel_hi:[1,0]
    v_pk_mul_f32 v[84:85], v[84:85], v[10:11] op_sel_hi:[1,0]
    v_pk_mul_f32 v[132:133], v[132:133], v[12:13] op_sel_hi:[1,0]
    v_pk_mul_f32 v[86:87], v[86:87], v[10:11] op_sel_hi:[1,0]
    v_pk_mul_f32 v[134:135], v[134:135], v[12:13] op_sel_hi:[1,0]
    v_cvt_pk_bf16_f32 v24, v72, v73
    v_cvt_pk_bf16_f32 v25, v74, v75
    v_cvt_pk_bf16_f32 v26, v76, v77
    v_cvt_pk_bf16_f32 v27, v78, v79
    v_cvt_pk_bf16_f32 v28, v80, v81
    v_cvt_pk_bf16_f32 v29, v82, v83
    v_cvt_pk_bf16_f32 v30, v84, v85
    v_cvt_pk_bf16_f32 v31, v86, v87
    v_cvt_pk_bf16_f32 v72, v120, v121
    v_cvt_pk_bf16_f32 v73, v122, v123
    v_cvt_pk_bf16_f32 v74, v124, v125
    v_cvt_pk_bf16_f32 v75, v126, v127
    v_cvt_pk_bf16_f32 v76, v128, v129
    v_cvt_pk_bf16_f32 v77, v130, v131
    v_cvt_pk_bf16_f32 v78, v132, v133
    v_cvt_pk_bf16_f32 v79, v134, v135
    s_waitcnt vmcnt(0)
    s_mov_b32 s6, 0xbfb8aa3b
    v_lshlrev_b32 v216, 16, v216
    v_lshlrev_b32 v217, 16, v217
    v_lshlrev_b32 v218, 16, v218
    v_lshlrev_b32 v219, 16, v219
    v_lshlrev_b32 v220, 16, v220
    v_lshlrev_b32 v221, 16, v221
    v_lshlrev_b32 v222, 16, v222
    v_lshlrev_b32 v223, 16, v223
    v_mul_f32 v224, s6, v216
    v_mul_f32 v225, s6, v217
    v_mul_f32 v226, s6, v218
    v_mul_f32 v227, s6, v219
    v_mul_f32 v228, s6, v220
    v_mul_f32 v229, s6, v221
    v_mul_f32 v230, s6, v222
    v_mul_f32 v231, s6, v223
    v_exp_f32 v224, v224
    v_exp_f32 v225, v225
    v_exp_f32 v226, v226
    v_exp_f32 v227, v227
    v_exp_f32 v228, v228
    v_exp_f32 v229, v229
    v_exp_f32 v230, v230
    v_exp_f32 v231, v231
    v_add_f32 v224, 1.0, v224
    v_add_f32 v225, 1.0, v225
    v_add_f32 v226, 1.0, v226
    v_add_f32 v227, 1.0, v227
    v_add_f32 v228, 1.0, v228
    v_add_f32 v229, 1.0, v229
    v_add_f32 v230, 1.0, v230
    v_add_f32 v231, 1.0, v231
    v_rcp_f32 v224, v224
    v_rcp_f32 v225, v225
    v_rcp_f32 v226, v226
    v_rcp_f32 v227, v227
    v_rcp_f32 v228, v228
    v_rcp_f32 v229, v229
    v_rcp_f32 v230, v230
    v_rcp_f32 v231, v231
    v_mul_f32 v216, v216, v224
    v_mul_f32 v217, v217, v225
    v_mul_f32 v218, v218, v226
    v_mul_f32 v219, v219, v227
    v_mul_f32 v220, v220, v228
    v_mul_f32 v221, v221, v229
    v_mul_f32 v222, v222, v230
    v_mul_f32 v223, v223, v231
    v_cvt_pk_bf16_f32 v216, v216, v216
    v_cvt_pk_bf16_f32 v217, v217, v217
    v_cvt_pk_bf16_f32 v218, v218, v218
    v_cvt_pk_bf16_f32 v219, v219, v219
    v_cvt_pk_bf16_f32 v220, v220, v220
    v_cvt_pk_bf16_f32 v221, v221, v221
    v_cvt_pk_bf16_f32 v222, v222, v222
    v_cvt_pk_bf16_f32 v223, v223, v223
    v_lshlrev_b32 v216, 16, v216
    v_lshlrev_b32 v217, 16, v217
    v_lshlrev_b32 v218, 16, v218
    v_lshlrev_b32 v219, 16, v219
    v_lshlrev_b32 v220, 16, v220
    v_lshlrev_b32 v221, 16, v221
    v_lshlrev_b32 v222, 16, v222
    v_lshlrev_b32 v223, 16, v223
    v_lshlrev_b32 v224, 16, v184
    v_and_b32 v225, 0xffff0000, v184
    v_lshlrev_b32 v226, 16, v185
    v_and_b32 v227, 0xffff0000, v185
    v_lshlrev_b32 v228, 16, v186
    v_and_b32 v229, 0xffff0000, v186
    v_lshlrev_b32 v230, 16, v187
    v_and_b32 v231, 0xffff0000, v187
    v_mul_f32 v240, v216, v224
    v_mul_f32 v241, v216, v225
    v_mul_f32 v242, v216, v226
    v_mul_f32 v243, v216, v227
    v_mul_f32 v244, v216, v228
    v_mul_f32 v245, v216, v229
    v_mul_f32 v246, v216, v230
    v_mul_f32 v247, v216, v231
    v_lshlrev_b32 v232, 16, v188
    v_and_b32 v233, 0xffff0000, v188
    v_lshlrev_b32 v234, 16, v189
    v_and_b32 v235, 0xffff0000, v189
    v_lshlrev_b32 v236, 16, v190
    v_and_b32 v237, 0xffff0000, v190
    v_lshlrev_b32 v238, 16, v191
    v_and_b32 v239, 0xffff0000, v191
    v_fmac_f32 v240, v217, v232
    v_fmac_f32 v241, v217, v233
    v_fmac_f32 v242, v217, v234
    v_fmac_f32 v243, v217, v235
    v_fmac_f32 v244, v217, v236
    v_fmac_f32 v245, v217, v237
    v_fmac_f32 v246, v217, v238
    v_fmac_f32 v247, v217, v239
    v_lshlrev_b32 v224, 16, v192
    v_and_b32 v225, 0xffff0000, v192
    v_lshlrev_b32 v226, 16, v193
    v_and_b32 v227, 0xffff0000, v193
    v_lshlrev_b32 v228, 16, v194
    v_and_b32 v229, 0xffff0000, v194
    v_lshlrev_b32 v230, 16, v195
    v_and_b32 v231, 0xffff0000, v195
    v_fmac_f32 v240, v218, v224
    v_fmac_f32 v241, v218, v225
    v_fmac_f32 v242, v218, v226
    v_fmac_f32 v243, v218, v227
    v_fmac_f32 v244, v218, v228
    v_fmac_f32 v245, v218, v229
    v_fmac_f32 v246, v218, v230
    v_fmac_f32 v247, v218, v231
    v_lshlrev_b32 v232, 16, v196
    v_and_b32 v233, 0xffff0000, v196
    v_lshlrev_b32 v234, 16, v197
    v_and_b32 v235, 0xffff0000, v197
    v_lshlrev_b32 v236, 16, v198
    v_and_b32 v237, 0xffff0000, v198
    v_lshlrev_b32 v238, 16, v199
    v_and_b32 v239, 0xffff0000, v199
    v_fmac_f32 v240, v219, v232
    v_fmac_f32 v241, v219, v233
    v_fmac_f32 v242, v219, v234
    v_fmac_f32 v243, v219, v235
    v_fmac_f32 v244, v219, v236
    v_fmac_f32 v245, v219, v237
    v_fmac_f32 v246, v219, v238
    v_fmac_f32 v247, v219, v239
    v_lshlrev_b32 v224, 16, v200
    v_and_b32 v225, 0xffff0000, v200
    v_lshlrev_b32 v226, 16, v201
    v_and_b32 v227, 0xffff0000, v201
    v_lshlrev_b32 v228, 16, v202
    v_and_b32 v229, 0xffff0000, v202
    v_lshlrev_b32 v230, 16, v203
    v_and_b32 v231, 0xffff0000, v203
    v_fmac_f32 v240, v220, v224
    v_fmac_f32 v241, v220, v225
    v_fmac_f32 v242, v220, v226
    v_fmac_f32 v243, v220, v227
    v_fmac_f32 v244, v220, v228
    v_fmac_f32 v245, v220, v229
    v_fmac_f32 v246, v220, v230
    v_fmac_f32 v247, v220, v231
    v_lshlrev_b32 v232, 16, v204
    v_and_b32 v233, 0xffff0000, v204
    v_lshlrev_b32 v234, 16, v205
    v_and_b32 v235, 0xffff0000, v205
    v_lshlrev_b32 v236, 16, v206
    v_and_b32 v237, 0xffff0000, v206
    v_lshlrev_b32 v238, 16, v207
    v_and_b32 v239, 0xffff0000, v207
    v_fmac_f32 v240, v221, v232
    v_fmac_f32 v241, v221, v233
    v_fmac_f32 v242, v221, v234
    v_fmac_f32 v243, v221, v235
    v_fmac_f32 v244, v221, v236
    v_fmac_f32 v245, v221, v237
    v_fmac_f32 v246, v221, v238
    v_fmac_f32 v247, v221, v239
    v_lshlrev_b32 v224, 16, v208
    v_and_b32 v225, 0xffff0000, v208
    v_lshlrev_b32 v226, 16, v209
    v_and_b32 v227, 0xffff0000, v209
    v_lshlrev_b32 v228, 16, v210
    v_and_b32 v229, 0xffff0000, v210
    v_lshlrev_b32 v230, 16, v211
    v_and_b32 v231, 0xffff0000, v211
    v_fmac_f32 v240, v222, v224
    v_fmac_f32 v241, v222, v225
    v_fmac_f32 v242, v222, v226
    v_fmac_f32 v243, v222, v227
    v_fmac_f32 v244, v222, v228
    v_fmac_f32 v245, v222, v229
    v_fmac_f32 v246, v222, v230
    v_fmac_f32 v247, v222, v231
    v_lshlrev_b32 v232, 16, v212
    v_and_b32 v233, 0xffff0000, v212
    v_lshlrev_b32 v234, 16, v213
    v_and_b32 v235, 0xffff0000, v213
    v_lshlrev_b32 v236, 16, v214
    v_and_b32 v237, 0xffff0000, v214
    v_lshlrev_b32 v238, 16, v215
    v_and_b32 v239, 0xffff0000, v215
    v_fmac_f32 v240, v223, v232
    v_fmac_f32 v241, v223, v233
    v_fmac_f32 v242, v223, v234
    v_fmac_f32 v243, v223, v235
    v_fmac_f32 v244, v223, v236
    v_fmac_f32 v245, v223, v237
    v_fmac_f32 v246, v223, v238
    v_fmac_f32 v247, v223, v239
    v_add_f32_dpp v240, v240, v240 row_ror:8 row_mask:0xf bank_mask:0xf
    v_add_f32_dpp v241, v241, v241 row_ror:8 row_mask:0xf bank_mask:0xf
    v_add_f32_dpp v242, v242, v242 row_ror:8 row_mask:0xf bank_mask:0xf
    v_add_f32_dpp v243, v243, v243 row_ror:8 row_mask:0xf bank_mask:0xf
    v_add_f32_dpp v244, v244, v244 row_ror:8 row_mask:0xf bank_mask:0xf
    v_add_f32_dpp v245, v245, v245 row_ror:8 row_mask:0xf bank_mask:0xf
    v_add_f32_dpp v246, v246, v246 row_ror:8 row_mask:0xf bank_mask:0xf
    v_add_f32_dpp v247, v247, v247 row_ror:8 row_mask:0xf bank_mask:0xf
    v_mov_b32 v232, v240
    v_mov_b32 v233, v241
    v_mov_b32 v234, v242
    v_mov_b32 v235, v243
    v_mov_b32 v236, v244
    v_mov_b32 v237, v245
    v_mov_b32 v238, v246
    v_mov_b32 v239, v247
    v_permlane16_swap_b32 v240, v232
    v_permlane16_swap_b32 v241, v233
    v_permlane16_swap_b32 v242, v234
    v_permlane16_swap_b32 v243, v235
    v_permlane16_swap_b32 v244, v236
    v_permlane16_swap_b32 v245, v237
    v_permlane16_swap_b32 v246, v238
    v_permlane16_swap_b32 v247, v239
    v_add_f32 v240, v240, v232
    v_add_f32 v241, v241, v233
    v_add_f32 v242, v242, v234
    v_add_f32 v243, v243, v235
    v_add_f32 v244, v244, v236
    v_add_f32 v245, v245, v237
    v_add_f32 v246, v246, v238
    v_add_f32 v247, v247, v239
    v_mov_b32 v232, v240
    v_mov_b32 v233, v241
    v_mov_b32 v234, v242
    v_mov_b32 v235, v243
    v_mov_b32 v236, v244
    v_mov_b32 v237, v245
    v_mov_b32 v238, v246
    v_mov_b32 v239, v247
    v_permlane32_swap_b32 v240, v232
    v_permlane32_swap_b32 v241, v233
    v_permlane32_swap_b32 v242, v234
    v_permlane32_swap_b32 v243, v235
    v_permlane32_swap_b32 v244, v236
    v_permlane32_swap_b32 v245, v237
    v_permlane32_swap_b32 v246, v238
    v_permlane32_swap_b32 v247, v239
    v_add_f32 v240, v240, v232
    v_add_f32 v241, v241, v233
    v_add_f32 v242, v242, v234
    v_add_f32 v243, v243, v235
    v_add_f32 v244, v244, v236
    v_add_f32 v245, v245, v237
    v_add_f32 v246, v246, v238
    v_add_f32 v247, v247, v239
    s_mov_b32 s32, 0xff00
    s_mov_b32 s33, 0x0
    v_cndmask_b32 v240, v240, v241, s[32:33]
    s_mov_b32 s32, 0xff0000
    s_mov_b32 s33, 0x0
    v_cndmask_b32 v240, v240, v242, s[32:33]
    s_mov_b32 s32, 0xff000000
    s_mov_b32 s33, 0x0
    v_cndmask_b32 v240, v240, v243, s[32:33]
    s_mov_b32 s32, 0x0
    s_mov_b32 s33, 0xff
    v_cndmask_b32 v240, v240, v244, s[32:33]
    s_mov_b32 s32, 0x0
    s_mov_b32 s33, 0xff00
    v_cndmask_b32 v240, v240, v245, s[32:33]
    s_mov_b32 s32, 0x0
    s_mov_b32 s33, 0xff0000
    v_cndmask_b32 v240, v240, v246, s[32:33]
    s_mov_b32 s32, 0x0
    s_mov_b32 s33, 0xff000000
    v_cndmask_b32 v240, v240, v247, s[32:33]
    s_and_b32 s6, s2, 63
    s_lshl_b32 s6, s6, 8
    s_add_u32 s6, s6, 98304
    s_add_u32 s68, s62, s6
    s_addc_u32 s69, s63, 0
    s_mov_b32 s70, 0x100
    s_mov_b32 s71, 0x00020000
    v_and_b32 v232, 7, v1
    v_lshrrev_b32 v233, 3, v1
    v_lshlrev_b32 v233, 2, v233
    v_lshl_add_u32 v232, v232, 5, v233
    buffer_atomic_add_f32 v240, v232, s[68:71], 0 offen
    s_lshl_b32 s6, s35, 12
    s_add_u32 s6, s6, 65536
    v_lshl_add_u32 v6, v1, 4, s6
    s_lshl_b32 s6, s35, 7
    s_add_u32 s6, s6, 73728
    v_add_u32 v7, s6, v5
    v_and_b32 v4, 15, v1
    v_add_u32 v4, s34, v4
    v_bfe_u32 v3, v1, 4, 1
    v_lshl_add_u32 v3, v3, 5, v5
    v_lshl_add_u32 v4, v4, 12, v3
    s_lshl_b32 s72, s35, 6
    s_add_u32 s73, s72, 65536
    s_add_u32 s74, s72, 131072
    s_add_u32 s75, s72, 196608
    s_lshl_b32 s6, s3, 14
    v_lshl_add_u32 v232, v1, 4, s6
    v_add_u32 v233, 4096, v232
    v_add_u32 v234, 8192, v232
    v_add_u32 v235, 12288, v232
    s_lshl_b32 s6, s3, 10
    s_add_u32 s6, s6, 65536
    v_lshl_add_u32 v236, v1, 4, s6
    v_mov_b32 v240, 74240
    s_mov_b32 s66, 0x1000000
L_k2_fl_18:
    ds_read_b32 v241, v240
    s_waitcnt lgkmcnt(0)
    v_cmp_eq_u32 vcc, 0, v241
    s_sub_u32 s66, s66, 1
    s_cbranch_scc1 L_k2_fd_19
    s_cbranch_vccz L_k2_fd_19
    s_sleep 1
    s_branch L_k2_fl_18
L_k2_fd_19:
    s_mov_b32 s66, 262144
L_k2_u_l_20:
    buffer_load_dwordx4 v[88:91], v232, s[16:19], 0 offen offset:0 sc1
    buffer_load_dwordx4 v[92:95], v232, s[16:19], 0 offen offset:1024 sc1
    buffer_load_dwordx4 v[96:99], v232, s[16:19], 0 offen offset:2048 sc1
    buffer_load_dwordx4 v[100:103], v232, s[16:19], 0 offen offset:3072 sc1
    buffer_load_dwordx4 v[104:107], v233, s[16:19], 0 offen offset:0 sc1
    buffer_load_dwordx4 v[108:111], v233, s[16:19], 0 offen offset:1024 sc1
    buffer_load_dwordx4 v[112:115], v233, s[16:19], 0 offen offset:2048 sc1
    buffer_load_dwordx4 v[116:119], v233, s[16:19], 0 offen offset:3072 sc1
    buffer_load_dwordx4 v[120:123], v234, s[16:19], 0 offen offset:0 sc1
    buffer_load_dwordx4 v[124:127], v234, s[16:19], 0 offen offset:1024 sc1
    buffer_load_dwordx4 v[128:131], v234, s[16:19], 0 offen offset:2048 sc1
    buffer_load_dwordx4 v[132:135], v234, s[16:19], 0 offen offset:3072 sc1
    buffer_load_dwordx4 v[136:139], v235, s[16:19], 0 offen offset:0 sc1
    buffer_load_dwordx4 v[140:143], v235, s[16:19], 0 offen offset:1024 sc1
    buffer_load_dwordx4 v[144:147], v235, s[16:19], 0 offen offset:2048 sc1
    buffer_load_dwordx4 v[148:151], v235, s[16:19], 0 offen offset:3072 sc1
    s_waitcnt vmcnt(15)
    v_lshlrev_b32 v184, 16, v88
    v_and_b32 v185, 0xffff0000, v88
    v_lshlrev_b32 v186, 16, v89
    v_and_b32 v187, 0xffff0000, v89
    v_lshlrev_b32 v188, 16, v90
    v_and_b32 v189, 0xffff0000, v90
    v_lshlrev_b32 v190, 16, v91
    v_and_b32 v191, 0xffff0000, v91
    s_waitcnt vmcnt(14)
    v_lshlrev_b32 v192, 16, v92
    v_and_b32 v193, 0xffff0000, v92
    v_lshlrev_b32 v194, 16, v93
    v_and_b32 v195, 0xffff0000, v93
    v_lshlrev_b32 v196, 16, v94
    v_and_b32 v197, 0xffff0000, v94
    v_lshlrev_b32 v198, 16, v95
    v_and_b32 v199, 0xffff0000, v95
    v_pk_add_f32 v[184:185], v[184:185], v[192:193]
    v_pk_add_f32 v[186:187], v[186:187], v[194:195]
    v_pk_add_f32 v[188:189], v[188:189], v[196:197]
    v_pk_add_f32 v[190:191], v[190:191], v[198:199]
    s_waitcnt vmcnt(13)
    v_lshlrev_b32 v192, 16, v96
    v_and_b32 v193, 0xffff0000, v96
    v_lshlrev_b32 v194, 16, v97
    v_and_b32 v195, 0xffff0000, v97
    v_lshlrev_b32 v196, 16, v98
    v_and_b32 v197, 0xffff0000, v98
    v_lshlrev_b32 v198, 16, v99
    v_and_b32 v199, 0xffff0000, v99
    v_pk_add_f32 v[184:185], v[184:185], v[192:193]
    v_pk_add_f32 v[186:187], v[186:187], v[194:195]
    v_pk_add_f32 v[188:189], v[188:189], v[196:197]
    v_pk_add_f32 v[190:191], v[190:191], v[198:199]
    s_waitcnt vmcnt(12)
    v_lshlrev_b32 v192, 16, v100
    v_and_b32 v193, 0xffff0000, v100
    v_lshlrev_b32 v194, 16, v101
    v_and_b32 v195, 0xffff0000, v101
    v_lshlrev_b32 v196, 16, v102
    v_and_b32 v197, 0xffff0000, v102
    v_lshlrev_b32 v198, 16, v103
    v_and_b32 v199, 0xffff0000, v103
    v_pk_add_f32 v[184:185], v[184:185], v[192:193]
    v_pk_add_f32 v[186:187], v[186:187], v[194:195]
    v_pk_add_f32 v[188:189], v[188:189], v[196:197]
    v_pk_add_f32 v[190:191], v[190:191], v[198:199]
    s_waitcnt vmcnt(11)
    v_lshlrev_b32 v192, 16, v104
    v_and_b32 v193, 0xffff0000, v104
    v_lshlrev_b32 v194, 16, v105
    v_and_b32 v195, 0xffff0000, v105
    v_lshlrev_b32 v196, 16, v106
    v_and_b32 v197, 0xffff0000, v106
    v_lshlrev_b32 v198, 16, v107
    v_and_b32 v199, 0xffff0000, v107
    v_pk_add_f32 v[184:185], v[184:185], v[192:193]
    v_pk_add_f32 v[186:187], v[186:187], v[194:195]
    v_pk_add_f32 v[188:189], v[188:189], v[196:197]
    v_pk_add_f32 v[190:191], v[190:191], v[198:199]
    s_waitcnt vmcnt(10)
    v_lshlrev_b32 v192, 16, v108
    v_and_b32 v193, 0xffff0000, v108
    v_lshlrev_b32 v194, 16, v109
    v_and_b32 v195, 0xffff0000, v109
    v_lshlrev_b32 v196, 16, v110
    v_and_b32 v197, 0xffff0000, v110
    v_lshlrev_b32 v198, 16, v111
    v_and_b32 v199, 0xffff0000, v111
    v_pk_add_f32 v[184:185], v[184:185], v[192:193]
    v_pk_add_f32 v[186:187], v[186:187], v[194:195]
    v_pk_add_f32 v[188:189], v[188:189], v[196:197]
    v_pk_add_f32 v[190:191], v[190:191], v[198:199]
    s_waitcnt vmcnt(9)
    v_lshlrev_b32 v192, 16, v112
    v_and_b32 v193, 0xffff0000, v112
    v_lshlrev_b32 v194, 16, v113
    v_and_b32 v195, 0xffff0000, v113
    v_lshlrev_b32 v196, 16, v114
    v_and_b32 v197, 0xffff0000, v114
    v_lshlrev_b32 v198, 16, v115
    v_and_b32 v199, 0xffff0000, v115
    v_pk_add_f32 v[184:185], v[184:185], v[192:193]
    v_pk_add_f32 v[186:187], v[186:187], v[194:195]
    v_pk_add_f32 v[188:189], v[188:189], v[196:197]
    v_pk_add_f32 v[190:191], v[190:191], v[198:199]
    s_waitcnt vmcnt(8)
    v_lshlrev_b32 v192, 16, v116
    v_and_b32 v193, 0xffff0000, v116
    v_lshlrev_b32 v194, 16, v117
    v_and_b32 v195, 0xffff0000, v117
    v_lshlrev_b32 v196, 16, v118
    v_and_b32 v197, 0xffff0000, v118
    v_lshlrev_b32 v198, 16, v119
    v_and_b32 v199, 0xffff0000, v119
    v_pk_add_f32 v[184:185], v[184:185], v[192:193]
    v_pk_add_f32 v[186:187], v[186:187], v[194:195]
    v_pk_add_f32 v[188:189], v[188:189], v[196:197]
    v_pk_add_f32 v[190:191], v[190:191], v[198:199]
    s_waitcnt vmcnt(7)
    v_lshlrev_b32 v192, 16, v120
    v_and_b32 v193, 0xffff0000, v120
    v_lshlrev_b32 v194, 16, v121
    v_and_b32 v195, 0xffff0000, v121
    v_lshlrev_b32 v196, 16, v122
    v_and_b32 v197, 0xffff0000, v122
    v_lshlrev_b32 v198, 16, v123
    v_and_b32 v199, 0xffff0000, v123
    v_pk_add_f32 v[184:185], v[184:185], v[192:193]
    v_pk_add_f32 v[186:187], v[186:187], v[194:195]
    v_pk_add_f32 v[188:189], v[188:189], v[196:197]
    v_pk_add_f32 v[190:191], v[190:191], v[198:199]
    s_waitcnt vmcnt(6)
    v_lshlrev_b32 v192, 16, v124
    v_and_b32 v193, 0xffff0000, v124
    v_lshlrev_b32 v194, 16, v125
    v_and_b32 v195, 0xffff0000, v125
    v_lshlrev_b32 v196, 16, v126
    v_and_b32 v197, 0xffff0000, v126
    v_lshlrev_b32 v198, 16, v127
    v_and_b32 v199, 0xffff0000, v127
    v_pk_add_f32 v[184:185], v[184:185], v[192:193]
    v_pk_add_f32 v[186:187], v[186:187], v[194:195]
    v_pk_add_f32 v[188:189], v[188:189], v[196:197]
    v_pk_add_f32 v[190:191], v[190:191], v[198:199]
    s_waitcnt vmcnt(5)
    v_lshlrev_b32 v192, 16, v128
    v_and_b32 v193, 0xffff0000, v128
    v_lshlrev_b32 v194, 16, v129
    v_and_b32 v195, 0xffff0000, v129
    v_lshlrev_b32 v196, 16, v130
    v_and_b32 v197, 0xffff0000, v130
    v_lshlrev_b32 v198, 16, v131
    v_and_b32 v199, 0xffff0000, v131
    v_pk_add_f32 v[184:185], v[184:185], v[192:193]
    v_pk_add_f32 v[186:187], v[186:187], v[194:195]
    v_pk_add_f32 v[188:189], v[188:189], v[196:197]
    v_pk_add_f32 v[190:191], v[190:191], v[198:199]
    s_waitcnt vmcnt(4)
    v_lshlrev_b32 v192, 16, v132
    v_and_b32 v193, 0xffff0000, v132
    v_lshlrev_b32 v194, 16, v133
    v_and_b32 v195, 0xffff0000, v133
    v_lshlrev_b32 v196, 16, v134
    v_and_b32 v197, 0xffff0000, v134
    v_lshlrev_b32 v198, 16, v135
    v_and_b32 v199, 0xffff0000, v135
    v_pk_add_f32 v[184:185], v[184:185], v[192:193]
    v_pk_add_f32 v[186:187], v[186:187], v[194:195]
    v_pk_add_f32 v[188:189], v[188:189], v[196:197]
    v_pk_add_f32 v[190:191], v[190:191], v[198:199]
    s_waitcnt vmcnt(3)
    v_lshlrev_b32 v192, 16, v136
    v_and_b32 v193, 0xffff0000, v136
    v_lshlrev_b32 v194, 16, v137
    v_and_b32 v195, 0xffff0000, v137
    v_lshlrev_b32 v196, 16, v138
    v_and_b32 v197, 0xffff0000, v138
    v_lshlrev_b32 v198, 16, v139
    v_and_b32 v199, 0xffff0000, v139
    v_pk_add_f32 v[184:185], v[184:185], v[192:193]
    v_pk_add_f32 v[186:187], v[186:187], v[194:195]
    v_pk_add_f32 v[188:189], v[188:189], v[196:197]
    v_pk_add_f32 v[190:191], v[190:191], v[198:199]
    s_waitcnt vmcnt(2)
    v_lshlrev_b32 v192, 16, v140
    v_and_b32 v193, 0xffff0000, v140
    v_lshlrev_b32 v194, 16, v141
    v_and_b32 v195, 0xffff0000, v141
    v_lshlrev_b32 v196, 16, v142
    v_and_b32 v197, 0xffff0000, v142
    v_lshlrev_b32 v198, 16, v143
    v_and_b32 v199, 0xffff0000, v143
    v_pk_add_f32 v[184:185], v[184:185], v[192:193]
    v_pk_add_f32 v[186:187], v[186:187], v[194:195]
    v_pk_add_f32 v[188:189], v[188:189], v[196:197]
    v_pk_add_f32 v[190:191], v[190:191], v[198:199]
    s_waitcnt vmcnt(1)
    v_lshlrev_b32 v192, 16, v144
    v_and_b32 v193, 0xffff0000, v144
    v_lshlrev_b32 v194, 16, v145
    v_and_b32 v195, 0xffff0000, v145
    v_lshlrev_b32 v196, 16, v146
    v_and_b32 v197, 0xffff0000, v146
    v_lshlrev_b32 v198, 16, v147
    v_and_b32 v199, 0xffff0000, v147
    v_pk_add_f32 v[184:185], v[184:185], v[192:193]
    v_pk_add_f32 v[186:187], v[186:187], v[194:195]
    v_pk_add_f32 v[188:189], v[188:189], v[196:197]
    v_pk_add_f32 v[190:191], v[190:191], v[198:199]
    s_waitcnt vmcnt(0)
    v_lshlrev_b32 v192, 16, v148
    v_and_b32 v193, 0xffff0000, v148
    v_lshlrev_b32 v194, 16, v149
    v_and_b32 v195, 0xffff0000, v149
    v_lshlrev_b32 v196, 16, v150
    v_and_b32 v197, 0xffff0000, v150
    v_lshlrev_b32 v198, 16, v151
    v_and_b32 v199, 0xffff0000, v151
    v_pk_add_f32 v[184:185], v[184:185], v[192:193]
    v_pk_add_f32 v[186:187], v[186:187], v[194:195]
    v_pk_add_f32 v[188:189], v[188:189], v[196:197]
    v_pk_add_f32 v[190:191], v[190:191], v[198:199]
    v_cmp_u_f32 vcc, v184, v191
    v_cvt_pk_bf16_f32 v196, v184, v185
    v_cvt_pk_bf16_f32 v197, v186, v187
    v_cvt_pk_bf16_f32 v198, v188, v189
    v_cvt_pk_bf16_f32 v199, v190, v191
    s_sub_u32 s66, s66, 1
    s_cbranch_scc1 L_k2_u_d_21
    s_cbranch_vccz L_k2_u_d_21
    s_branch L_k2_u_l_20
L_k2_u_d_21:
    ds_write_b128 v236, v[196:199]
    s_waitcnt lgkmcnt(0)
    s_barrier
    ds_read_b128 v[104:107], v7 offset:0
    ds_read_b128 v[108:111], v7 offset:32
    ds_read_b128 v[112:115], v7 offset:64
    ds_read_b128 v[116:119], v7 offset:96
    ds_read_b128 v[88:91], v6 offset:0
    ds_read_b128 v[92:95], v6 offset:1024
    ds_read_b128 v[96:99], v6 offset:2048
    ds_read_b128 v[100:103], v6 offset:3072
    s_waitcnt lgkmcnt(4)
    v_mfma_f32_32x32x16_bf16 v[136:151], v[104:107], v[16:19], 0
    v_mfma_f32_32x32x16_bf16 v[136:151], v[108:111], v[20:23], v[136:151]
    v_mfma_f32_32x32x16_bf16 v[136:151], v[112:115], v[56:59], v[136:151]
    v_mfma_f32_32x32x16_bf16 v[136:151], v[116:119], v[60:63], v[136:151]
    v_mfma_f32_32x32x16_bf16 v[200:215], v[104:107], v[24:27], 0
    v_mfma_f32_32x32x16_bf16 v[200:215], v[108:111], v[28:31], v[200:215]
    v_mfma_f32_32x32x16_bf16 v[200:215], v[112:115], v[72:75], v[200:215]
    v_mfma_f32_32x32x16_bf16 v[200:215], v[116:119], v[76:79], v[200:215]
    s_waitcnt lgkmcnt(0)
    v_mfma_f32_32x32x16_bf16 v[120:135], v[88:91], v[16:19], 0
    v_mfma_f32_32x32x16_bf16 v[120:135], v[92:95], v[20:23], v[120:135]
    v_mfma_f32_32x32x16_bf16 v[120:135], v[96:99], v[56:59], v[120:135]
    v_mfma_f32_32x32x16_bf16 v[120:135], v[100:103], v[60:63], v[120:135]
    v_add_f32 v8, 0x358637bd, v136
    v_add_f32 v10, 0x358637bd, v200
    v_rcp_f32 v8, v8
    v_rcp_f32 v10, v10
    v_mfma_f32_32x32x16_bf16 v[184:199], v[88:91], v[24:27], 0
    v_mfma_f32_32x32x16_bf16 v[184:199], v[92:95], v[28:31], v[184:199]
    v_mfma_f32_32x32x16_bf16 v[184:199], v[96:99], v[72:75], v[184:199]
    v_mfma_f32_32x32x16_bf16 v[184:199], v[100:103], v[76:79], v[184:199]
    v_pk_mul_f32 v[120:121], v[120:121], v[8:9] op_sel_hi:[1,0]
    v_pk_mul_f32 v[122:123], v[122:123], v[8:9] op_sel_hi:[1,0]
    v_pk_mul_f32 v[124:125], v[124:125], v[8:9] op_sel_hi:[1,0]
    v_pk_mul_f32 v[126:127], v[126:127], v[8:9] op_sel_hi:[1,0]
    v_pk_mul_f32 v[128:129], v[128:129], v[8:9] op_sel_hi:[1,0]
    v_pk_mul_f32 v[130:131], v[130:131], v[8:9] op_sel_hi:[1,0]
    v_pk_mul_f32 v[132:133], v[132:133], v[8:9] op_sel_hi:[1,0]
    v_pk_mul_f32 v[134:135], v[134:135], v[8:9] op_sel_hi:[1,0]
    v_cvt_pk_bf16_f32 v136, v120, v121
    v_cvt_pk_bf16_f32 v137, v122, v123
    v_cvt_pk_bf16_f32 v138, v124, v125
    v_cvt_pk_bf16_f32 v139, v126, v127
    v_cvt_pk_bf16_f32 v140, v128, v129
    v_cvt_pk_bf16_f32 v141, v130, v131
    v_cvt_pk_bf16_f32 v142, v132, v133
    v_cvt_pk_bf16_f32 v143, v134, v135
    v_permlane16_swap_b32 v136, v140
    v_permlane16_swap_b32 v137, v141
    v_permlane16_swap_b32 v138, v142
    v_permlane16_swap_b32 v139, v143
    buffer_store_dwordx4 v[136:139], v4, s[28:31], s72 offen sc1
    buffer_store_dwordx4 v[140:143], v4, s[28:31], s73 offen sc1
    s_nop 2
    v_pk_mul_f32 v[184:185], v[184:185], v[10:11] op_sel_hi:[1,0]
    v_pk_mul_f32 v[186:187], v[186:187], v[10:11] op_sel_hi:[1,0]
    v_pk_mul_f32 v[188:189], v[188:189], v[10:11] op_sel_hi:[1,0]
    v_pk_mul_f32 v[190:191], v[190:191], v[10:11] op_sel_hi:[1,0]
    v_pk_mul_f32 v[192:193], v[192:193], v[10:11] op_sel_hi:[1,0]
    v_pk_mul_f32 v[194:195], v[194:195], v[10:11] op_sel_hi:[1,0]
    v_pk_mul_f32 v[196:197], v[196:197], v[10:11] op_sel_hi:[1,0]
    v_pk_mul_f32 v[198:199], v[198:199], v[10:11] op_sel_hi:[1,0]
    v_cvt_pk_bf16_f32 v200, v184, v185
    v_cvt_pk_bf16_f32 v201, v186, v187
    v_cvt_pk_bf16_f32 v202, v188, v189
    v_cvt_pk_bf16_f32 v203, v190, v191
    v_cvt_pk_bf16_f32 v204, v192, v193
    v_cvt_pk_bf16_f32 v205, v194, v195
    v_cvt_pk_bf16_f32 v206, v196, v197
    v_cvt_pk_bf16_f32 v207, v198, v199
    v_permlane16_swap_b32 v200, v204
    v_permlane16_swap_b32 v201, v205
    v_permlane16_swap_b32 v202, v206
    v_permlane16_swap_b32 v203, v207
    buffer_store_dwordx4 v[200:203], v4, s[28:31], s74 offen sc1
    buffer_store_dwordx4 v[204:207], v4, s[28:31], s75 offen sc1
    s_branch L_k2_com_22
L_k2_ldr_11:
    s_sub_u32 s34, s3, 4
    v_and_b32 v1, 63, v0
    v_lshrrev_b32 v2, 3, v1
    v_and_b32 v3, 7, v1
    s_lshl_b32 s6, s34, 3
    v_add_u32 v2, s6, v2
    v_bfe_u32 v4, v2, 1, 3
    v_xor_b32 v4, v4, v3
    s_mov_b32 s6, 4096
    v_mul_lo_u32 v5, s6, v2
    v_lshl_add_u32 v16, v4, 4, v5
    v_add_u32 v17, 131072, v16
    v_add_u32 v18, 131072, v17
    v_add_u32 v19, 131072, v18
    v_bfe_u32 v4, v2, 1, 1
    v_lshlrev_b32 v4, 2, v4
    v_xor_b32 v4, v4, v3
    s_mov_b32 s6, 6144
    v_mul_lo_u32 v5, s6, v2
    v_lshl_add_u32 v5, v4, 4, v5
    v_add_u32 v20, 0, v5
    v_add_u32 v21, 196608, v20
    v_add_u32 v22, 2048, v5
    v_add_u32 v23, 196608, v22
    v_add_u32 v24, 4096, v5
    v_add_u32 v25, 196608, v24
    s_lshl_b32 s64, s34, 10
    s_add_u32 s65, s64, 163840
    s_mov_b32 s7, 0
    s_mov_b32 s33, 0
    s_setprio 0
    s_cmp_lg_u32 s3, 4
    s_cbranch_scc1 L_k2_a2_23
    s_add_u32 s68, s62, 0xc5800
    s_addc_u32 s69, s63, 0
    s_mov_b32 s70, 0x400
    s_mov_b32 s71, 0x00020000
    v_lshlrev_b32 v38, 4, v1
    s_sleep 8
    s_mov_b32 s66, 262144
L_k2_a_l_24:
    buffer_load_dwordx4 v[44:47], v38, s[68:71], 0 offen offset:0 sc1
    s_waitcnt vmcnt(0)
    v_xor_b32 v44, v44, v253
    v_xor_b32 v45, v45, v253
    v_xor_b32 v46, v46, v253
    v_xor_b32 v47, v47, v253
    v_or3_b32 v44, v44, v45, v46
    v_or_b32 v44, v44, v47
    v_cmp_ne_u32 vcc, 0, v44
    s_sub_u32 s66, s66, 1
    s_cbranch_scc1 L_k2_a_d_25
    s_cbranch_vccz L_k2_a_d_25
    s_sleep 8
    s_branch L_k2_a_l_24
L_k2_a_d_25:
L_k2_a2_23:
    s_barrier
    s_mov_b32 s6, 0
    s_add_u32 m0, s64, 16384
    s_nop 0
    buffer_load_dwordx4 v20, s[12:15], s6 offen lds
    s_add_u32 m0, s64, 20480
    s_nop 0
    buffer_load_dwordx4 v21, s[12:15], s6 offen lds
    s_add_u32 m0, s64, 24576
    s_nop 0
    buffer_load_dwordx4 v22, s[12:15], s6 offen lds
    s_add_u32 m0, s64, 28672
    s_nop 0
    buffer_load_dwordx4 v23, s[12:15], s6 offen lds
    s_add_u32 m0, s64, 32768
    s_nop 0
    buffer_load_dwordx4 v24, s[12:15], s6 offen lds
    s_add_u32 m0, s64, 36864
    s_nop 0
    buffer_load_dwordx4 v25, s[12:15], s6 offen lds
    s_mov_b32 s6, 393216
    s_add_u32 m0, s64, 57344
    s_nop 0
    buffer_load_dwordx4 v20, s[12:15], s6 offen lds
    s_add_u32 m0, s64, 61440
    s_nop 0
    buffer_load_dwordx4 v21, s[12:15], s6 offen lds
    s_add_u32 m0, s64, 65536
    s_nop 0
    buffer_load_dwordx4 v22, s[12:15], s6 offen lds
    s_add_u32 m0, s64, 69632
    s_nop 0
    buffer_load_dwordx4 v23, s[12:15], s6 offen lds
    s_add_u32 m0, s64, 73728
    s_nop 0
    buffer_load_dwordx4 v24, s[12:15], s6 offen lds
    s_add_u32 m0, s64, 77824
    s_nop 0
    buffer_load_dwordx4 v25, s[12:15], s6 offen lds
    s_mov_b32 s6, 786432
    s_add_u32 m0, s64, 98304
    s_nop 0
    buffer_load_dwordx4 v20, s[12:15], s6 offen lds
    s_add_u32 m0, s64, 102400
    s_nop 0
    buffer_load_dwordx4 v21, s[12:15], s6 offen lds
    s_add_u32 m0, s64, 106496
    s_nop 0
    buffer_load_dwordx4 v22, s[12:15], s6 offen lds
    s_add_u32 m0, s64, 110592
    s_nop 0
    buffer_load_dwordx4 v23, s[12:15], s6 offen lds
    s_add_u32 m0, s64, 114688
    s_nop 0
    buffer_load_dwordx4 v24, s[12:15], s6 offen lds
    s_add_u32 m0, s64, 118784
    s_nop 0
    buffer_load_dwordx4 v25, s[12:15], s6 offen lds
    v_lshrrev_b32 v30, 0, v1
    v_min_u32 v30, 15, v30
    s_lshl_b32 s6, s4, 7
    s_add_u32 s6, s6, 20480
    v_lshl_add_u32 v30, v30, 2, s6
    v_mov_b32 v32, -1
    v_mov_b32 v33, -1
    v_mov_b32 v34, -1
    v_mov_b32 v35, -1
    v_mov_b32 v36, 163832
    s_barrier
    ds_read_b32 v36, v36
    s_waitcnt lgkmcnt(0)
    v_readfirstlane_b32 s99, v36
    s_andn2_b32 s101, 0xffff, s99
    s_and_b32 s6, s101, 7
    s_cbranch_scc1 L_k2_slow_28
    s_mov_b32 s6, 0
    s_add_u32 m0, s64, 0
    s_nop 0
    buffer_load_dwordx4 v16, s[8:11], s6 offen sc1 lds
    s_add_u32 m0, s64, 4096
    s_nop 0
    buffer_load_dwordx4 v17, s[8:11], s6 offen sc1 lds
    s_add_u32 m0, s64, 8192
    s_nop 0
    buffer_load_dwordx4 v18, s[8:11], s6 offen sc1 lds
    s_add_u32 m0, s64, 12288
    s_nop 0
    buffer_load_dwordx4 v19, s[8:11], s6 offen sc1 lds
    s_mov_b32 s6, 128
    s_add_u32 m0, s64, 40960
    s_nop 0
    buffer_load_dwordx4 v16, s[8:11], s6 offen sc1 lds
    s_add_u32 m0, s64, 45056
    s_nop 0
    buffer_load_dwordx4 v17, s[8:11], s6 offen sc1 lds
    s_add_u32 m0, s64, 49152
    s_nop 0
    buffer_load_dwordx4 v18, s[8:11], s6 offen sc1 lds
    s_add_u32 m0, s64, 53248
    s_nop 0
    buffer_load_dwordx4 v19, s[8:11], s6 offen sc1 lds
    s_mov_b32 s6, 256
    s_add_u32 m0, s64, 81920
    s_nop 0
    buffer_load_dwordx4 v16, s[8:11], s6 offen sc1 lds
    s_add_u32 m0, s64, 86016
    s_nop 0
    buffer_load_dwordx4 v17, s[8:11], s6 offen sc1 lds
    s_add_u32 m0, s64, 90112
    s_nop 0
    buffer_load_dwordx4 v18, s[8:11], s6 offen sc1 lds
    s_add_u32 m0, s64, 94208
    s_nop 0
    buffer_load_dwordx4 v19, s[8:11], s6 offen sc1 lds
    s_andn2_b32 s99, s99, 7
L_k2_pdone_27:
    s_ff1_i32_b32 s6, s99
    s_bitset0_b32 s99, s6
    s_mul_i32 s33, s6, 393216
    s_add_u32 s7, s6, 4
    s_mul_i32 s7, s7, 37
    s_lshr_b32 s7, s7, 8
    s_add_u32 s7, s6, s7
    s_lshl_b32 s7, s7, 7
    s_add_u32 s64, s64, 122880
    s_lshl_b32 s100, s4, 7
    s_lshl_b32 s6, s5, 2
    s_add_u32 s100, s100, s6
    s_add_u32 s100, s100, 0
    v_and_b32 v2, 255, v0
    v_lshlrev_b32 v2, 7, v2
    s_getpc_b64 s[68:69]
L_pc_29:
    s_sub_u32 s68, s68, L_pc_29-L_code_k2
    s_subb_u32 s69, s69, 0
    s_mov_b32 s70, L_code_k4-L_code_k2
    s_mov_b32 s71, 0x00020000
    buffer_load_dword v3, v2, s[68:71], 0 offen
    s_add_u32 s68, s62, 0xc0000
    s_addc_u32 s69, s63, 0
    s_mov_b32 s70, 0x6000
    s_mov_b32 s71, 0x00020000
    s_waitcnt vmcnt(9)
    s_barrier
    s_add_u32 m0, s64, 0
    s_nop 0
    buffer_load_dwordx4 v16, s[8:11], s7 offen sc1 lds
    s_add_u32 m0, s64, 4096
    s_nop 0
    buffer_load_dwordx4 v17, s[8:11], s7 offen sc1 lds
    s_add_u32 m0, s64, 8192
    s_nop 0
    buffer_load_dwordx4 v18, s[8:11], s7 offen sc1 lds
    s_add_u32 m0, s64, 12288
    s_nop 0
    buffer_load_dwordx4 v19, s[8:11], s7 offen sc1 lds
    s_add_u32 m0, s64, 16384
    s_nop 0
    buffer_load_dwordx4 v20, s[12:15], s33 offen lds
    s_add_u32 m0, s64, 20480
    s_nop 0
    buffer_load_dwordx4 v21, s[12:15], s33 offen lds
    s_add_u32 m0, s64, 24576
    s_nop 0
    buffer_load_dwordx4 v22, s[12:15], s33 offen lds
    s_add_u32 m0, s64, 28672
    s_nop 0
    buffer_load_dwordx4 v23, s[12:15], s33 offen lds
    s_add_u32 m0, s64, 32768
    s_nop 0
    buffer_load_dwordx4 v24, s[12:15], s33 offen lds
    s_add_u32 m0, s64, 36864
    s_nop 0
    buffer_load_dwordx4 v25, s[12:15], s33 offen lds
    s_cmp_eq_u32 s99, 0
    s_cbranch_scc1 L_k2_lt_30
L_k2_ltb_31:
    s_ff1_i32_b32 s6, s99
    s_bitset0_b32 s99, s6
    s_mul_i32 s33, s6, 393216
    s_add_u32 s7, s6, 4
    s_mul_i32 s7, s7, 37
    s_lshr_b32 s7, s7, 8
    s_add_u32 s7, s6, s7
    s_lshl_b32 s7, s7, 7
    s_bcnt1_i32_b32 s6, s99
    s_cmp_eq_u32 s6, 2
    s_cbranch_scc1 L_k2_pp_32
L_k2_ppb_33:
    s_add_u32 s64, s64, 40960
    s_cmp_eq_u32 s64, s65
    s_cselect_b32 s6, 163840, 0
    s_sub_u32 s64, s64, s6
    s_waitcnt vmcnt(15)
    s_barrier
    s_add_u32 m0, s64, 0
    s_nop 0
    buffer_load_dwordx4 v16, s[8:11], s7 offen sc1 lds
    s_add_u32 m0, s64, 4096
    s_nop 0
    buffer_load_dwordx4 v17, s[8:11], s7 offen sc1 lds
    s_add_u32 m0, s64, 8192
    s_nop 0
    buffer_load_dwordx4 v18, s[8:11], s7 offen sc1 lds
    s_add_u32 m0, s64, 12288
    s_nop 0
    buffer_load_dwordx4 v19, s[8:11], s7 offen sc1 lds
    s_add_u32 m0, s64, 16384
    s_nop 0
    buffer_load_dwordx4 v20, s[12:15], s33 offen lds
    s_add_u32 m0, s64, 20480
    s_nop 0
    buffer_load_dwordx4 v21, s[12:15], s33 offen lds
    s_add_u32 m0, s64, 24576
    s_nop 0
    buffer_load_dwordx4 v22, s[12:15], s33 offen lds
    s_add_u32 m0, s64, 28672
    s_nop 0
    buffer_load_dwordx4 v23, s[12:15], s33 offen lds
    s_add_u32 m0, s64, 32768
    s_nop 0
    buffer_load_dwordx4 v24, s[12:15], s33 offen lds
    s_add_u32 m0, s64, 36864
    s_nop 0
    buffer_load_dwordx4 v25, s[12:15], s33 offen lds
    s_cmp_eq_u32 s99, 0
    s_cbranch_scc1 L_k2_lt_34
L_k2_ltb_35:
    s_ff1_i32_b32 s6, s99
    s_bitset0_b32 s99, s6
    s_mul_i32 s33, s6, 393216
    s_add_u32 s7, s6, 4
    s_mul_i32 s7, s7, 37
    s_lshr_b32 s7, s7, 8
    s_add_u32 s7, s6, s7
    s_lshl_b32 s7, s7, 7
    s_bcnt1_i32_b32 s6, s99
    s_cmp_eq_u32 s6, 2
    s_cbranch_scc1 L_k2_pp_36
L_k2_ppb_37:
    s_add_u32 s64, s64, 40960
    s_cmp_eq_u32 s64, s65
    s_cselect_b32 s6, 163840, 0
    s_sub_u32 s64, s64, s6
    s_mov_b32 s66, 11
.p2align 4
L_k2_ll_38:
    s_waitcnt vmcnt(20)
    s_barrier
    s_add_u32 m0, s64, 0
    s_nop 0
    buffer_load_dwordx4 v16, s[8:11], s7 offen sc1 lds
    s_add_u32 m0, s64, 4096
    s_nop 0
    buffer_load_dwordx4 v17, s[8:11], s7 offen sc1 lds
    s_add_u32 m0, s64, 8192
    s_nop 0
    buffer_load_dwordx4 v18, s[8:11], s7 offen sc1 lds
    s_add_u32 m0, s64, 12288
    s_nop 0
    buffer_load_dwordx4 v19, s[8:11], s7 offen sc1 lds
    s_add_u32 m0, s64, 16384
    s_nop 0
    buffer_load_dwordx4 v20, s[12:15], s33 offen lds
    s_add_u32 m0, s64, 20480
    s_nop 0
    buffer_load_dwordx4 v21, s[12:15], s33 offen lds
    s_add_u32 m0, s64, 24576
    s_nop 0
    buffer_load_dwordx4 v22, s[12:15], s33 offen lds
    s_add_u32 m0, s64, 28672
    s_nop 0
    buffer_load_dwordx4 v23, s[12:15], s33 offen lds
    s_add_u32 m0, s64, 32768
    s_nop 0
    buffer_load_dwordx4 v24, s[12:15], s33 offen lds
    s_add_u32 m0, s64, 36864
    s_nop 0
    buffer_load_dwordx4 v25, s[12:15], s33 offen lds
    s_cmp_eq_u32 s99, 0
    s_cbranch_scc1 L_k2_lt_39
L_k2_ltb_40:
    s_ff1_i32_b32 s6, s99
    s_bitset0_b32 s99, s6
    s_mul_i32 s33, s6, 393216
    s_add_u32 s7, s6, 4
    s_mul_i32 s7, s7, 37
    s_lshr_b32 s7, s7, 8
    s_add_u32 s7, s6, s7
    s_lshl_b32 s7, s7, 7
    s_bcnt1_i32_b32 s6, s99
    s_cmp_eq_u32 s6, 2
    s_cbranch_scc1 L_k2_pp_41
L_k2_ppb_42:
    s_add_u32 s64, s64, 40960
    s_cmp_eq_u32 s64, s65
    s_cselect_b32 s6, 163840, 0
    s_sub_u32 s64, s64, s6
    s_sub_u32 s66, s66, 1
    s_cmp_lg_u32 s66, 0
    s_cbranch_scc1 L_k2_ll_38
    s_waitcnt vmcnt(20)
    s_barrier
    v_and_b32 v3, 255, v0
    v_lshlrev_b32 v2, 7, v3
    s_mul_i32 s6, s2, 8192
    s_add_u32 s8, s42, s6
    s_addc_u32 s9, s43, 0
    s_mov_b32 s10, 0x2000
    s_mov_b32 s11, 0x00020000
    buffer_load_dword v60, v2, s[8:11], 0 offen
    s_mul_i32 s6, s2, 28672
    s_add_u32 s12, s46, s6
    s_addc_u32 s13, s47, 0
    s_mov_b32 s14, 0x7000
    s_mov_b32 s15, 0x00020000
    buffer_load_dword v61, v2, s[12:15], 0 offen
    s_waitcnt vmcnt(12)
    s_barrier
    s_waitcnt vmcnt(2)
    s_barrier
    s_barrier
    s_lshl_b32 s6, s3, 14
    v_lshl_add_u32 v16, v1, 4, s6
    v_add_u32 v17, 4096, v16
    v_add_u32 v18, 8192, v16
    v_add_u32 v19, 12288, v16
    s_lshl_b32 s6, s3, 10
    s_add_u32 s6, s6, 65536
    v_lshl_add_u32 v20, v1, 4, s6
    v_and_b32 v10, 15, v1
    v_lshlrev_b32 v21, 2, v10
    v_add_u32 v21, 16384, v21
    v_lshlrev_b32 v25, 3, v1
    v_add_u32 v25, 8192, v25
    v_add_u32 v23, 4096, v25
    v_lshlrev_b32 v27, 2, v1
    v_add_u32 v27, 73728, v27
    v_mov_b32 v28, 0
    v_mov_b32 v29, 74240
    ds_write_b32 v29, v28
    s_setprio 0
    s_waitcnt vmcnt(0) lgkmcnt(0)
    s_barrier
    s_cmp_lg_u32 s34, 0
    s_cbranch_scc1 L_k2_lg_44
    s_sleep 16
    s_mov_b32 s66, 262144
    buffer_load_dword v36, v21, s[20:23], 0 offen sc1
L_k2_h_l_47:
    s_waitcnt vmcnt(0)
    v_cmp_eq_u32 vcc, -1, v36
    s_sub_u32 s66, s66, 1
    s_cbranch_scc1 L_k2_h_d_48
    s_cbranch_vccz L_k2_h_d_48
    buffer_load_dword v36, v21, s[20:23], 0 offen sc1
    s_branch L_k2_h_l_47
L_k2_h_d_48:
    ds_write_b32 v29, v29
    s_branch L_k2_lu_46
L_k2_lg_44:
    v_mov_b32 v30, 74240
    s_mov_b32 s66, 0x1000000
L_k2_fl_49:
    ds_read_b32 v31, v30
    s_waitcnt lgkmcnt(0)
    v_cmp_eq_u32 vcc, 0, v31
    s_sub_u32 s66, s66, 1
    s_cbranch_scc1 L_k2_fd_50
    s_cbranch_vccz L_k2_fd_50
    s_sleep 1
    s_branch L_k2_fl_49
L_k2_fd_50:
    s_cmp_eq_u32 s34, 1
    s_cbranch_scc1 L_k2_lz_43
L_k2_lu_46:
    s_mov_b32 s66, 262144
L_k2_u_l_51:
    buffer_load_dwordx4 v[144:147], v16, s[16:19], 0 offen offset:0 sc1
    buffer_load_dwordx4 v[148:151], v16, s[16:19], 0 offen offset:1024 sc1
    buffer_load_dwordx4 v[152:155], v16, s[16:19], 0 offen offset:2048 sc1
    buffer_load_dwordx4 v[156:159], v16, s[16:19], 0 offen offset:3072 sc1
    buffer_load_dwordx4 v[160:163], v17, s[16:19], 0 offen offset:0 sc1
    buffer_load_dwordx4 v[164:167], v17, s[16:19], 0 offen offset:1024 sc1
    buffer_load_dwordx4 v[168:171], v17, s[16:19], 0 offen offset:2048 sc1
    buffer_load_dwordx4 v[172:175], v17, s[16:19], 0 offen offset:3072 sc1
    buffer_load_dwordx4 v[176:179], v18, s[16:19], 0 offen offset:0 sc1
    buffer_load_dwordx4 v[180:183], v18, s[16:19], 0 offen offset:1024 sc1
    buffer_load_dwordx4 v[184:187], v18, s[16:19], 0 offen offset:2048 sc1
    buffer_load_dwordx4 v[188:191], v18, s[16:19], 0 offen offset:3072 sc1
    buffer_load_dwordx4 v[192:195], v19, s[16:19], 0 offen offset:0 sc1
    buffer_load_dwordx4 v[196:199], v19, s[16:19], 0 offen offset:1024 sc1
    buffer_load_dwordx4 v[200:203], v19, s[16:19], 0 offen offset:2048 sc1
    buffer_load_dwordx4 v[204:207], v19, s[16:19], 0 offen offset:3072 sc1
    s_waitcnt vmcnt(15)
    v_lshlrev_b32 v64, 16, v144
    v_and_b32 v65, 0xffff0000, v144
    v_lshlrev_b32 v66, 16, v145
    v_and_b32 v67, 0xffff0000, v145
    v_lshlrev_b32 v68, 16, v146
    v_and_b32 v69, 0xffff0000, v146
    v_lshlrev_b32 v70, 16, v147
    v_and_b32 v71, 0xffff0000, v147
    s_waitcnt vmcnt(14)
    v_lshlrev_b32 v72, 16, v148
    v_and_b32 v73, 0xffff0000, v148
    v_lshlrev_b32 v74, 16, v149
    v_and_b32 v75, 0xffff0000, v149
    v_lshlrev_b32 v76, 16, v150
    v_and_b32 v77, 0xffff0000, v150
    v_lshlrev_b32 v78, 16, v151
    v_and_b32 v79, 0xffff0000, v151
    v_pk_add_f32 v[64:65], v[64:65], v[72:73]
    v_pk_add_f32 v[66:67], v[66:67], v[74:75]
    v_pk_add_f32 v[68:69], v[68:69], v[76:77]
    v_pk_add_f32 v[70:71], v[70:71], v[78:79]
    s_waitcnt vmcnt(13)
    v_lshlrev_b32 v72, 16, v152
    v_and_b32 v73, 0xffff0000, v152
    v_lshlrev_b32 v74, 16, v153
    v_and_b32 v75, 0xffff0000, v153
    v_lshlrev_b32 v76, 16, v154
    v_and_b32 v77, 0xffff0000, v154
    v_lshlrev_b32 v78, 16, v155
    v_and_b32 v79, 0xffff0000, v155
    v_pk_add_f32 v[64:65], v[64:65], v[72:73]
    v_pk_add_f32 v[66:67], v[66:67], v[74:75]
    v_pk_add_f32 v[68:69], v[68:69], v[76:77]
    v_pk_add_f32 v[70:71], v[70:71], v[78:79]
    s_waitcnt vmcnt(12)
    v_lshlrev_b32 v72, 16, v156
    v_and_b32 v73, 0xffff0000, v156
    v_lshlrev_b32 v74, 16, v157
    v_and_b32 v75, 0xffff0000, v157
    v_lshlrev_b32 v76, 16, v158
    v_and_b32 v77, 0xffff0000, v158
    v_lshlrev_b32 v78, 16, v159
    v_and_b32 v79, 0xffff0000, v159
    v_pk_add_f32 v[64:65], v[64:65], v[72:73]
    v_pk_add_f32 v[66:67], v[66:67], v[74:75]
    v_pk_add_f32 v[68:69], v[68:69], v[76:77]
    v_pk_add_f32 v[70:71], v[70:71], v[78:79]
    s_waitcnt vmcnt(11)
    v_lshlrev_b32 v72, 16, v160
    v_and_b32 v73, 0xffff0000, v160
    v_lshlrev_b32 v74, 16, v161
    v_and_b32 v75, 0xffff0000, v161
    v_lshlrev_b32 v76, 16, v162
    v_and_b32 v77, 0xffff0000, v162
    v_lshlrev_b32 v78, 16, v163
    v_and_b32 v79, 0xffff0000, v163
    v_pk_add_f32 v[64:65], v[64:65], v[72:73]
    v_pk_add_f32 v[66:67], v[66:67], v[74:75]
    v_pk_add_f32 v[68:69], v[68:69], v[76:77]
    v_pk_add_f32 v[70:71], v[70:71], v[78:79]
    s_waitcnt vmcnt(10)
    v_lshlrev_b32 v72, 16, v164
    v_and_b32 v73, 0xffff0000, v164
    v_lshlrev_b32 v74, 16, v165
    v_and_b32 v75, 0xffff0000, v165
    v_lshlrev_b32 v76, 16, v166
    v_and_b32 v77, 0xffff0000, v166
    v_lshlrev_b32 v78, 16, v167
    v_and_b32 v79, 0xffff0000, v167
    v_pk_add_f32 v[64:65], v[64:65], v[72:73]
    v_pk_add_f32 v[66:67], v[66:67], v[74:75]
    v_pk_add_f32 v[68:69], v[68:69], v[76:77]
    v_pk_add_f32 v[70:71], v[70:71], v[78:79]
    s_waitcnt vmcnt(9)
    v_lshlrev_b32 v72, 16, v168
    v_and_b32 v73, 0xffff0000, v168
    v_lshlrev_b32 v74, 16, v169
    v_and_b32 v75, 0xffff0000, v169
    v_lshlrev_b32 v76, 16, v170
    v_and_b32 v77, 0xffff0000, v170
    v_lshlrev_b32 v78, 16, v171
    v_and_b32 v79, 0xffff0000, v171
    v_pk_add_f32 v[64:65], v[64:65], v[72:73]
    v_pk_add_f32 v[66:67], v[66:67], v[74:75]
    v_pk_add_f32 v[68:69], v[68:69], v[76:77]
    v_pk_add_f32 v[70:71], v[70:71], v[78:79]
    s_waitcnt vmcnt(8)
    v_lshlrev_b32 v72, 16, v172
    v_and_b32 v73, 0xffff0000, v172
    v_lshlrev_b32 v74, 16, v173
    v_and_b32 v75, 0xffff0000, v173
    v_lshlrev_b32 v76, 16, v174
    v_and_b32 v77, 0xffff0000, v174
    v_lshlrev_b32 v78, 16, v175
    v_and_b32 v79, 0xffff0000, v175
    v_pk_add_f32 v[64:65], v[64:65], v[72:73]
    v_pk_add_f32 v[66:67], v[66:67], v[74:75]
    v_pk_add_f32 v[68:69], v[68:69], v[76:77]
    v_pk_add_f32 v[70:71], v[70:71], v[78:79]
    s_waitcnt vmcnt(7)
    v_lshlrev_b32 v72, 16, v176
    v_and_b32 v73, 0xffff0000, v176
    v_lshlrev_b32 v74, 16, v177
    v_and_b32 v75, 0xffff0000, v177
    v_lshlrev_b32 v76, 16, v178
    v_and_b32 v77, 0xffff0000, v178
    v_lshlrev_b32 v78, 16, v179
    v_and_b32 v79, 0xffff0000, v179
    v_pk_add_f32 v[64:65], v[64:65], v[72:73]
    v_pk_add_f32 v[66:67], v[66:67], v[74:75]
    v_pk_add_f32 v[68:69], v[68:69], v[76:77]
    v_pk_add_f32 v[70:71], v[70:71], v[78:79]
    s_waitcnt vmcnt(6)
    v_lshlrev_b32 v72, 16, v180
    v_and_b32 v73, 0xffff0000, v180
    v_lshlrev_b32 v74, 16, v181
    v_and_b32 v75, 0xffff0000, v181
    v_lshlrev_b32 v76, 16, v182
    v_and_b32 v77, 0xffff0000, v182
    v_lshlrev_b32 v78, 16, v183
    v_and_b32 v79, 0xffff0000, v183
    v_pk_add_f32 v[64:65], v[64:65], v[72:73]
    v_pk_add_f32 v[66:67], v[66:67], v[74:75]
    v_pk_add_f32 v[68:69], v[68:69], v[76:77]
    v_pk_add_f32 v[70:71], v[70:71], v[78:79]
    s_waitcnt vmcnt(5)
    v_lshlrev_b32 v72, 16, v184
    v_and_b32 v73, 0xffff0000, v184
    v_lshlrev_b32 v74, 16, v185
    v_and_b32 v75, 0xffff0000, v185
    v_lshlrev_b32 v76, 16, v186
    v_and_b32 v77, 0xffff0000, v186
    v_lshlrev_b32 v78, 16, v187
    v_and_b32 v79, 0xffff0000, v187
    v_pk_add_f32 v[64:65], v[64:65], v[72:73]
    v_pk_add_f32 v[66:67], v[66:67], v[74:75]
    v_pk_add_f32 v[68:69], v[68:69], v[76:77]
    v_pk_add_f32 v[70:71], v[70:71], v[78:79]
    s_waitcnt vmcnt(4)
    v_lshlrev_b32 v72, 16, v188
    v_and_b32 v73, 0xffff0000, v188
    v_lshlrev_b32 v74, 16, v189
    v_and_b32 v75, 0xffff0000, v189
    v_lshlrev_b32 v76, 16, v190
    v_and_b32 v77, 0xffff0000, v190
    v_lshlrev_b32 v78, 16, v191
    v_and_b32 v79, 0xffff0000, v191
    v_pk_add_f32 v[64:65], v[64:65], v[72:73]
    v_pk_add_f32 v[66:67], v[66:67], v[74:75]
    v_pk_add_f32 v[68:69], v[68:69], v[76:77]
    v_pk_add_f32 v[70:71], v[70:71], v[78:79]
    s_waitcnt vmcnt(3)
    v_lshlrev_b32 v72, 16, v192
    v_and_b32 v73, 0xffff0000, v192
    v_lshlrev_b32 v74, 16, v193
    v_and_b32 v75, 0xffff0000, v193
    v_lshlrev_b32 v76, 16, v194
    v_and_b32 v77, 0xffff0000, v194
    v_lshlrev_b32 v78, 16, v195
    v_and_b32 v79, 0xffff0000, v195
    v_pk_add_f32 v[64:65], v[64:65], v[72:73]
    v_pk_add_f32 v[66:67], v[66:67], v[74:75]
    v_pk_add_f32 v[68:69], v[68:69], v[76:77]
    v_pk_add_f32 v[70:71], v[70:71], v[78:79]
    s_waitcnt vmcnt(2)
    v_lshlrev_b32 v72, 16, v196
    v_and_b32 v73, 0xffff0000, v196
    v_lshlrev_b32 v74, 16, v197
    v_and_b32 v75, 0xffff0000, v197
    v_lshlrev_b32 v76, 16, v198
    v_and_b32 v77, 0xffff0000, v198
    v_lshlrev_b32 v78, 16, v199
    v_and_b32 v79, 0xffff0000, v199
    v_pk_add_f32 v[64:65], v[64:65], v[72:73]
    v_pk_add_f32 v[66:67], v[66:67], v[74:75]
    v_pk_add_f32 v[68:69], v[68:69], v[76:77]
    v_pk_add_f32 v[70:71], v[70:71], v[78:79]
    s_waitcnt vmcnt(1)
    v_lshlrev_b32 v72, 16, v200
    v_and_b32 v73, 0xffff0000, v200
    v_lshlrev_b32 v74, 16, v201
    v_and_b32 v75, 0xffff0000, v201
    v_lshlrev_b32 v76, 16, v202
    v_and_b32 v77, 0xffff0000, v202
    v_lshlrev_b32 v78, 16, v203
    v_and_b32 v79, 0xffff0000, v203
    v_pk_add_f32 v[64:65], v[64:65], v[72:73]
    v_pk_add_f32 v[66:67], v[66:67], v[74:75]
    v_pk_add_f32 v[68:69], v[68:69], v[76:77]
    v_pk_add_f32 v[70:71], v[70:71], v[78:79]
    s_waitcnt vmcnt(0)
    v_lshlrev_b32 v72, 16, v204
    v_and_b32 v73, 0xffff0000, v204
    v_lshlrev_b32 v74, 16, v205
    v_and_b32 v75, 0xffff0000, v205
    v_lshlrev_b32 v76, 16, v206
    v_and_b32 v77, 0xffff0000, v206
    v_lshlrev_b32 v78, 16, v207
    v_and_b32 v79, 0xffff0000, v207
    v_pk_add_f32 v[64:65], v[64:65], v[72:73]
    v_pk_add_f32 v[66:67], v[66:67], v[74:75]
    v_pk_add_f32 v[68:69], v[68:69], v[76:77]
    v_pk_add_f32 v[70:71], v[70:71], v[78:79]
    v_cmp_u_f32 vcc, v64, v71
    v_cvt_pk_bf16_f32 v76, v64, v65
    v_cvt_pk_bf16_f32 v77, v66, v67
    v_cvt_pk_bf16_f32 v78, v68, v69
    v_cvt_pk_bf16_f32 v79, v70, v71
    s_sub_u32 s66, s66, 1
    s_cbranch_scc1 L_k2_u_d_52
    s_cbranch_vccz L_k2_u_d_52
    s_branch L_k2_u_l_51
L_k2_u_d_52:
    ds_write_b128 v20, v[76:79]
    s_branch L_k2_nr2_45
L_k2_lz_43:
    s_mov_b32 s66, 262144
L_k2_u_l_53:
    buffer_load_dwordx2 v[96:97], v25, s[20:23], 0 offen offset:0 sc1
    buffer_load_dwordx2 v[98:99], v25, s[20:23], 0 offen offset:512 sc1
    buffer_load_dwordx2 v[100:101], v25, s[20:23], 0 offen offset:1024 sc1
    buffer_load_dwordx2 v[102:103], v25, s[20:23], 0 offen offset:1536 sc1
    buffer_load_dwordx2 v[104:105], v25, s[20:23], 0 offen offset:2048 sc1
    buffer_load_dwordx2 v[106:107], v25, s[20:23], 0 offen offset:2560 sc1
    buffer_load_dwordx2 v[108:109], v25, s[20:23], 0 offen offset:3072 sc1
    buffer_load_dwordx2 v[110:111], v25, s[20:23], 0 offen offset:3584 sc1
    buffer_load_dwordx2 v[112:113], v23, s[20:23], 0 offen offset:0 sc1
    buffer_load_dwordx2 v[114:115], v23, s[20:23], 0 offen offset:512 sc1
    buffer_load_dwordx2 v[116:117], v23, s[20:23], 0 offen offset:1024 sc1
    buffer_load_dwordx2 v[118:119], v23, s[20:23], 0 offen offset:1536 sc1
    buffer_load_dwordx2 v[120:121], v23, s[20:23], 0 offen offset:2048 sc1
    buffer_load_dwordx2 v[122:123], v23, s[20:23], 0 offen offset:2560 sc1
    buffer_load_dwordx2 v[124:125], v23, s[20:23], 0 offen offset:3072 sc1
    buffer_load_dwordx2 v[126:127], v23, s[20:23], 0 offen offset:3584 sc1
    buffer_load_dwordx4 v[144:147], v16, s[16:19], 0 offen offset:0 sc1
    buffer_load_dwordx4 v[148:151], v16, s[16:19], 0 offen offset:1024 sc1
    buffer_load_dwordx4 v[152:155], v16, s[16:19], 0 offen offset:2048 sc1
    buffer_load_dwordx4 v[156:159], v16, s[16:19], 0 offen offset:3072 sc1
    buffer_load_dwordx4 v[160:163], v17, s[16:19], 0 offen offset:0 sc1
    buffer_load_dwordx4 v[164:167], v17, s[16:19], 0 offen offset:1024 sc1
    buffer_load_dwordx4 v[168:171], v17, s[16:19], 0 offen offset:2048 sc1
    buffer_load_dwordx4 v[172:175], v17, s[16:19], 0 offen offset:3072 sc1
    buffer_load_dwordx4 v[176:179], v18, s[16:19], 0 offen offset:0 sc1
    buffer_load_dwordx4 v[180:183], v18, s[16:19], 0 offen offset:1024 sc1
    buffer_load_dwordx4 v[184:187], v18, s[16:19], 0 offen offset:2048 sc1
    buffer_load_dwordx4 v[188:191], v18, s[16:19], 0 offen offset:3072 sc1
    buffer_load_dwordx4 v[192:195], v19, s[16:19], 0 offen offset:0 sc1
    buffer_load_dwordx4 v[196:199], v19, s[16:19], 0 offen offset:1024 sc1
    buffer_load_dwordx4 v[200:203], v19, s[16:19], 0 offen offset:2048 sc1
    buffer_load_dwordx4 v[204:207], v19, s[16:19], 0 offen offset:3072 sc1
    s_waitcnt vmcnt(30)
    v_pk_add_f32 v[96:97], v[96:97], v[98:99]
    s_waitcnt vmcnt(29)
    v_pk_add_f32 v[96:97], v[96:97], v[100:101]
    s_waitcnt vmcnt(28)
    v_pk_add_f32 v[96:97], v[96:97], v[102:103]
    s_waitcnt vmcnt(27)
    v_pk_add_f32 v[96:97], v[96:97], v[104:105]
    s_waitcnt vmcnt(26)
    v_pk_add_f32 v[96:97], v[96:97], v[106:107]
    s_waitcnt vmcnt(25)
    v_pk_add_f32 v[96:97], v[96:97], v[108:109]
    s_waitcnt vmcnt(24)
    v_pk_add_f32 v[96:97], v[96:97], v[110:111]
    s_waitcnt vmcnt(23)
    v_pk_add_f32 v[96:97], v[96:97], v[112:113]
    s_waitcnt vmcnt(22)
    v_pk_add_f32 v[96:97], v[96:97], v[114:115]
    s_waitcnt vmcnt(21)
    v_pk_add_f32 v[96:97], v[96:97], v[116:117]
    s_waitcnt vmcnt(20)
    v_pk_add_f32 v[96:97], v[96:97], v[118:119]
    s_waitcnt vmcnt(19)
    v_pk_add_f32 v[96:97], v[96:97], v[120:121]
    s_waitcnt vmcnt(18)
    v_pk_add_f32 v[96:97], v[96:97], v[122:123]
    s_waitcnt vmcnt(17)
    v_pk_add_f32 v[96:97], v[96:97], v[124:125]
    s_waitcnt vmcnt(16)
    v_pk_add_f32 v[96:97], v[96:97], v[126:127]
    v_cvt_pk_bf16_f32 v30, v96, v97
    v_add_f32 v96, v96, v97
    s_waitcnt vmcnt(15)
    v_lshlrev_b32 v64, 16, v144
    v_and_b32 v65, 0xffff0000, v144
    v_lshlrev_b32 v66, 16, v145
    v_and_b32 v67, 0xffff0000, v145
    v_lshlrev_b32 v68, 16, v146
    v_and_b32 v69, 0xffff0000, v146
    v_lshlrev_b32 v70, 16, v147
    v_and_b32 v71, 0xffff0000, v147
    s_waitcnt vmcnt(14)
    v_lshlrev_b32 v72, 16, v148
    v_and_b32 v73, 0xffff0000, v148
    v_lshlrev_b32 v74, 16, v149
    v_and_b32 v75, 0xffff0000, v149
    v_lshlrev_b32 v76, 16, v150
    v_and_b32 v77, 0xffff0000, v150
    v_lshlrev_b32 v78, 16, v151
    v_and_b32 v79, 0xffff0000, v151
    v_pk_add_f32 v[64:65], v[64:65], v[72:73]
    v_pk_add_f32 v[66:67], v[66:67], v[74:75]
    v_pk_add_f32 v[68:69], v[68:69], v[76:77]
    v_pk_add_f32 v[70:71], v[70:71], v[78:79]
    s_waitcnt vmcnt(13)
    v_lshlrev_b32 v72, 16, v152
    v_and_b32 v73, 0xffff0000, v152
    v_lshlrev_b32 v74, 16, v153
    v_and_b32 v75, 0xffff0000, v153
    v_lshlrev_b32 v76, 16, v154
    v_and_b32 v77, 0xffff0000, v154
    v_lshlrev_b32 v78, 16, v155
    v_and_b32 v79, 0xffff0000, v155
    v_pk_add_f32 v[64:65], v[64:65], v[72:73]
    v_pk_add_f32 v[66:67], v[66:67], v[74:75]
    v_pk_add_f32 v[68:69], v[68:69], v[76:77]
    v_pk_add_f32 v[70:71], v[70:71], v[78:79]
    s_waitcnt vmcnt(12)
    v_lshlrev_b32 v72, 16, v156
    v_and_b32 v73, 0xffff0000, v156
    v_lshlrev_b32 v74, 16, v157
    v_and_b32 v75, 0xffff0000, v157
    v_lshlrev_b32 v76, 16, v158
    v_and_b32 v77, 0xffff0000, v158
    v_lshlrev_b32 v78, 16, v159
    v_and_b32 v79, 0xffff0000, v159
    v_pk_add_f32 v[64:65], v[64:65], v[72:73]
    v_pk_add_f32 v[66:67], v[66:67], v[74:75]
    v_pk_add_f32 v[68:69], v[68:69], v[76:77]
    v_pk_add_f32 v[70:71], v[70:71], v[78:79]
    s_waitcnt vmcnt(11)
    v_lshlrev_b32 v72, 16, v160
    v_and_b32 v73, 0xffff0000, v160
    v_lshlrev_b32 v74, 16, v161
    v_and_b32 v75, 0xffff0000, v161
    v_lshlrev_b32 v76, 16, v162
    v_and_b32 v77, 0xffff0000, v162
    v_lshlrev_b32 v78, 16, v163
    v_and_b32 v79, 0xffff0000, v163
    v_pk_add_f32 v[64:65], v[64:65], v[72:73]
    v_pk_add_f32 v[66:67], v[66:67], v[74:75]
    v_pk_add_f32 v[68:69], v[68:69], v[76:77]
    v_pk_add_f32 v[70:71], v[70:71], v[78:79]
    s_waitcnt vmcnt(10)
    v_lshlrev_b32 v72, 16, v164
    v_and_b32 v73, 0xffff0000, v164
    v_lshlrev_b32 v74, 16, v165
    v_and_b32 v75, 0xffff0000, v165
    v_lshlrev_b32 v76, 16, v166
    v_and_b32 v77, 0xffff0000, v166
    v_lshlrev_b32 v78, 16, v167
    v_and_b32 v79, 0xffff0000, v167
    v_pk_add_f32 v[64:65], v[64:65], v[72:73]
    v_pk_add_f32 v[66:67], v[66:67], v[74:75]
    v_pk_add_f32 v[68:69], v[68:69], v[76:77]
    v_pk_add_f32 v[70:71], v[70:71], v[78:79]
    s_waitcnt vmcnt(9)
    v_lshlrev_b32 v72, 16, v168
    v_and_b32 v73, 0xffff0000, v168
    v_lshlrev_b32 v74, 16, v169
    v_and_b32 v75, 0xffff0000, v169
    v_lshlrev_b32 v76, 16, v170
    v_and_b32 v77, 0xffff0000, v170
    v_lshlrev_b32 v78, 16, v171
    v_and_b32 v79, 0xffff0000, v171
    v_pk_add_f32 v[64:65], v[64:65], v[72:73]
    v_pk_add_f32 v[66:67], v[66:67], v[74:75]
    v_pk_add_f32 v[68:69], v[68:69], v[76:77]
    v_pk_add_f32 v[70:71], v[70:71], v[78:79]
    s_waitcnt vmcnt(8)
    v_lshlrev_b32 v72, 16, v172
    v_and_b32 v73, 0xffff0000, v172
    v_lshlrev_b32 v74, 16, v173
    v_and_b32 v75, 0xffff0000, v173
    v_lshlrev_b32 v76, 16, v174
    v_and_b32 v77, 0xffff0000, v174
    v_lshlrev_b32 v78, 16, v175
    v_and_b32 v79, 0xffff0000, v175
    v_pk_add_f32 v[64:65], v[64:65], v[72:73]
    v_pk_add_f32 v[66:67], v[66:67], v[74:75]
    v_pk_add_f32 v[68:69], v[68:69], v[76:77]
    v_pk_add_f32 v[70:71], v[70:71], v[78:79]
    s_waitcnt vmcnt(7)
    v_lshlrev_b32 v72, 16, v176
    v_and_b32 v73, 0xffff0000, v176
    v_lshlrev_b32 v74, 16, v177
    v_and_b32 v75, 0xffff0000, v177
    v_lshlrev_b32 v76, 16, v178
    v_and_b32 v77, 0xffff0000, v178
    v_lshlrev_b32 v78, 16, v179
    v_and_b32 v79, 0xffff0000, v179
    v_pk_add_f32 v[64:65], v[64:65], v[72:73]
    v_pk_add_f32 v[66:67], v[66:67], v[74:75]
    v_pk_add_f32 v[68:69], v[68:69], v[76:77]
    v_pk_add_f32 v[70:71], v[70:71], v[78:79]
    s_waitcnt vmcnt(6)
    v_lshlrev_b32 v72, 16, v180
    v_and_b32 v73, 0xffff0000, v180
    v_lshlrev_b32 v74, 16, v181
    v_and_b32 v75, 0xffff0000, v181
    v_lshlrev_b32 v76, 16, v182
    v_and_b32 v77, 0xffff0000, v182
    v_lshlrev_b32 v78, 16, v183
    v_and_b32 v79, 0xffff0000, v183
    v_pk_add_f32 v[64:65], v[64:65], v[72:73]
    v_pk_add_f32 v[66:67], v[66:67], v[74:75]
    v_pk_add_f32 v[68:69], v[68:69], v[76:77]
    v_pk_add_f32 v[70:71], v[70:71], v[78:79]
    s_waitcnt vmcnt(5)
    v_lshlrev_b32 v72, 16, v184
    v_and_b32 v73, 0xffff0000, v184
    v_lshlrev_b32 v74, 16, v185
    v_and_b32 v75, 0xffff0000, v185
    v_lshlrev_b32 v76, 16, v186
    v_and_b32 v77, 0xffff0000, v186
    v_lshlrev_b32 v78, 16, v187
    v_and_b32 v79, 0xffff0000, v187
    v_pk_add_f32 v[64:65], v[64:65], v[72:73]
    v_pk_add_f32 v[66:67], v[66:67], v[74:75]
    v_pk_add_f32 v[68:69], v[68:69], v[76:77]
    v_pk_add_f32 v[70:71], v[70:71], v[78:79]
    s_waitcnt vmcnt(4)
    v_lshlrev_b32 v72, 16, v188
    v_and_b32 v73, 0xffff0000, v188
    v_lshlrev_b32 v74, 16, v189
    v_and_b32 v75, 0xffff0000, v189
    v_lshlrev_b32 v76, 16, v190
    v_and_b32 v77, 0xffff0000, v190
    v_lshlrev_b32 v78, 16, v191
    v_and_b32 v79, 0xffff0000, v191
    v_pk_add_f32 v[64:65], v[64:65], v[72:73]
    v_pk_add_f32 v[66:67], v[66:67], v[74:75]
    v_pk_add_f32 v[68:69], v[68:69], v[76:77]
    v_pk_add_f32 v[70:71], v[70:71], v[78:79]
    s_waitcnt vmcnt(3)
    v_lshlrev_b32 v72, 16, v192
    v_and_b32 v73, 0xffff0000, v192
    v_lshlrev_b32 v74, 16, v193
    v_and_b32 v75, 0xffff0000, v193
    v_lshlrev_b32 v76, 16, v194
    v_and_b32 v77, 0xffff0000, v194
    v_lshlrev_b32 v78, 16, v195
    v_and_b32 v79, 0xffff0000, v195
    v_pk_add_f32 v[64:65], v[64:65], v[72:73]
    v_pk_add_f32 v[66:67], v[66:67], v[74:75]
    v_pk_add_f32 v[68:69], v[68:69], v[76:77]
    v_pk_add_f32 v[70:71], v[70:71], v[78:79]
    s_waitcnt vmcnt(2)
    v_lshlrev_b32 v72, 16, v196
    v_and_b32 v73, 0xffff0000, v196
    v_lshlrev_b32 v74, 16, v197
    v_and_b32 v75, 0xffff0000, v197
    v_lshlrev_b32 v76, 16, v198
    v_and_b32 v77, 0xffff0000, v198
    v_lshlrev_b32 v78, 16, v199
    v_and_b32 v79, 0xffff0000, v199
    v_pk_add_f32 v[64:65], v[64:65], v[72:73]
    v_pk_add_f32 v[66:67], v[66:67], v[74:75]
    v_pk_add_f32 v[68:69], v[68:69], v[76:77]
    v_pk_add_f32 v[70:71], v[70:71], v[78:79]
    s_waitcnt vmcnt(1)
    v_lshlrev_b32 v72, 16, v200
    v_and_b32 v73, 0xffff0000, v200
    v_lshlrev_b32 v74, 16, v201
    v_and_b32 v75, 0xffff0000, v201
    v_lshlrev_b32 v76, 16, v202
    v_and_b32 v77, 0xffff0000, v202
    v_lshlrev_b32 v78, 16, v203
    v_and_b32 v79, 0xffff0000, v203
    v_pk_add_f32 v[64:65], v[64:65], v[72:73]
    v_pk_add_f32 v[66:67], v[66:67], v[74:75]
    v_pk_add_f32 v[68:69], v[68:69], v[76:77]
    v_pk_add_f32 v[70:71], v[70:71], v[78:79]
    s_waitcnt vmcnt(0)
    v_lshlrev_b32 v72, 16, v204
    v_and_b32 v73, 0xffff0000, v204
    v_lshlrev_b32 v74, 16, v205
    v_and_b32 v75, 0xffff0000, v205
    v_lshlrev_b32 v76, 16, v206
    v_and_b32 v77, 0xffff0000, v206
    v_lshlrev_b32 v78, 16, v207
    v_and_b32 v79, 0xffff0000, v207
    v_pk_add_f32 v[64:65], v[64:65], v[72:73]
    v_pk_add_f32 v[66:67], v[66:67], v[74:75]
    v_pk_add_f32 v[68:69], v[68:69], v[76:77]
    v_pk_add_f32 v[70:71], v[70:71], v[78:79]
    v_add_f32 v72, v64, v96
    v_cmp_u_f32 vcc, v72, v71
    v_cvt_pk_bf16_f32 v76, v64, v65
    v_cvt_pk_bf16_f32 v77, v66, v67
    v_cvt_pk_bf16_f32 v78, v68, v69
    v_cvt_pk_bf16_f32 v79, v70, v71
    s_sub_u32 s66, s66, 1
    s_cbranch_scc1 L_k2_u_d_54
    s_cbranch_vccz L_k2_u_d_54
    s_branch L_k2_u_l_53
L_k2_u_d_54:
    ds_write_b128 v20, v[76:79]
    ds_write_b32 v27, v30
L_k2_nr2_45:
    s_waitcnt lgkmcnt(0)
    s_barrier
L_k2_com_22:
.p2align 3
L_code_k3:
L_phase_k3:
    s_mov_b64 exec, -1
    s_lshr_b32 s6, s2, 3
    s_and_b32 s4, s6, 3
    s_and_b32 s7, s2, 3
    s_lshl_b32 s7, s7, 2
    s_add_u32 s4, s4, s7
    s_lshr_b32 s5, s6, 2
    s_bfe_u32 s7, s2, 0x10002
    s_lshl_b32 s7, s7, 3
    s_add_u32 s5, s5, s7
    s_mul_i32 s6, s4, 524288
    s_add_u32 s6, s6, 0x1000000
    s_add_u32 s8, s62, s6
    s_addc_u32 s9, s63, 0
    s_mov_b32 s10, 0x80000
    s_mov_b32 s11, 0x00020000
    s_mul_i32 s6, s5, 128
    s_sub_u32 s7, 0x200000, s6
    s_and_b32 s14, s5, 7
    s_cmp_eq_u32 s14, 3
    s_cselect_b64 s[12:13], s[62:63], s[42:43]
    s_cselect_b32 s14, 0x5800080, 0
    s_add_u32 s6, s6, s14
    s_add_u32 s12, s12, s6
    s_addc_u32 s13, s13, 0
    s_mov_b32 s14, s7
    s_mov_b32 s15, 0x00020000
    s_lshl_b32 s6, s4, 18
    s_lshl_b32 s7, s5, 7
    s_add_u32 s6, s6, s7
    s_sub_u32 s7, 4194304, s6
    s_add_u32 s16, s36, s6
    s_addc_u32 s17, s37, 0
    s_mov_b32 s18, s7
    s_mov_b32 s19, 0x00020000
    s_add_u32 s32, s6, 0x4800000
    s_add_u32 s20, s62, s32
    s_addc_u32 s21, s63, 0
    s_mov_b32 s22, s7
    s_mov_b32 s23, 0x00020000
    s_add_u32 s6, s5, 4
    s_mul_i32 s6, s6, 37
    s_lshr_b32 s6, s6, 8
    s_add_u32 s32, s5, s6
    s_lshl_b32 s32, s32, 7
    s_lshl_b32 s6, s4, 19
    s_add_u32 s32, s32, s6
    s_add_u32 s32, s32, 0x3800000
    s_add_u32 s72, s62, s32
    s_addc_u32 s73, s63, 0
    s_mov_b32 s74, 0x80000
    s_mov_b32 s75, 0x00020000
    s_lshl_b32 s6, s4, 9
    s_add_u32 s6, s6, 0xc000
    s_add_u32 s28, s62, s6
    s_addc_u32 s29, s63, 0
    s_mov_b32 s30, 0x2200
    s_mov_b32 s31, 0x00020000
    s_lshl_b32 s6, s5, 8
    s_add_u32 s6, s6, 98304
    s_add_u32 s24, s62, s6
    s_addc_u32 s25, s63, 0
    s_mov_b32 s26, 0x2100
    s_mov_b32 s27, 0x00020000
    s_movk_i32 s96, 0x4000
    s_mov_b32 s97, 0x8000
    s_movk_i32 s98, 0x2000
    s_cmp_ge_u32 s3, 4
    s_cbranch_scc1 L_k3_ldr_55
    s_setprio 2
    v_and_b32 v1, 63, v0
    s_mul_i32 s34, s3, 32
    s_mov_b32 s35, 0
    v_and_b32 v10, 31, v1
    v_bfe_u32 v11, v1, 1, 3
    v_lshrrev_b32 v12, 5, v1
    v_xor_b32 v11, v11, v12
    v_add_u32 v10, s34, v10
    v_lshlrev_b32 v10, 7, v10
    v_lshl_add_u32 v2, v11, 4, v10
    v_xor_b32 v3, 32, v2
    v_xor_b32 v4, 64, v2
    v_xor_b32 v5, 96, v2
    v_bfe_u32 v10, v1, 2, 2
    v_lshl_add_u32 v10, v12, 3, v10
    v_bfe_u32 v11, v1, 4, 1
    v_lshlrev_b32 v11, 5, v11
    v_and_b32 v13, 1, v1
    v_lshl_add_u32 v11, v13, 4, v11
    v_bfe_u32 v13, v1, 1, 1
    v_lshl_add_u32 v11, v13, 3, v11
    v_bfe_u32 v13, v1, 3, 1
    v_lshl_add_u32 v11, v13, 6, v11
    v_lshl_add_u32 v6, v10, 7, v11
    v_xor_b32 v7, 64, v6
    v_and_b32 v10, 31, v1
    v_add_u32 v10, s34, v10
    v_lshrrev_b32 v136, 5, v1
    v_lshlrev_b32 v136, 1, v136
    v_and_b32 v137, 7, v1
    v_xor_b32 v136, v136, v137
    v_lshlrev_b32 v136, 4, v136
    v_lshl_add_u32 v136, v10, 8, v136
    v_xor_b32 v137, 16, v136
    v_xor_b32 v138, 64, v136
    v_xor_b32 v139, 80, v136
    v_lshrrev_b32 v240, 0, v1
    v_min_u32 v240, 15, v240
    s_lshl_b32 s6, s4, 7
    s_add_u32 s6, s6, 0
    v_lshl_add_u32 v240, v240, 2, s6
    v_mov_b32 v40, 0
    v_mov_b32 v41, 0
    v_mov_b32 v42, 0
    v_mov_b32 v43, 0
    v_mov_b32 v44, 0
    v_mov_b32 v45, 0
    v_mov_b32 v46, 0
    v_mov_b32 v47, 0
    v_mov_b32 v48, 0
    v_mov_b32 v49, 0
    v_mov_b32 v50, 0
    v_mov_b32 v51, 0
    v_mov_b32 v52, 0
    v_mov_b32 v53, 0
    v_mov_b32 v54, 0
    v_mov_b32 v55, 0
    v_mov_b32 v56, 0
    v_mov_b32 v57, 0
    v_mov_b32 v58, 0
    v_mov_b32 v59, 0
    v_mov_b32 v60, 0
    v_mov_b32 v61, 0
    v_mov_b32 v62, 0
    v_mov_b32 v63, 0
    v_mov_b32 v64, 0
    v_mov_b32 v65, 0
    v_mov_b32 v66, 0
    v_mov_b32 v67, 0
    v_mov_b32 v68, 0
    v_mov_b32 v69, 0
    v_mov_b32 v70, 0
    v_mov_b32 v71, 0
    s_waitcnt vmcnt(0)
    s_barrier
    s_add_u32 s68, s62, 0xc0000
    s_addc_u32 s69, s63, 0
    s_mov_b32 s70, 0x6000
    s_mov_b32 s71, 0x00020000
    v_mov_b32 v10, 0
    s_cmp_eq_u32 s3, 0
    s_cselect_b64 exec, 1, 0
    buffer_store_dword v10, v10, s[68:71], s100 offen sc1
    s_mov_b64 exec, -1
    s_cmp_lg_u32 s3, 1
    s_cbranch_scc1 L_k3_np_57
    s_mov_b32 s66, 262144
L_k3_dl_58:
    buffer_load_dword v242, v240, s[68:71], 0 offen sc1
    s_waitcnt vmcnt(0)
    v_cmp_ne_u32 vcc, -1, v242
    s_and_b32 s67, vcc_lo, 0xffff
    s_sub_u32 s66, s66, 1
    s_cselect_b32 s67, 0xffff, s67
    s_bcnt1_i32_b32 s6, s67
    s_cmp_ge_u32 s6, 8
    s_cbranch_scc1 L_k3_dd_59
    s_sleep 1
    s_branch L_k3_dl_58
L_k3_dd_59:
    v_mov_b32 v240, s67
    v_mov_b32 v241, 163832
    ds_write_b32 v241, v240
    s_waitcnt lgkmcnt(0)
L_k3_np_57:
    s_barrier
    s_lshl_b32 s100, s4, 7
    s_lshl_b32 s6, s5, 2
    s_add_u32 s100, s100, s6
    s_add_u32 s100, s100, 2048
    s_mov_b32 s64, 0
    s_mov_b32 s67, 24576
    s_mov_b32 s6, 16
    s_barrier
    ds_read_b64_tr_b16 v[20:21], v6 offset:16384
    ds_read_b64_tr_b16 v[22:23], v6 offset:16896
    ds_read_b128 v[16:19], v2 offset:0
    ds_read_b64_tr_b16 v[24:25], v7 offset:16384
    ds_read_b64_tr_b16 v[26:27], v7 offset:16896
    v_lshrrev_b32 v10, 3, v1
    s_lshl_b32 s32, s3, 4
    v_add_u32 v97, s32, v10
    v_and_b32 v98, 7, v1
    v_lshlrev_b32 v98, 1, v98
    v_xor_b32 v98, v98, v10
    v_lshlrev_b32 v98, 4, v98
    v_lshl_add_u32 v98, v97, 8, v98
    v_xor_b32 v99, 16, v98
    v_and_b32 v11, 7, v1
    v_lshlrev_b32 v12, 5, v11
    v_lshlrev_b32 v11, 4, v11
    v_lshl_add_u32 v96, v97, 11, v11
    v_lshl_add_u32 v97, v97, 12, v11
    buffer_load_dwordx4 v[72:75], v96, s[16:19], 0 offen sc1
    buffer_load_dwordx4 v[76:79], v96, s[16:19], s96 offen sc1
    v_add_u32 v102, 98304, v12
    v_and_b32 v11, 7, v1
    v_lshlrev_b32 v11, 5, v11
    v_lshl_add_u32 v101, v10, 2, v11
    v_and_b32 v11, 15, v1
    v_bfe_u32 v10, v1, 4, 1
    s_lshl_b32 s32, s3, 6
    v_lshl_add_u32 v11, v11, 2, s32
    v_lshl_add_u32 v100, v10, 13, v11
.p2align 4
L_k3_cl_60:
    s_add_u32 s64, s64, 24576
    s_cmp_eq_u32 s64, 98304
    s_cselect_b32 s65, 0xfffee000, s67
    s_cselect_b32 s64, 0, s64
    s_waitcnt lgkmcnt(0)
    v_mfma_f32_32x32x16_bf16 v[40:55], v[20:23], v[16:19], v[40:55]
    ds_read_b64_tr_b16 v[32:33], v6 offset:18432
    ds_read_b64_tr_b16 v[34:35], v6 offset:18944
    ds_read_b128 v[28:31], v3 offset:0
    ds_read_b64_tr_b16 v[36:37], v7 offset:18432
    ds_read_b64_tr_b16 v[38:39], v7 offset:18944
    v_add_u32 v3, s65, v3
    v_add_u32 v2, s65, v2
    v_mfma_f32_32x32x16_bf16 v[56:71], v[24:27], v[16:19], v[56:71]
    s_waitcnt lgkmcnt(0)
    v_mfma_f32_32x32x16_bf16 v[40:55], v[32:35], v[28:31], v[40:55]
    ds_read_b64_tr_b16 v[20:21], v6 offset:20480
    ds_read_b64_tr_b16 v[22:23], v6 offset:20992
    ds_read_b128 v[16:19], v4 offset:0
    ds_read_b64_tr_b16 v[24:25], v7 offset:20480
    ds_read_b64_tr_b16 v[26:27], v7 offset:20992
    v_add_u32 v4, s65, v4
    v_mfma_f32_32x32x16_bf16 v[56:71], v[36:39], v[28:31], v[56:71]
    s_waitcnt lgkmcnt(0)
    v_mfma_f32_32x32x16_bf16 v[40:55], v[20:23], v[16:19], v[40:55]
    ds_read_b64_tr_b16 v[32:33], v6 offset:22528
    ds_read_b64_tr_b16 v[34:35], v6 offset:23040
    ds_read_b128 v[28:31], v5 offset:0
    ds_read_b64_tr_b16 v[36:37], v7 offset:22528
    ds_read_b64_tr_b16 v[38:39], v7 offset:23040
    v_add_u32 v5, s65, v5
    v_add_u32 v6, s65, v6
    v_add_u32 v7, s65, v7
    v_mfma_f32_32x32x16_bf16 v[56:71], v[24:27], v[16:19], v[56:71]
    s_waitcnt lgkmcnt(0)
    v_mfma_f32_32x32x16_bf16 v[40:55], v[32:35], v[28:31], v[40:55]
    s_sub_u32 s6, s6, 1
    s_barrier
    ds_read_b64_tr_b16 v[20:21], v6 offset:16384
    ds_read_b64_tr_b16 v[22:23], v6 offset:16896
    ds_read_b128 v[16:19], v2 offset:0
    ds_read_b64_tr_b16 v[24:25], v7 offset:16384
    ds_read_b64_tr_b16 v[26:27], v7 offset:16896
    v_mfma_f32_32x32x16_bf16 v[56:71], v[36:39], v[28:31], v[56:71]
    s_cmp_lg_u32 s6, 0
    s_cbranch_scc1 L_k3_cl_60
    s_waitcnt lgkmcnt(0)
    s_nop 10
    ds_write_b128 v136, v[40:43] offset:0
    ds_write_b128 v137, v[44:47] offset:0
    ds_write_b128 v138, v[48:51] offset:0
    ds_write_b128 v139, v[52:55] offset:0
    ds_write_b128 v136, v[56:59] offset:128
    ds_write_b128 v137, v[60:63] offset:128
    ds_write_b128 v138, v[64:67] offset:128
    ds_write_b128 v139, v[68:71] offset:128
    s_setprio 0
    s_waitcnt vmcnt(0)
    s_branch L_k3_com_61
L_k3_ldr_55:
    s_sub_u32 s34, s3, 4
    v_and_b32 v1, 63, v0
    v_lshrrev_b32 v2, 3, v1
    v_and_b32 v3, 7, v1
    s_lshl_b32 s6, s34, 3
    v_add_u32 v2, s6, v2
    v_bfe_u32 v4, v2, 1, 3
    v_xor_b32 v4, v4, v3
    s_mov_b32 s6, 4096
    v_mul_lo_u32 v5, s6, v2
    v_lshl_add_u32 v16, v4, 4, v5
    v_add_u32 v17, 131072, v16
    v_add_u32 v18, 131072, v17
    v_add_u32 v19, 131072, v18
    v_bfe_u32 v4, v2, 1, 1
    v_lshlrev_b32 v4, 2, v4
    v_xor_b32 v4, v4, v3
    s_mov_b32 s6, 2048
    v_mul_lo_u32 v5, s6, v2
    v_lshl_add_u32 v5, v4, 4, v5
    v_add_u32 v20, 0, v5
    v_add_u32 v21, 65536, v20
    s_lshl_b32 s64, s34, 10
    s_add_u32 s65, s64, 98304
    s_mov_b32 s7, 0
    s_mov_b32 s33, 0
    s_setprio 0
    s_barrier
    s_mov_b32 s6, 0
    s_add_u32 m0, s64, 16384
    s_nop 0
    buffer_load_dwordx4 v20, s[12:15], s6 offen lds
    s_add_u32 m0, s64, 20480
    s_nop 0
    buffer_load_dwordx4 v21, s[12:15], s6 offen lds
    s_mov_b32 s6, 131072
    s_add_u32 m0, s64, 40960
    s_nop 0
    buffer_load_dwordx4 v20, s[12:15], s6 offen lds
    s_add_u32 m0, s64, 45056
    s_nop 0
    buffer_load_dwordx4 v21, s[12:15], s6 offen lds
    s_mov_b32 s6, 262144
    s_add_u32 m0, s64, 65536
    s_nop 0
    buffer_load_dwordx4 v20, s[12:15], s6 offen lds
    s_add_u32 m0, s64, 69632
    s_nop 0
    buffer_load_dwordx4 v21, s[12:15], s6 offen lds
    v_lshrrev_b32 v30, 0, v1
    v_min_u32 v30, 15, v30
    s_lshl_b32 s6, s4, 7
    s_add_u32 s6, s6, 0
    v_lshl_add_u32 v30, v30, 2, s6
    v_mov_b32 v32, -1
    v_mov_b32 v33, -1
    v_mov_b32 v34, -1
    v_mov_b32 v35, -1
    v_mov_b32 v36, 163832
    s_barrier
    ds_read_b32 v36, v36
    s_waitcnt lgkmcnt(0)
    v_readfirstlane_b32 s99, v36
    s_andn2_b32 s101, 0xffff, s99
    s_and_b32 s6, s101, 7
    s_cbranch_scc1 L_k3_slow_64
    s_mov_b32 s6, 0
    s_add_u32 m0, s64, 0
    s_nop 0
    buffer_load_dwordx4 v16, s[8:11], s6 offen sc1 lds
    s_add_u32 m0, s64, 4096
    s_nop 0
    buffer_load_dwordx4 v17, s[8:11], s6 offen sc1 lds
    s_add_u32 m0, s64, 8192
    s_nop 0
    buffer_load_dwordx4 v18, s[8:11], s6 offen sc1 lds
    s_add_u32 m0, s64, 12288
    s_nop 0
    buffer_load_dwordx4 v19, s[8:11], s6 offen sc1 lds
    s_mov_b32 s6, 128
    s_add_u32 m0, s64, 24576
    s_nop 0
    buffer_load_dwordx4 v16, s[8:11], s6 offen sc1 lds
    s_add_u32 m0, s64, 28672
    s_nop 0
    buffer_load_dwordx4 v17, s[8:11], s6 offen sc1 lds
    s_add_u32 m0, s64, 32768
    s_nop 0
    buffer_load_dwordx4 v18, s[8:11], s6 offen sc1 lds
    s_add_u32 m0, s64, 36864
    s_nop 0
    buffer_load_dwordx4 v19, s[8:11], s6 offen sc1 lds
    s_mov_b32 s6, 256
    s_add_u32 m0, s64, 49152
    s_nop 0
    buffer_load_dwordx4 v16, s[8:11], s6 offen sc1 lds
    s_add_u32 m0, s64, 53248
    s_nop 0
    buffer_load_dwordx4 v17, s[8:11], s6 offen sc1 lds
    s_add_u32 m0, s64, 57344
    s_nop 0
    buffer_load_dwordx4 v18, s[8:11], s6 offen sc1 lds
    s_add_u32 m0, s64, 61440
    s_nop 0
    buffer_load_dwordx4 v19, s[8:11], s6 offen sc1 lds
    s_andn2_b32 s99, s99, 7
L_k3_pdone_63:
    s_ff1_i32_b32 s6, s99
    s_bitset0_b32 s99, s6
    s_mul_i32 s33, s6, 131072
    s_add_u32 s7, s6, 4
    s_mul_i32 s7, s7, 37
    s_lshr_b32 s7, s7, 8
    s_add_u32 s7, s6, s7
    s_lshl_b32 s7, s7, 7
    s_add_u32 s64, s64, 73728
    s_lshl_b32 s100, s4, 7
    s_lshl_b32 s6, s5, 2
    s_add_u32 s100, s100, s6
    s_add_u32 s100, s100, 2048
    v_and_b32 v2, 255, v0
    v_lshlrev_b32 v2, 7, v2
    s_getpc_b64 s[68:69]
L_pc_65:
    s_sub_u32 s68, s68, L_pc_65-L_code_k3
    s_subb_u32 s69, s69, 0
    s_mov_b32 s70, L_code_k5-L_code_k3
    s_mov_b32 s71, 0x00020000
    buffer_load_dword v3, v2, s[68:71], 0 offen
    s_add_u32 s68, s62, 0xc0000
    s_addc_u32 s69, s63, 0
    s_mov_b32 s70, 0x6000
    s_mov_b32 s71, 0x00020000
    v_lshrrev_b32 v38, 2, v1
    v_lshlrev_b32 v38, 7, v38
    v_and_b32 v39, 3, v1
    v_lshl_add_u32 v38, v39, 4, v38
    s_waitcnt vmcnt(9)
    s_barrier
    s_add_u32 m0, s64, 0
    s_nop 0
    buffer_load_dwordx4 v16, s[8:11], s7 offen sc1 lds
    s_add_u32 m0, s64, 4096
    s_nop 0
    buffer_load_dwordx4 v17, s[8:11], s7 offen sc1 lds
    s_add_u32 m0, s64, 8192
    s_nop 0
    buffer_load_dwordx4 v18, s[8:11], s7 offen sc1 lds
    s_add_u32 m0, s64, 12288
    s_nop 0
    buffer_load_dwordx4 v19, s[8:11], s7 offen sc1 lds
    s_add_u32 m0, s64, 16384
    s_nop 0
    buffer_load_dwordx4 v20, s[12:15], s33 offen lds
    s_add_u32 m0, s64, 20480
    s_nop 0
    buffer_load_dwordx4 v21, s[12:15], s33 offen lds
    s_cmp_eq_u32 s99, 0
    s_cbranch_scc1 L_k3_lt_66
L_k3_ltb_67:
    s_ff1_i32_b32 s6, s99
    s_bitset0_b32 s99, s6
    s_mul_i32 s33, s6, 131072
    s_add_u32 s7, s6, 4
    s_mul_i32 s7, s7, 37
    s_lshr_b32 s7, s7, 8
    s_add_u32 s7, s6, s7
    s_lshl_b32 s7, s7, 7
    s_bcnt1_i32_b32 s6, s99
    s_cmp_eq_u32 s6, 2
    s_cbranch_scc1 L_k3_pp_68
L_k3_ppb_69:
    s_add_u32 s64, s64, 24576
    s_cmp_eq_u32 s64, s65
    s_cselect_b32 s6, 98304, 0
    s_sub_u32 s64, s64, s6
    s_waitcnt vmcnt(11)
    s_barrier
    s_add_u32 m0, s64, 0
    s_nop 0
    buffer_load_dwordx4 v16, s[8:11], s7 offen sc1 lds
    s_add_u32 m0, s64, 4096
    s_nop 0
    buffer_load_dwordx4 v17, s[8:11], s7 offen sc1 lds
    s_add_u32 m0, s64, 8192
    s_nop 0
    buffer_load_dwordx4 v18, s[8:11], s7 offen sc1 lds
    s_add_u32 m0, s64, 12288
    s_nop 0
    buffer_load_dwordx4 v19, s[8:11], s7 offen sc1 lds
    s_add_u32 m0, s64, 16384
    s_nop 0
    buffer_load_dwordx4 v20, s[12:15], s33 offen lds
    s_add_u32 m0, s64, 20480
    s_nop 0
    buffer_load_dwordx4 v21, s[12:15], s33 offen lds
    s_cmp_eq_u32 s99, 0
    s_cbranch_scc1 L_k3_lt_70
L_k3_ltb_71:
    s_ff1_i32_b32 s6, s99
    s_bitset0_b32 s99, s6
    s_mul_i32 s33, s6, 131072
    s_add_u32 s7, s6, 4
    s_mul_i32 s7, s7, 37
    s_lshr_b32 s7, s7, 8
    s_add_u32 s7, s6, s7
    s_lshl_b32 s7, s7, 7
    s_bcnt1_i32_b32 s6, s99
    s_cmp_eq_u32 s6, 2
    s_cbranch_scc1 L_k3_pp_72
L_k3_ppb_73:
    s_add_u32 s64, s64, 24576
    s_cmp_eq_u32 s64, s65
    s_cselect_b32 s6, 98304, 0
    s_sub_u32 s64, s64, s6
    s_mov_b32 s66, 11
.p2align 4
L_k3_ll_74:
    s_waitcnt vmcnt(12)
    s_barrier
    s_add_u32 m0, s64, 0
    s_nop 0
    buffer_load_dwordx4 v16, s[8:11], s7 offen sc1 lds
    s_add_u32 m0, s64, 4096
    s_nop 0
    buffer_load_dwordx4 v17, s[8:11], s7 offen sc1 lds
    s_add_u32 m0, s64, 8192
    s_nop 0
    buffer_load_dwordx4 v18, s[8:11], s7 offen sc1 lds
    s_add_u32 m0, s64, 12288
    s_nop 0
    buffer_load_dwordx4 v19, s[8:11], s7 offen sc1 lds
    s_add_u32 m0, s64, 16384
    s_nop 0
    buffer_load_dwordx4 v20, s[12:15], s33 offen lds
    s_add_u32 m0, s64, 20480
    s_nop 0
    buffer_load_dwordx4 v21, s[12:15], s33 offen lds
    s_cmp_eq_u32 s99, 0
    s_cbranch_scc1 L_k3_lt_75
L_k3_ltb_76:
    s_ff1_i32_b32 s6, s99
    s_bitset0_b32 s99, s6
    s_mul_i32 s33, s6, 131072
    s_add_u32 s7, s6, 4
    s_mul_i32 s7, s7, 37
    s_lshr_b32 s7, s7, 8
    s_add_u32 s7, s6, s7
    s_lshl_b32 s7, s7, 7
    s_bcnt1_i32_b32 s6, s99
    s_cmp_eq_u32 s6, 2
    s_cbranch_scc1 L_k3_pp_77
L_k3_ppb_78:
    s_add_u32 s64, s64, 24576
    s_cmp_eq_u32 s64, s65
    s_cselect_b32 s6, 98304, 0
    s_sub_u32 s64, s64, s6
    s_cmp_eq_u32 s66, 3
    s_cbranch_scc1 L_k3_t_79
L_k3_tb_80:
    s_sub_u32 s66, s66, 1
    s_cmp_lg_u32 s66, 0
    s_cbranch_scc1 L_k3_ll_74
    s_waitcnt vmcnt(12)
    s_barrier
    v_max3_u32 v44, v44, v45, v46
    v_max_u32 v44, v44, v47
    v_cmp_eq_u32 vcc, -1, v44
    s_cbranch_vccz L_fok_81
    s_mov_b32 s32, s66
    s_mov_b32 s66, 262144
L_fl_l_82:
    buffer_load_dwordx4 v[44:47], v38, s[68:71], 0 offen offset:0 sc1
    s_waitcnt vmcnt(0)
    v_max3_u32 v44, v44, v45, v46
    v_max_u32 v44, v44, v47
    v_cmp_eq_u32 vcc, -1, v44
    s_sub_u32 s66, s66, 1
    s_cbranch_scc1 L_fl_d_83
    s_cbranch_vccz L_fl_d_83
    s_sleep 4
    s_branch L_fl_l_82
L_fl_d_83:
    s_mov_b32 s66, s32
L_fok_81:
    v_lshlrev_b32 v9, 2, v1
    buffer_load_dword v40, v9, s[24:27], 0 offen sc1
    buffer_load_dword v41, v9, s[24:27], s98 offen sc1
    v_lshrrev_b32 v10, 3, v1
    s_lshl_b32 s32, s3, 4
    v_add_u32 v97, s32, v10
    v_and_b32 v98, 7, v1
    v_lshlrev_b32 v98, 1, v98
    v_xor_b32 v98, v98, v10
    v_lshlrev_b32 v98, 4, v98
    v_lshl_add_u32 v98, v97, 8, v98
    v_xor_b32 v99, 16, v98
    v_and_b32 v11, 7, v1
    v_lshlrev_b32 v12, 5, v11
    v_lshlrev_b32 v11, 4, v11
    v_lshl_add_u32 v96, v97, 11, v11
    v_lshl_add_u32 v97, v97, 12, v11
    buffer_load_dwordx4 v[72:75], v96, s[16:19], 0 offen sc1
    buffer_load_dwordx4 v[76:79], v96, s[16:19], s96 offen sc1
    v_add_u32 v102, 98304, v12
    v_and_b32 v11, 7, v1
    v_lshlrev_b32 v11, 5, v11
    v_lshl_add_u32 v101, v10, 2, v11
    v_and_b32 v11, 15, v1
    v_bfe_u32 v10, v1, 4, 1
    s_lshl_b32 s32, s3, 6
    v_lshl_add_u32 v11, v11, 2, s32
    v_lshl_add_u32 v100, v10, 13, v11
    s_waitcnt vmcnt(10)
    s_barrier
    s_waitcnt vmcnt(4)
    s_barrier
    s_barrier
    v_add_u32 v9, 98304, v9
    s_lshr_b32 s6, s2, 3
    s_cmp_ge_u32 s6, 14
    s_cselect_b32 s7, 14, 0
    s_cselect_b32 s32, 1, 0
    s_sub_u32 s7, s6, s7
    s_and_b32 s33, s2, 1
    s_lshl_b32 s33, s33, 1
    s_add_u32 s32, s32, s33
    s_cmp_ge_u32 s7, 7
    s_cselect_b32 s33, 21, 0
    s_add_u32 s33, s33, s7
    s_bfe_u32 s6, s2, 0x20001
    s_mul_i32 s6, s6, 7
    s_add_u32 s33, s33, s6
    s_cmp_lt_u32 s7, 14
    s_cselect_b32 s99, -1, 0
    s_lshl_b32 s32, s32, 2
    s_add_u32 s32, s32, s3
    s_sub_u32 s32, s32, 4
    s_lshl_b32 s32, s32, 6
    s_lshl_b32 s6, s32, 2
    s_add_u32 s6, s6, 102400
    s_add_u32 s68, s62, s6
    s_addc_u32 s69, s63, 0
    s_mov_b32 s70, 0x1100
    s_mov_b32 s71, 0x00020000
    s_mul_i32 s6, s32, 7168
    s_lshl_b32 s7, s33, 7
    s_add_u32 s6, s6, s7
    s_and_b32 s7, s99, 458752
    s_add_u32 s8, s46, s6
    s_addc_u32 s9, s47, 0
    s_mov_b32 s10, s7
    s_mov_b32 s11, 0x00020000
    v_lshrrev_b32 v2, 3, v1
    v_and_b32 v3, 7, v1
    v_bfe_u32 v4, v1, 4, 1
    v_lshlrev_b32 v4, 2, v4
    v_xor_b32 v3, v3, v4
    v_mul_u32_u24 v2, 7168, v2
    v_lshl_add_u32 v2, v3, 4, v2
    s_lshl_b32 s7, s3, 13
    s_add_u32 s7, s7, 66560
    s_mov_b32 s6, 0
    s_add_u32 m0, s7, 0
    s_nop 0
    buffer_load_dwordx4 v2, s[8:11], s6 offen lds
    s_add_u32 m0, s7, 1024
    s_add_u32 s6, s6, 57344
    buffer_load_dwordx4 v2, s[8:11], s6 offen lds
    s_add_u32 m0, s7, 2048
    s_add_u32 s6, s6, 57344
    buffer_load_dwordx4 v2, s[8:11], s6 offen lds
    s_add_u32 m0, s7, 3072
    s_add_u32 s6, s6, 57344
    buffer_load_dwordx4 v2, s[8:11], s6 offen lds
    s_add_u32 m0, s7, 4096
    s_add_u32 s6, s6, 57344
    buffer_load_dwordx4 v2, s[8:11], s6 offen lds
    s_add_u32 m0, s7, 5120
    s_add_u32 s6, s6, 57344
    buffer_load_dwordx4 v2, s[8:11], s6 offen lds
    s_add_u32 m0, s7, 6144
    s_add_u32 s6, s6, 57344
    buffer_load_dwordx4 v2, s[8:11], s6 offen lds
    s_add_u32 m0, s7, 7168
    s_add_u32 s6, s6, 57344
    buffer_load_dwordx4 v2, s[8:11], s6 offen lds
    v_lshlrev_b32 v2, 2, v1
    s_movk_i32 s6, 0x1000
    buffer_load_dword v200, v2, s[68:71], s6 offen sc1
    buffer_load_dword v201, v2, s[68:71], 0 offen sc1
    s_waitcnt vmcnt(12)
    v_cvt_pk_bf16_f32 v40, v40, v40
    v_lshlrev_b32 v40, 16, v40
    ds_write_b32 v9, v40
    v_cvt_pk_bf16_f32 v41, v41, v41
    v_lshlrev_b32 v41, 16, v41
    v_add_f32 v41, 1.0, v41
    v_cvt_pk_bf16_f32 v41, v41, v41
    v_lshlrev_b32 v41, 16, v41
    ds_write_b32 v9, v41 offset:256
    s_waitcnt vmcnt(10)
L_k3_com_61:
    s_waitcnt lgkmcnt(0)
    s_barrier
    ds_read_b128 v[80:83], v102 offset:0
    ds_read_b128 v[84:87], v102 offset:16
    ds_read_b128 v[104:107], v98 offset:0
    ds_read_b128 v[108:111], v99 offset:0
    ds_read_b128 v[112:115], v98 offset:2048
    ds_read_b128 v[116:119], v99 offset:2048
    ds_read_b128 v[88:91], v102 offset:256
    ds_read_b128 v[92:95], v102 offset:272
    v_lshlrev_b32 v120, 16, v72
    v_and_b32 v121, 0xffff0000, v72
    v_lshlrev_b32 v122, 16, v73
    v_and_b32 v123, 0xffff0000, v73
    v_lshlrev_b32 v124, 16, v74
    v_and_b32 v125, 0xffff0000, v74
    v_lshlrev_b32 v126, 16, v75
    v_and_b32 v127, 0xffff0000, v75
    v_lshlrev_b32 v128, 16, v76
    v_and_b32 v129, 0xffff0000, v76
    v_lshlrev_b32 v130, 16, v77
    v_and_b32 v131, 0xffff0000, v77
    v_lshlrev_b32 v132, 16, v78
    v_and_b32 v133, 0xffff0000, v78
    v_lshlrev_b32 v134, 16, v79
    v_and_b32 v135, 0xffff0000, v79
    s_waitcnt lgkmcnt(4)
    v_pk_fma_f32 v[104:105], v[104:105], v[80:81], v[120:121]
    v_pk_fma_f32 v[106:107], v[106:107], v[82:83], v[122:123]
    v_pk_fma_f32 v[108:109], v[108:109], v[84:85], v[124:125]
    v_pk_fma_f32 v[110:111], v[110:111], v[86:87], v[126:127]
    v_cvt_pk_bf16_f32 v72, v104, v105
    v_cvt_pk_bf16_f32 v73, v106, v107
    v_cvt_pk_bf16_f32 v74, v108, v109
    v_cvt_pk_bf16_f32 v75, v110, v111
    buffer_store_dwordx4 v[72:75], v96, s[20:23], 0 offen sc1
    s_waitcnt lgkmcnt(2)
    v_pk_fma_f32 v[112:113], v[112:113], v[80:81], v[128:129]
    v_pk_fma_f32 v[114:115], v[114:115], v[82:83], v[130:131]
    v_pk_fma_f32 v[116:117], v[116:117], v[84:85], v[132:133]
    v_pk_fma_f32 v[118:119], v[118:119], v[86:87], v[134:135]
    v_cvt_pk_bf16_f32 v76, v112, v113
    v_cvt_pk_bf16_f32 v77, v114, v115
    v_cvt_pk_bf16_f32 v78, v116, v117
    v_cvt_pk_bf16_f32 v79, v118, v119
    buffer_store_dwordx4 v[76:79], v96, s[20:23], s96 offen sc1
    v_lshlrev_b32 v104, 16, v72
    v_and_b32 v105, 0xffff0000, v72
    v_lshlrev_b32 v106, 16, v73
    v_and_b32 v107, 0xffff0000, v73
    v_lshlrev_b32 v108, 16, v74
    v_and_b32 v109, 0xffff0000, v74
    v_lshlrev_b32 v110, 16, v75
    v_and_b32 v111, 0xffff0000, v75
    v_lshlrev_b32 v112, 16, v76
    v_and_b32 v113, 0xffff0000, v76
    v_lshlrev_b32 v114, 16, v77
    v_and_b32 v115, 0xffff0000, v77
    v_lshlrev_b32 v116, 16, v78
    v_and_b32 v117, 0xffff0000, v78
    v_lshlrev_b32 v118, 16, v79
    v_and_b32 v119, 0xffff0000, v79
    s_waitcnt lgkmcnt(0)
    v_pk_mul_f32 v[120:121], v[104:105], v[88:89]
    v_pk_mul_f32 v[122:123], v[106:107], v[90:91]
    v_pk_mul_f32 v[124:125], v[108:109], v[92:93]
    v_pk_mul_f32 v[126:127], v[110:111], v[94:95]
    v_pk_mul_f32 v[128:129], v[112:113], v[88:89]
    v_pk_mul_f32 v[130:131], v[114:115], v[90:91]
    v_pk_mul_f32 v[132:133], v[116:117], v[92:93]
    v_pk_mul_f32 v[134:135], v[118:119], v[94:95]
    v_cvt_pk_bf16_f32 v80, v120, v121
    v_cvt_pk_bf16_f32 v81, v122, v123
    v_cvt_pk_bf16_f32 v82, v124, v125
    v_cvt_pk_bf16_f32 v83, v126, v127
    buffer_store_dwordx4 v[80:83], v97, s[72:75], 0 offen sc1
    v_cvt_pk_bf16_f32 v84, v128, v129
    v_cvt_pk_bf16_f32 v85, v130, v131
    v_cvt_pk_bf16_f32 v86, v132, v133
    v_cvt_pk_bf16_f32 v87, v134, v135
    buffer_store_dwordx4 v[84:87], v97, s[72:75], s97 offen sc1
    v_pk_add_f32 v[120:121], v[104:105], v[106:107]
    v_pk_mul_f32 v[122:123], v[104:105], v[104:105]
    v_pk_fma_f32 v[122:123], v[106:107], v[106:107], v[122:123]
    v_pk_add_f32 v[120:121], v[120:121], v[108:109]
    v_pk_fma_f32 v[122:123], v[108:109], v[108:109], v[122:123]
    v_pk_add_f32 v[120:121], v[120:121], v[110:111]
    v_pk_fma_f32 v[122:123], v[110:111], v[110:111], v[122:123]
    v_pk_add_f32 v[124:125], v[112:113], v[114:115]
    v_pk_mul_f32 v[126:127], v[112:113], v[112:113]
    v_pk_fma_f32 v[126:127], v[114:115], v[114:115], v[126:127]
    v_pk_add_f32 v[124:125], v[124:125], v[116:117]
    v_pk_fma_f32 v[126:127], v[116:117], v[116:117], v[126:127]
    v_pk_add_f32 v[124:125], v[124:125], v[118:119]
    v_pk_fma_f32 v[126:127], v[118:119], v[118:119], v[126:127]
    v_add_f32 v120, v120, v121
    v_add_f32 v122, v122, v123
    v_add_f32 v124, v124, v125
    v_add_f32 v126, v126, v127
    v_add_f32_dpp v120, v120, v120 quad_perm:[1,0,3,2] row_mask:0xf bank_mask:0xf
    v_add_f32_dpp v122, v122, v122 quad_perm:[1,0,3,2] row_mask:0xf bank_mask:0xf
    v_add_f32_dpp v124, v124, v124 quad_perm:[1,0,3,2] row_mask:0xf bank_mask:0xf
    v_add_f32_dpp v126, v126, v126 quad_perm:[1,0,3,2] row_mask:0xf bank_mask:0xf
    v_add_f32_dpp v120, v120, v120 quad_perm:[2,3,0,1] row_mask:0xf bank_mask:0xf
    v_add_f32_dpp v122, v122, v122 quad_perm:[2,3,0,1] row_mask:0xf bank_mask:0xf
    v_add_f32_dpp v124, v124, v124 quad_perm:[2,3,0,1] row_mask:0xf bank_mask:0xf
    v_add_f32_dpp v126, v126, v126 quad_perm:[2,3,0,1] row_mask:0xf bank_mask:0xf
    v_add_f32_dpp v120, v120, v120 row_half_mirror row_mask:0xf bank_mask:0xf
    v_add_f32_dpp v122, v122, v122 row_half_mirror row_mask:0xf bank_mask:0xf
    v_add_f32_dpp v124, v124, v124 row_half_mirror row_mask:0xf bank_mask:0xf
    v_add_f32_dpp v126, v126, v126 row_half_mirror row_mask:0xf bank_mask:0xf
    v_mov_b32 v128, v120
    s_mov_b32 s66, 0x2020202
    s_mov_b32 s67, s66
    v_cndmask_b32 v128, v128, v124, s[66:67]
    s_mov_b32 s66, 0x4040404
    s_mov_b32 s67, s66
    v_cndmask_b32 v128, v128, v122, s[66:67]
    s_mov_b32 s66, 0x8080808
    s_mov_b32 s67, s66
    v_cndmask_b32 v128, v128, v126, s[66:67]
    ds_bpermute_b32 v128, v101, v128
    s_mov_b32 exec_hi, 0
    s_waitcnt lgkmcnt(0)
    buffer_atomic_add_f32 v128, v100, s[28:31], 0 offen
.p2align 3
L_code_k4:
L_phase_k4:
    s_mov_b64 exec, -1
    s_lshr_b32 s6, s2, 3
    s_and_b32 s4, s6, 7
    s_and_b32 s7, s2, 1
    s_lshl_b32 s7, s7, 3
    s_add_u32 s4, s4, s7
    s_lshr_b32 s5, s6, 3
    s_bfe_u32 s7, s2, 0x20001
    s_lshl_b32 s7, s7, 2
    s_add_u32 s5, s5, s7
    s_mul_i32 s6, s4, 524288
    s_add_u32 s6, s6, 0x3800000
    s_add_u32 s8, s62, s6
    s_addc_u32 s9, s63, 0
    s_mov_b32 s10, 0x80000
    s_mov_b32 s11, 0x00020000
    s_mul_i32 s6, s5, 0
    s_sub_u32 s7, 0x700000, s6
    s_add_u32 s12, s46, s6
    s_addc_u32 s13, s47, 0
    s_mov_b32 s14, s7
    s_mov_b32 s15, 0x00020000
    s_add_u32 s16, s62, 0x10000
    s_addc_u32 s17, s63, 0
    s_mov_b32 s18, 0x8000
    s_mov_b32 s19, 0x00020000
    s_add_u32 s20, s62, 0xc000
    s_addc_u32 s21, s63, 0
    s_mov_b32 s22, 0x4000
    s_mov_b32 s23, 0x00020000
    s_lshl_b32 s6, s4, 19
    s_add_u32 s6, s6, 0x1800000
    s_add_u32 s24, s62, s6
    s_addc_u32 s25, s63, 0
    s_mov_b32 s26, 0x880000
    s_mov_b32 s27, 0x00020000
    s_lshl_b32 s6, s4, 14
    s_add_u32 s6, s6, 0x80000
    s_add_u32 s28, s62, s6
    s_addc_u32 s29, s63, 0
    s_mov_b32 s30, 0x4000
    s_mov_b32 s31, 0x00020000
    s_and_b32 s6, s5, 3
    s_lshl_b32 s7, s6, 2
    s_lshr_b32 s32, s5, 2
    s_mul_i32 s32, s32, 896
    s_lshr_b32 s72, 0xa840, s7
    s_and_b32 s72, s72, 15
    s_lshl_b32 s72, s72, 6
    s_add_u32 s72, s72, s32
    s_lshr_b32 s73, 0xca02, s7
    s_and_b32 s73, s73, 15
    s_lshl_b32 s73, s73, 6
    s_add_u32 s73, s73, s32
    s_lshr_b32 s74, 0x8c24, s7
    s_and_b32 s74, s74, 15
    s_lshl_b32 s74, s74, 6
    s_add_u32 s74, s74, s32
    s_lshr_b32 s75, 0x7766, s7
    s_and_b32 s75, s75, 15
    s_lshl_b32 s75, s75, 6
    s_add_u32 s75, s75, s32
    s_add_u32 s72, s72, 3584
    s_add_u32 s6, s6, 1
    s_and_b32 s33, s6, 2
    s_cmp_eq_u32 s33, 0
    s_cselect_b32 s6, 3584, 0
    s_add_u32 s73, s73, s6
    s_sub_u32 s6, 3584, s6
    s_add_u32 s75, s75, s6
    s_mov_b32 s98, s33
    s_cmp_ge_u32 s3, 4
    s_cbranch_scc1 L_k4_ldr_84
    s_setprio 2
    v_and_b32 v1, 63, v0
    s_lshr_b32 s34, s3, 1
    s_mul_i32 s34, s34, 64
    s_and_b32 s35, s3, 1
    v_and_b32 v10, 15, v1
    v_bfe_u32 v11, v1, 1, 3
    v_lshrrev_b32 v12, 4, v1
    v_xor_b32 v11, v11, v12
    v_add_u32 v10, s34, v10
    v_lshlrev_b32 v10, 7, v10
    v_lshl_add_u32 v2, v11, 4, v10
    v_xor_b32 v3, 64, v2
    v_bfe_u32 v10, v1, 2, 2
    v_lshl_add_u32 v10, v12, 3, v10
    v_and_b32 v11, 3, v1
    v_lshlrev_b32 v11, 3, v11
    v_bfe_u32 v13, v1, 4, 1
    v_xor_b32 v14, s35, v13
    v_lshl_add_u32 v14, v14, 5, v11
    v_lshl_add_u32 v6, v10, 6, v14
    v_xor_b32 v13, s35, v13
    v_lshl_add_u32 v11, v13, 6, v11
    v_bfe_u32 v13, v1, 3, 1
    v_lshl_add_u32 v11, v13, 5, v11
    v_lshl_add_u32 v4, v10, 7, v11
    v_xor_b32 v5, 32, v4
    v_and_b32 v10, 15, v1
    v_add_u32 v10, s34, v10
    v_lshrrev_b32 v13, 4, v1
    v_and_b32 v14, 7, v1
    v_xor_b32 v13, v13, v14
    s_lshl_b32 s6, s35, 2
    v_xor_b32 v14, s6, v13
    v_bfe_u32 v15, v1, 3, 1
    v_xor_b32 v14, v14, v15
    v_lshlrev_b32 v14, 4, v14
    v_lshl_add_u32 v218, v10, 7, v14
    v_add_u32 v218, 98304, v218
    s_lshl_b32 s6, s35, 7
    v_lshl_add_u32 v13, v13, 4, s6
    v_lshl_add_u32 v216, v10, 8, v13
    v_xor_b32 v217, 64, v216
    v_add_u32 v219, 0x10000, v216
    v_add_u32 v220, 0x10000, v217
    v_lshrrev_b32 v240, 0, v1
    v_min_u32 v240, 15, v240
    s_lshl_b32 s6, s4, 7
    s_add_u32 s6, s6, 2048
    v_lshl_add_u32 v240, v240, 2, s6
    v_mov_b32 v104, 0
    v_mov_b32 v105, 0
    v_mov_b32 v106, 0
    v_mov_b32 v107, 0
    v_mov_b32 v108, 0
    v_mov_b32 v109, 0
    v_mov_b32 v110, 0
    v_mov_b32 v111, 0
    v_mov_b32 v112, 0
    v_mov_b32 v113, 0
    v_mov_b32 v114, 0
    v_mov_b32 v115, 0
    v_mov_b32 v116, 0
    v_mov_b32 v117, 0
    v_mov_b32 v118, 0
    v_mov_b32 v119, 0
    v_mov_b32 v120, 0
    v_mov_b32 v121, 0
    v_mov_b32 v122, 0
    v_mov_b32 v123, 0
    v_mov_b32 v124, 0
    v_mov_b32 v125, 0
    v_mov_b32 v126, 0
    v_mov_b32 v127, 0
    v_mov_b32 v128, 0
    v_mov_b32 v129, 0
    v_mov_b32 v130, 0
    v_mov_b32 v131, 0
    v_mov_b32 v132, 0
    v_mov_b32 v133, 0
    v_mov_b32 v134, 0
    v_mov_b32 v135, 0
    v_mov_b32 v136, 0
    v_mov_b32 v137, 0
    v_mov_b32 v138, 0
    v_mov_b32 v139, 0
    v_mov_b32 v140, 0
    v_mov_b32 v141, 0
    v_mov_b32 v142, 0
    v_mov_b32 v143, 0
    v_mov_b32 v144, 0
    v_mov_b32 v145, 0
    v_mov_b32 v146, 0
    v_mov_b32 v147, 0
    v_mov_b32 v148, 0
    v_mov_b32 v149, 0
    v_mov_b32 v150, 0
    v_mov_b32 v151, 0
    v_mov_b32 v152, 0
    v_mov_b32 v153, 0
    v_mov_b32 v154, 0
    v_mov_b32 v155, 0
    v_mov_b32 v156, 0
    v_mov_b32 v157, 0
    v_mov_b32 v158, 0
    v_mov_b32 v159, 0
    v_mov_b32 v160, 0
    v_mov_b32 v161, 0
    v_mov_b32 v162, 0
    v_mov_b32 v163, 0
    v_mov_b32 v164, 0
    v_mov_b32 v165, 0
    v_mov_b32 v166, 0
    v_mov_b32 v167, 0
    v_mov_b32 v168, 0
    v_mov_b32 v169, 0
    v_mov_b32 v170, 0
    v_mov_b32 v171, 0
    v_mov_b32 v172, 0
    v_mov_b32 v173, 0
    v_mov_b32 v174, 0
    v_mov_b32 v175, 0
    v_mov_b32 v176, 0
    v_mov_b32 v177, 0
    v_mov_b32 v178, 0
    v_mov_b32 v179, 0
    v_mov_b32 v180, 0
    v_mov_b32 v181, 0
    v_mov_b32 v182, 0
    v_mov_b32 v183, 0
    v_mov_b32 v184, 0
    v_mov_b32 v185, 0
    v_mov_b32 v186, 0
    v_mov_b32 v187, 0
    v_mov_b32 v188, 0
    v_mov_b32 v189, 0
    v_mov_b32 v190, 0
    v_mov_b32 v191, 0
    v_mov_b32 v192, 0
    v_mov_b32 v193, 0
    v_mov_b32 v194, 0
    v_mov_b32 v195, 0
    v_mov_b32 v196, 0
    v_mov_b32 v197, 0
    v_mov_b32 v198, 0
    v_mov_b32 v199, 0
    v_mov_b32 v200, 0
    v_mov_b32 v201, 0
    v_mov_b32 v202, 0
    v_mov_b32 v203, 0
    v_mov_b32 v204, 0
    v_mov_b32 v205, 0
    v_mov_b32 v206, 0
    v_mov_b32 v207, 0
    v_mov_b32 v208, 0
    v_mov_b32 v209, 0
    v_mov_b32 v210, 0
    v_mov_b32 v211, 0
    v_mov_b32 v212, 0
    v_mov_b32 v213, 0
    v_mov_b32 v214, 0
    v_mov_b32 v215, 0
    s_waitcnt vmcnt(0)
    s_barrier
    s_add_u32 s68, s62, 0xc0000
    s_addc_u32 s69, s63, 0
    s_mov_b32 s70, 0x6000
    s_mov_b32 s71, 0x00020000
    v_mov_b32 v10, 0
    s_cmp_eq_u32 s3, 0
    s_cselect_b64 exec, 1, 0
    buffer_store_dword v10, v10, s[68:71], s100 offen sc1
    s_mov_b64 exec, -1
    s_cmp_lg_u32 s3, 1
    s_cbranch_scc1 L_k4_np_86
    s_mov_b32 s66, 262144
L_k4_dl_87:
    buffer_load_dword v242, v240, s[68:71], 0 offen sc1
    s_waitcnt vmcnt(0)
    v_cmp_ne_u32 vcc, -1, v242
    s_and_b32 s67, vcc_lo, 0xffff
    s_sub_u32 s66, s66, 1
    s_cselect_b32 s67, 0xffff, s67
    s_bcnt1_i32_b32 s6, s67
    s_cmp_ge_u32 s6, 8
    s_cbranch_scc1 L_k4_dd_88
    s_sleep 1
    s_branch L_k4_dl_87
L_k4_dd_88:
    v_mov_b32 v240, s67
    v_mov_b32 v241, 163832
    ds_write_b32 v241, v240
    s_waitcnt lgkmcnt(0)
L_k4_np_86:
    s_barrier
    s_lshl_b32 s100, s5, 7
    s_lshl_b32 s6, s4, 2
    s_add_u32 s100, s100, s6
    s_add_u32 s100, s100, 4096
    s_mov_b32 s64, 0
    s_mov_b32 s67, 45056
    s_mov_b32 s6, 16
    s_barrier
    ds_read_b64_tr_b16 v[32:33], v4 offset:16384
    ds_read_b64_tr_b16 v[34:35], v4 offset:16896
    ds_read_b128 v[16:19], v2 offset:0
    ds_read_b128 v[20:23], v2 offset:2048
    ds_read_b128 v[24:27], v2 offset:4096
    ds_read_b128 v[28:31], v2 offset:6144
    ds_read_b64_tr_b16 v[36:37], v5 offset:16384
    ds_read_b64_tr_b16 v[38:39], v5 offset:16896
    ds_read_b64_tr_b16 v[40:41], v4 offset:24576
    ds_read_b64_tr_b16 v[42:43], v4 offset:25088
    ds_read_b64_tr_b16 v[44:45], v5 offset:24576
    ds_read_b64_tr_b16 v[46:47], v5 offset:25088
    ds_read_b64_tr_b16 v[48:49], v4 offset:32768
    ds_read_b64_tr_b16 v[50:51], v4 offset:33280
    ds_read_b64_tr_b16 v[52:53], v5 offset:32768
    ds_read_b64_tr_b16 v[54:55], v5 offset:33280
    ds_read_b64_tr_b16 v[56:57], v6 offset:40960
    ds_read_b64_tr_b16 v[58:59], v6 offset:41216
.p2align 4
L_k4_cl_89:
    s_add_u32 s64, s64, 45056
    s_cmp_eq_u32 s64, 135168
    s_cselect_b32 s65, 0xfffea000, s67
    s_cselect_b32 s64, 0, s64
    s_waitcnt lgkmcnt(0)
    v_mfma_f32_16x16x32_bf16 v[104:107], v[32:35], v[16:19], v[104:107]
    ds_read_b64_tr_b16 v[76:77], v4 offset:20480
    v_mfma_f32_16x16x32_bf16 v[108:111], v[32:35], v[20:23], v[108:111]
    ds_read_b64_tr_b16 v[78:79], v4 offset:20992
    v_mfma_f32_16x16x32_bf16 v[112:115], v[32:35], v[24:27], v[112:115]
    ds_read_b128 v[60:63], v3 offset:0
    v_mfma_f32_16x16x32_bf16 v[116:119], v[32:35], v[28:31], v[116:119]
    ds_read_b128 v[64:67], v3 offset:2048
    v_mfma_f32_16x16x32_bf16 v[120:123], v[36:39], v[16:19], v[120:123]
    ds_read_b128 v[68:71], v3 offset:4096
    v_mfma_f32_16x16x32_bf16 v[124:127], v[36:39], v[20:23], v[124:127]
    ds_read_b128 v[72:75], v3 offset:6144
    v_mfma_f32_16x16x32_bf16 v[128:131], v[36:39], v[24:27], v[128:131]
    ds_read_b64_tr_b16 v[80:81], v5 offset:20480
    v_mfma_f32_16x16x32_bf16 v[132:135], v[36:39], v[28:31], v[132:135]
    ds_read_b64_tr_b16 v[82:83], v5 offset:20992
    v_mfma_f32_16x16x32_bf16 v[136:139], v[40:43], v[16:19], v[136:139]
    ds_read_b64_tr_b16 v[84:85], v4 offset:28672
    v_mfma_f32_16x16x32_bf16 v[140:143], v[40:43], v[20:23], v[140:143]
    ds_read_b64_tr_b16 v[86:87], v4 offset:29184
    v_mfma_f32_16x16x32_bf16 v[144:147], v[40:43], v[24:27], v[144:147]
    ds_read_b64_tr_b16 v[88:89], v5 offset:28672
    v_mfma_f32_16x16x32_bf16 v[148:151], v[40:43], v[28:31], v[148:151]
    ds_read_b64_tr_b16 v[90:91], v5 offset:29184
    v_mfma_f32_16x16x32_bf16 v[152:155], v[44:47], v[16:19], v[152:155]
    ds_read_b64_tr_b16 v[92:93], v4 offset:36864
    v_mfma_f32_16x16x32_bf16 v[156:159], v[44:47], v[20:23], v[156:159]
    ds_read_b64_tr_b16 v[94:95], v4 offset:37376
    v_mfma_f32_16x16x32_bf16 v[160:163], v[44:47], v[24:27], v[160:163]
    ds_read_b64_tr_b16 v[96:97], v5 offset:36864
    v_mfma_f32_16x16x32_bf16 v[164:167], v[44:47], v[28:31], v[164:167]
    ds_read_b64_tr_b16 v[98:99], v5 offset:37376
    v_mfma_f32_16x16x32_bf16 v[168:171], v[48:51], v[16:19], v[168:171]
    ds_read_b64_tr_b16 v[100:101], v6 offset:43008
    v_mfma_f32_16x16x32_bf16 v[172:175], v[48:51], v[20:23], v[172:175]
    ds_read_b64_tr_b16 v[102:103], v6 offset:43264
    v_mfma_f32_16x16x32_bf16 v[176:179], v[48:51], v[24:27], v[176:179]
    v_add_u32 v3, s65, v3
    v_mfma_f32_16x16x32_bf16 v[180:183], v[48:51], v[28:31], v[180:183]
    v_add_u32 v2, s65, v2
    v_mfma_f32_16x16x32_bf16 v[184:187], v[52:55], v[16:19], v[184:187]
    v_add_u32 v4, s65, v4
    v_mfma_f32_16x16x32_bf16 v[188:191], v[52:55], v[20:23], v[188:191]
    v_add_u32 v5, s65, v5
    v_mfma_f32_16x16x32_bf16 v[192:195], v[52:55], v[24:27], v[192:195]
    v_add_u32 v6, s65, v6
    v_mfma_f32_16x16x32_bf16 v[196:199], v[52:55], v[28:31], v[196:199]
    v_mfma_f32_16x16x32_bf16 v[200:203], v[56:59], v[16:19], v[200:203]
    v_mfma_f32_16x16x32_bf16 v[204:207], v[56:59], v[20:23], v[204:207]
    v_mfma_f32_16x16x32_bf16 v[208:211], v[56:59], v[24:27], v[208:211]
    v_mfma_f32_16x16x32_bf16 v[212:215], v[56:59], v[28:31], v[212:215]
    s_waitcnt lgkmcnt(0)
    v_mfma_f32_16x16x32_bf16 v[104:107], v[76:79], v[60:63], v[104:107]
    s_sub_u32 s6, s6, 1
    s_barrier
    ds_read_b64_tr_b16 v[32:33], v4 offset:16384
    v_mfma_f32_16x16x32_bf16 v[108:111], v[76:79], v[64:67], v[108:111]
    ds_read_b64_tr_b16 v[34:35], v4 offset:16896
    v_mfma_f32_16x16x32_bf16 v[112:115], v[76:79], v[68:71], v[112:115]
    ds_read_b128 v[16:19], v2 offset:0
    v_mfma_f32_16x16x32_bf16 v[116:119], v[76:79], v[72:75], v[116:119]
    ds_read_b128 v[20:23], v2 offset:2048
    v_mfma_f32_16x16x32_bf16 v[120:123], v[80:83], v[60:63], v[120:123]
    ds_read_b128 v[24:27], v2 offset:4096
    v_mfma_f32_16x16x32_bf16 v[124:127], v[80:83], v[64:67], v[124:127]
    ds_read_b128 v[28:31], v2 offset:6144
    v_mfma_f32_16x16x32_bf16 v[128:131], v[80:83], v[68:71], v[128:131]
    ds_read_b64_tr_b16 v[36:37], v5 offset:16384
    v_mfma_f32_16x16x32_bf16 v[132:135], v[80:83], v[72:75], v[132:135]
    ds_read_b64_tr_b16 v[38:39], v5 offset:16896
    v_mfma_f32_16x16x32_bf16 v[136:139], v[84:87], v[60:63], v[136:139]
    ds_read_b64_tr_b16 v[40:41], v4 offset:24576
    v_mfma_f32_16x16x32_bf16 v[140:143], v[84:87], v[64:67], v[140:143]
    ds_read_b64_tr_b16 v[42:43], v4 offset:25088
    v_mfma_f32_16x16x32_bf16 v[144:147], v[84:87], v[68:71], v[144:147]
    ds_read_b64_tr_b16 v[44:45], v5 offset:24576
    v_mfma_f32_16x16x32_bf16 v[148:151], v[84:87], v[72:75], v[148:151]
    ds_read_b64_tr_b16 v[46:47], v5 offset:25088
    v_mfma_f32_16x16x32_bf16 v[152:155], v[88:91], v[60:63], v[152:155]
    ds_read_b64_tr_b16 v[48:49], v4 offset:32768
    v_mfma_f32_16x16x32_bf16 v[156:159], v[88:91], v[64:67], v[156:159]
    ds_read_b64_tr_b16 v[50:51], v4 offset:33280
    v_mfma_f32_16x16x32_bf16 v[160:163], v[88:91], v[68:71], v[160:163]
    ds_read_b64_tr_b16 v[52:53], v5 offset:32768
    v_mfma_f32_16x16x32_bf16 v[164:167], v[88:91], v[72:75], v[164:167]
    ds_read_b64_tr_b16 v[54:55], v5 offset:33280
    v_mfma_f32_16x16x32_bf16 v[168:171], v[92:95], v[60:63], v[168:171]
    ds_read_b64_tr_b16 v[56:57], v6 offset:40960
    v_mfma_f32_16x16x32_bf16 v[172:175], v[92:95], v[64:67], v[172:175]
    ds_read_b64_tr_b16 v[58:59], v6 offset:41216
    v_mfma_f32_16x16x32_bf16 v[176:179], v[92:95], v[68:71], v[176:179]
    v_mfma_f32_16x16x32_bf16 v[180:183], v[92:95], v[72:75], v[180:183]
    v_mfma_f32_16x16x32_bf16 v[184:187], v[96:99], v[60:63], v[184:187]
    v_mfma_f32_16x16x32_bf16 v[188:191], v[96:99], v[64:67], v[188:191]
    v_mfma_f32_16x16x32_bf16 v[192:195], v[96:99], v[68:71], v[192:195]
    v_mfma_f32_16x16x32_bf16 v[196:199], v[96:99], v[72:75], v[196:199]
    v_mfma_f32_16x16x32_bf16 v[200:203], v[100:103], v[60:63], v[200:203]
    v_mfma_f32_16x16x32_bf16 v[204:207], v[100:103], v[64:67], v[204:207]
    v_mfma_f32_16x16x32_bf16 v[208:211], v[100:103], v[68:71], v[208:211]
    v_mfma_f32_16x16x32_bf16 v[212:215], v[100:103], v[72:75], v[212:215]
    s_cmp_lg_u32 s6, 0
    s_cbranch_scc1 L_k4_cl_89
    s_waitcnt lgkmcnt(0)
    s_nop 6
    ds_write_b128 v216, v[104:107] offset:0
    ds_write_b128 v216, v[108:111] offset:4096
    ds_write_b128 v216, v[112:115] offset:8192
    ds_write_b128 v216, v[116:119] offset:12288
    ds_write_b128 v217, v[120:123] offset:0
    ds_write_b128 v217, v[124:127] offset:4096
    ds_write_b128 v217, v[128:131] offset:8192
    ds_write_b128 v217, v[132:135] offset:12288
    ds_write_b128 v216, v[136:139] offset:32768
    ds_write_b128 v216, v[140:143] offset:36864
    ds_write_b128 v216, v[144:147] offset:40960
    ds_write_b128 v216, v[148:151] offset:45056
    ds_write_b128 v217, v[152:155] offset:32768
    ds_write_b128 v217, v[156:159] offset:36864
    ds_write_b128 v217, v[160:163] offset:40960
    ds_write_b128 v217, v[164:167] offset:45056
    ds_write_b128 v219, v[168:171] offset:0
    ds_write_b128 v219, v[172:175] offset:4096
    ds_write_b128 v219, v[176:179] offset:8192
    ds_write_b128 v219, v[180:183] offset:12288
    ds_write_b128 v220, v[184:187] offset:0
    ds_write_b128 v220, v[188:191] offset:4096
    ds_write_b128 v220, v[192:195] offset:8192
    ds_write_b128 v220, v[196:199] offset:12288
    ds_write_b128 v218, v[200:203] offset:0
    ds_write_b128 v218, v[204:207] offset:2048
    ds_write_b128 v218, v[208:211] offset:4096
    ds_write_b128 v218, v[212:215] offset:6144
    s_branch L_k4_com_90
L_k4_ldr_84:
    s_sub_u32 s34, s3, 4
    v_and_b32 v1, 63, v0
    v_lshrrev_b32 v2, 3, v1
    v_and_b32 v3, 7, v1
    s_lshl_b32 s6, s34, 3
    v_add_u32 v2, s6, v2
    v_bfe_u32 v4, v2, 1, 3
    v_xor_b32 v4, v4, v3
    s_mov_b32 s6, 4096
    v_mul_lo_u32 v5, s6, v2
    v_lshl_add_u32 v16, v4, 4, v5
    v_add_u32 v17, 131072, v16
    v_add_u32 v18, 131072, v17
    v_add_u32 v19, 131072, v18
    v_bfe_u32 v4, v2, 1, 1
    v_lshlrev_b32 v4, 1, v4
    v_bfe_u32 v6, v2, 3, 1
    v_lshl_add_u32 v4, v6, 2, v4
    v_xor_b32 v4, v4, v3
    s_mov_b32 s6, 7168
    v_mul_lo_u32 v5, s6, v2
    v_lshl_add_u32 v5, v4, 4, v5
    v_add_u32 v20, s72, v5
    v_add_u32 v21, 229376, v20
    v_add_u32 v22, s73, v5
    v_add_u32 v23, 229376, v22
    v_add_u32 v24, s74, v5
    v_add_u32 v25, 229376, v24
    v_lshrrev_b32 v2, 2, v1
    s_lshl_b32 s35, s34, 4
    v_add_u32 v2, s35, v2
    v_and_b32 v3, 3, v1
    v_bfe_u32 v6, v2, 3, 1
    v_lshlrev_b32 v6, 1, v6
    v_xor_b32 v6, v6, v3
    v_mul_lo_u32 v8, s6, v2
    v_lshl_add_u32 v8, v6, 4, v8
    v_add_u32 v26, s75, v8
    s_lshl_b32 s64, s34, 10
    s_add_u32 s65, s64, 135168
    s_mov_b32 s7, 0
    s_mov_b32 s33, 0
    s_setprio 0
    s_waitcnt vmcnt(0)
    s_barrier
    s_mov_b32 s6, 0
    s_add_u32 m0, s64, 16384
    s_nop 0
    buffer_load_dwordx4 v20, s[12:15], s6 offen lds
    s_add_u32 m0, s64, 20480
    s_nop 0
    buffer_load_dwordx4 v21, s[12:15], s6 offen lds
    s_add_u32 m0, s64, 24576
    s_nop 0
    buffer_load_dwordx4 v22, s[12:15], s6 offen lds
    s_add_u32 m0, s64, 28672
    s_nop 0
    buffer_load_dwordx4 v23, s[12:15], s6 offen lds
    s_add_u32 m0, s64, 32768
    s_nop 0
    buffer_load_dwordx4 v24, s[12:15], s6 offen lds
    s_add_u32 m0, s64, 36864
    s_nop 0
    buffer_load_dwordx4 v25, s[12:15], s6 offen lds
    s_add_u32 m0, s64, 40960
    s_nop 0
    buffer_load_dwordx4 v26, s[12:15], s6 offen lds
    s_mov_b32 s6, 458752
    s_add_u32 m0, s64, 61440
    s_nop 0
    buffer_load_dwordx4 v20, s[12:15], s6 offen lds
    s_add_u32 m0, s64, 65536
    s_nop 0
    buffer_load_dwordx4 v21, s[12:15], s6 offen lds
    s_add_u32 m0, s64, 69632
    s_nop 0
    buffer_load_dwordx4 v22, s[12:15], s6 offen lds
    s_add_u32 m0, s64, 73728
    s_nop 0
    buffer_load_dwordx4 v23, s[12:15], s6 offen lds
    s_add_u32 m0, s64, 77824
    s_nop 0
    buffer_load_dwordx4 v24, s[12:15], s6 offen lds
    s_add_u32 m0, s64, 81920
    s_nop 0
    buffer_load_dwordx4 v25, s[12:15], s6 offen lds
    s_add_u32 m0, s64, 86016
    s_nop 0
    buffer_load_dwordx4 v26, s[12:15], s6 offen lds
    s_cmp_lt_u32 s3, 4
    s_cbranch_scc1 L_k2_pf_91
    s_lshr_b32 s6, s2, 3
    s_cmp_ge_u32 s6, 14
    s_cselect_b32 s7, 14, 0
    s_cselect_b32 s32, 1, 0
    s_sub_u32 s7, s6, s7
    s_and_b32 s33, s2, 1
    s_lshl_b32 s33, s33, 1
    s_add_u32 s32, s32, s33
    s_cmp_ge_u32 s7, 7
    s_cselect_b32 s33, 21, 0
    s_add_u32 s33, s33, s7
    s_bfe_u32 s6, s2, 0x20001
    s_mul_i32 s6, s6, 7
    s_add_u32 s33, s33, s6
    s_cmp_lt_u32 s7, 14
    s_cselect_b32 s99, -1, 0
    s_lshl_b32 s32, s32, 2
    s_add_u32 s32, s32, s3
    s_sub_u32 s32, s32, 4
    s_lshl_b32 s32, s32, 6
    v_mul_u32_u24 v60, 7168, v1
    s_xor_b32 s6, s32, 512
    s_mul_i32 s6, s6, 7168
    s_lshl_b32 s7, s33, 7
    s_add_u32 s6, s6, s7
    s_and_b32 s7, s99, 458752
    s_add_u32 s68, s46, s6
    s_addc_u32 s69, s47, 0
    s_mov_b32 s70, s7
    s_mov_b32 s71, 0x00020000
    buffer_load_dword v72, v60, s[68:71], 0 offen
    s_lshl_b32 s6, s3, 9
    s_add_u32 s6, s6, 130048
    v_lshl_add_u32 v2, v1, 1, s6
    v_mov_b32 v3, 0
    ds_write_b16 v2, v3 offset:256
    v_and_b32 v4, 31, v1
    v_lshrrev_b32 v5, 5, v1
    v_lshl_add_u32 v6, v5, 4, s6
    v_min_u32 v7, 2, v4
    v_lshl_add_u32 v76, v7, 7, v6
    v_subrev_u32 v7, 4, v4
    v_min_u32 v7, 2, v7
    v_lshl_add_u32 v77, v7, 7, v6
    v_bfe_u32 v10, v1, 2, 2
    v_lshl_add_u32 v10, v5, 3, v10
    v_bfe_u32 v11, v1, 4, 1
    v_lshlrev_b32 v11, 5, v11
    v_and_b32 v13, 1, v1
    v_lshl_add_u32 v11, v13, 4, v11
    v_bfe_u32 v13, v1, 1, 1
    v_lshl_add_u32 v11, v13, 3, v11
    v_bfe_u32 v13, v1, 3, 1
    v_lshl_add_u32 v11, v13, 6, v11
    s_lshl_b32 s7, s3, 13
    s_add_u32 s7, s7, 66560
    v_lshl_add_u32 v11, v10, 7, v11
    v_add_u32 v78, s7, v11
    v_xor_b32 v79, 64, v78
    v_and_b32 v10, 0x33, v1
    v_bfe_u32 v11, v1, 2, 1
    v_lshl_add_u32 v10, v11, 3, v10
    v_bfe_u32 v11, v1, 3, 1
    v_lshl_add_u32 v10, v11, 2, v10
    v_lshlrev_b32 v10, 2, v10
    s_lshl_b32 s6, s33, 8
    s_add_u32 s6, s6, 0x10000
    s_and_b32 s7, s99, 16640
    s_add_u32 s68, s62, s6
    s_addc_u32 s69, s63, 0
    s_mov_b32 s70, s7
    s_mov_b32 s71, 0x00020000
    s_movk_i32 s6, 0x4000
    s_waitcnt vmcnt(15)
    ds_read_b64_tr_b16 v[120:121], v78 offset:0
    ds_read_b64_tr_b16 v[122:123], v78 offset:512
    ds_read_b64_tr_b16 v[124:125], v79 offset:0
    ds_read_b64_tr_b16 v[126:127], v79 offset:512
    ds_read_b64_tr_b16 v[128:129], v78 offset:2048
    ds_read_b64_tr_b16 v[130:131], v78 offset:2560
    ds_read_b64_tr_b16 v[132:133], v79 offset:2048
    ds_read_b64_tr_b16 v[134:135], v79 offset:2560
    v_cvt_pk_bf16_f32 v200, v200, v200
    v_lshlrev_b32 v200, 16, v200
    v_add_f32 v200, 1.0, v200
    v_cvt_pk_bf16_f32 v200, v200, v200
    ds_write_b16 v2, v200 offset:0
    v_cvt_pk_bf16_f32 v201, v201, v201
    ds_write_b16 v2, v201 offset:128
    s_waitcnt lgkmcnt(2)
    ds_read_b128 v[88:91], v76 offset:0
    ds_read_b128 v[92:95], v77 offset:0
    ds_read_b128 v[96:99], v76 offset:32
    ds_read_b128 v[100:103], v77 offset:32
    ds_read_b128 v[104:107], v76 offset:64
    ds_read_b128 v[108:111], v77 offset:64
    ds_read_b128 v[112:115], v76 offset:96
    ds_read_b128 v[116:119], v77 offset:96
    s_waitcnt lgkmcnt(6)
    ds_read_b64_tr_b16 v[136:137], v78 offset:4096
    ds_read_b64_tr_b16 v[138:139], v78 offset:4608
    ds_read_b64_tr_b16 v[140:141], v79 offset:4096
    ds_read_b64_tr_b16 v[142:143], v79 offset:4608
    ds_read_b64_tr_b16 v[144:145], v78 offset:6144
    ds_read_b64_tr_b16 v[146:147], v78 offset:6656
    ds_read_b64_tr_b16 v[148:149], v79 offset:6144
    ds_read_b64_tr_b16 v[150:151], v79 offset:6656
    s_waitcnt lgkmcnt(8)
    v_mfma_f32_32x32x16_bf16 v[152:167], v[88:91], v[120:123], 0
    s_waitcnt lgkmcnt(8)
    v_mfma_f32_32x32x16_bf16 v[152:167], v[92:95], v[124:127], v[152:167]
    s_waitcnt lgkmcnt(8)
    v_mfma_f32_32x32x16_bf16 v[152:167], v[96:99], v[128:131], v[152:167]
    s_waitcnt lgkmcnt(8)
    v_mfma_f32_32x32x16_bf16 v[152:167], v[100:103], v[132:135], v[152:167]
    s_waitcnt lgkmcnt(6)
    v_mfma_f32_32x32x16_bf16 v[152:167], v[104:107], v[136:139], v[152:167]
    s_waitcnt lgkmcnt(4)
    v_mfma_f32_32x32x16_bf16 v[152:167], v[108:111], v[140:143], v[152:167]
    s_waitcnt lgkmcnt(2)
    v_mfma_f32_32x32x16_bf16 v[152:167], v[112:115], v[144:147], v[152:167]
    s_waitcnt lgkmcnt(0)
    v_mfma_f32_32x32x16_bf16 v[152:167], v[116:119], v[148:151], v[152:167]
    s_nop 10
    s_nop 6
    buffer_atomic_add_f32 v152, v10, s[68:71], 0 offen
    buffer_atomic_add_f32 v153, v10, s[68:71], s6 offen
L_k2_pf_91:
    v_lshrrev_b32 v30, 0, v1
    v_min_u32 v30, 15, v30
    s_lshl_b32 s6, s4, 7
    s_add_u32 s6, s6, 2048
    v_lshl_add_u32 v30, v30, 2, s6
    v_mov_b32 v32, -1
    v_mov_b32 v33, -1
    v_mov_b32 v34, -1
    v_mov_b32 v35, -1
    v_mov_b32 v36, 163832
    s_barrier
    ds_read_b32 v36, v36
    s_waitcnt lgkmcnt(0)
    v_readfirstlane_b32 s99, v36
    s_andn2_b32 s101, 0xffff, s99
    s_and_b32 s6, s101, 3
    s_cbranch_scc1 L_k4_slow_94
    s_mov_b32 s6, 0
    s_add_u32 m0, s64, 0
    s_nop 0
    buffer_load_dwordx4 v16, s[8:11], s6 offen sc1 lds
    s_add_u32 m0, s64, 4096
    s_nop 0
    buffer_load_dwordx4 v17, s[8:11], s6 offen sc1 lds
    s_add_u32 m0, s64, 8192
    s_nop 0
    buffer_load_dwordx4 v18, s[8:11], s6 offen sc1 lds
    s_add_u32 m0, s64, 12288
    s_nop 0
    buffer_load_dwordx4 v19, s[8:11], s6 offen sc1 lds
    s_mov_b32 s6, 128
    s_add_u32 m0, s64, 45056
    s_nop 0
    buffer_load_dwordx4 v16, s[8:11], s6 offen sc1 lds
    s_add_u32 m0, s64, 49152
    s_nop 0
    buffer_load_dwordx4 v17, s[8:11], s6 offen sc1 lds
    s_add_u32 m0, s64, 53248
    s_nop 0
    buffer_load_dwordx4 v18, s[8:11], s6 offen sc1 lds
    s_add_u32 m0, s64, 57344
    s_nop 0
    buffer_load_dwordx4 v19, s[8:11], s6 offen sc1 lds
    s_andn2_b32 s99, s99, 3
L_k4_pdone_93:
    s_ff1_i32_b32 s6, s99
    s_bitset0_b32 s99, s6
    s_mul_i32 s33, s6, 458752
    s_add_u32 s7, s6, 4
    s_mul_i32 s7, s7, 37
    s_lshr_b32 s7, s7, 8
    s_add_u32 s7, s6, s7
    s_lshl_b32 s7, s7, 7
    s_add_u32 s64, s64, 90112
    s_lshl_b32 s100, s5, 7
    s_lshl_b32 s6, s4, 2
    s_add_u32 s100, s100, s6
    s_add_u32 s100, s100, 4096
    v_and_b32 v2, 255, v0
    v_lshlrev_b32 v2, 7, v2
    s_getpc_b64 s[68:69]
L_pc_95:
    s_sub_u32 s68, s68, L_pc_95-L_code_k4
    s_subb_u32 s69, s69, 0
    s_mov_b32 s70, L_code_k6-L_code_k4
    s_mov_b32 s71, 0x00020000
    buffer_load_dword v3, v2, s[68:71], 0 offen
    s_add_u32 s68, s62, 0xc0000
    s_addc_u32 s69, s63, 0
    s_mov_b32 s70, 0x6000
    s_mov_b32 s71, 0x00020000
    v_lshlrev_b32 v38, 4, v1
    v_add_u32 v38, 12288, v38
    v_and_b32 v9, 255, v0
    s_cmp_eq_u32 s34, 0
    s_cselect_b32 s6, s72, s74
    s_cselect_b32 s32, s73, s75
    v_mov_b32 v10, s6
    v_mov_b32 v11, s32
    v_cmp_gt_u32 vcc, 32, v1
    v_bfe_u32 v12, v9, 1, 4
    v_and_b32 v13, 1, v9
    v_cndmask_b32 v10, v11, v10, vcc
    v_lshlrev_b32 v10, 1, v10
    v_lshl_add_u32 v10, v12, 4, v10
    v_lshl_add_u32 v41, v13, 14, v10
    v_and_b32 v42, 127, v9
    v_lshlrev_b32 v42, 2, v42
    v_lshrrev_b32 v12, 5, v9
    v_lshlrev_b32 v12, 9, v12
    v_and_b32 v11, 1, v9
    v_lshl_add_u32 v12, v11, 8, v12
    v_bfe_u32 v11, v9, 1, 1
    v_lshl_add_u32 v12, v11, 7, v12
    v_bfe_u32 v11, v9, 2, 3
    v_lshl_add_u32 v12, v11, 4, v12
    v_add_u32 v43, 135168, v12
    v_lshlrev_b32 v56, 1, v42
    v_add_u32 v56, 137216, v56
    s_waitcnt vmcnt(5)
    s_barrier
    s_add_u32 m0, s64, 0
    s_nop 0
    buffer_load_dwordx4 v16, s[8:11], s7 offen sc1 lds
    s_add_u32 m0, s64, 4096
    s_nop 0
    buffer_load_dwordx4 v17, s[8:11], s7 offen sc1 lds
    s_add_u32 m0, s64, 8192
    s_nop 0
    buffer_load_dwordx4 v18, s[8:11], s7 offen sc1 lds
    s_add_u32 m0, s64, 12288
    s_nop 0
    buffer_load_dwordx4 v19, s[8:11], s7 offen sc1 lds
    s_add_u32 m0, s64, 16384
    s_nop 0
    buffer_load_dwordx4 v20, s[12:15], s33 offen lds
    s_add_u32 m0, s64, 20480
    s_nop 0
    buffer_load_dwordx4 v21, s[12:15], s33 offen lds
    s_add_u32 m0, s64, 24576
    s_nop 0
    buffer_load_dwordx4 v22, s[12:15], s33 offen lds
    s_add_u32 m0, s64, 28672
    s_nop 0
    buffer_load_dwordx4 v23, s[12:15], s33 offen lds
    s_add_u32 m0, s64, 32768
    s_nop 0
    buffer_load_dwordx4 v24, s[12:15], s33 offen lds
    s_add_u32 m0, s64, 36864
    s_nop 0
    buffer_load_dwordx4 v25, s[12:15], s33 offen lds
    s_add_u32 m0, s64, 40960
    s_nop 0
    buffer_load_dwordx4 v26, s[12:15], s33 offen lds
    s_cmp_eq_u32 s99, 0
    s_cbranch_scc1 L_k4_lt_96
L_k4_ltb_97:
    s_ff1_i32_b32 s6, s99
    s_bitset0_b32 s99, s6
    s_mul_i32 s33, s6, 458752
    s_add_u32 s7, s6, 4
    s_mul_i32 s7, s7, 37
    s_lshr_b32 s7, s7, 8
    s_add_u32 s7, s6, s7
    s_lshl_b32 s7, s7, 7
    s_bcnt1_i32_b32 s6, s99
    s_cmp_eq_u32 s6, 1
    s_cbranch_scc1 L_k4_pp_98
L_k4_ppb_99:
    s_add_u32 s64, s64, 45056
    s_cmp_eq_u32 s64, s65
    s_cselect_b32 s6, 135168, 0
    s_sub_u32 s64, s64, s6
    s_mov_b32 s66, 13
.p2align 4
L_k4_ll_100:
    s_waitcnt vmcnt(11)
    s_barrier
    s_add_u32 m0, s64, 0
    s_nop 0
    buffer_load_dwordx4 v16, s[8:11], s7 offen sc1 lds
    s_add_u32 m0, s64, 4096
    s_nop 0
    buffer_load_dwordx4 v17, s[8:11], s7 offen sc1 lds
    s_add_u32 m0, s64, 8192
    s_nop 0
    buffer_load_dwordx4 v18, s[8:11], s7 offen sc1 lds
    s_add_u32 m0, s64, 12288
    s_nop 0
    buffer_load_dwordx4 v19, s[8:11], s7 offen sc1 lds
    s_add_u32 m0, s64, 16384
    s_nop 0
    buffer_load_dwordx4 v20, s[12:15], s33 offen lds
    s_add_u32 m0, s64, 20480
    s_nop 0
    buffer_load_dwordx4 v21, s[12:15], s33 offen lds
    s_add_u32 m0, s64, 24576
    s_nop 0
    buffer_load_dwordx4 v22, s[12:15], s33 offen lds
    s_add_u32 m0, s64, 28672
    s_nop 0
    buffer_load_dwordx4 v23, s[12:15], s33 offen lds
    s_add_u32 m0, s64, 32768
    s_nop 0
    buffer_load_dwordx4 v24, s[12:15], s33 offen lds
    s_add_u32 m0, s64, 36864
    s_nop 0
    buffer_load_dwordx4 v25, s[12:15], s33 offen lds
    s_add_u32 m0, s64, 40960
    s_nop 0
    buffer_load_dwordx4 v26, s[12:15], s33 offen lds
    s_cmp_eq_u32 s99, 0
    s_cbranch_scc1 L_k4_lt_101
L_k4_ltb_102:
    s_ff1_i32_b32 s6, s99
    s_bitset0_b32 s99, s6
    s_mul_i32 s33, s6, 458752
    s_add_u32 s7, s6, 4
    s_mul_i32 s7, s7, 37
    s_lshr_b32 s7, s7, 8
    s_add_u32 s7, s6, s7
    s_lshl_b32 s7, s7, 7
    s_bcnt1_i32_b32 s6, s99
    s_cmp_eq_u32 s6, 1
    s_cbranch_scc1 L_k4_pp_103
L_k4_ppb_104:
    s_add_u32 s64, s64, 45056
    s_cmp_eq_u32 s64, s65
    s_cselect_b32 s6, 135168, 0
    s_sub_u32 s64, s64, s6
    s_cmp_eq_u32 s66, 11
    s_cbranch_scc1 L_k4_t_105
L_k4_tb_106:
    s_cmp_eq_u32 s66, 4
    s_cbranch_scc1 L_k4_t_107
L_k4_tb_108:
    s_cmp_eq_u32 s66, 2
    s_cbranch_scc1 L_k4_t_109
L_k4_tb_110:
    s_sub_u32 s66, s66, 1
    s_cmp_lg_u32 s66, 0
    s_cbranch_scc1 L_k4_ll_100
    s_waitcnt vmcnt(11)
    s_barrier
    v_and_b32 v2, 255, v0
    v_lshlrev_b32 v2, 7, v2
    s_mul_i32 s6, s2, 32768
    s_add_u32 s8, s48, s6
    s_addc_u32 s9, s49, 0
    s_mov_b32 s10, 0x8000
    s_mov_b32 s11, 0x00020000
    buffer_load_dword v255, v2, s[8:11], 0 offen
    v_cmp_gt_u32 vcc, 112, v9
    v_mul_f32 v57, 0x3a800000, v52
    v_mul_f32 v54, 0x3a800000, v53
    v_fma_f32 v54, -v57, v57, v54
    v_max_f32 v54, 0, v54
    v_add_f32 v54, 0x3727c5ac, v54
    v_rsq_f32 v54, v54
    s_nop 0
    v_mul_f32 v55, -v57, v54
    ds_write_b64 v56, v[54:55]
    s_and_saveexec_b64 s[66:67], vcc
    ds_write_b128 v43, v[48:51]
    s_mov_b64 exec, s[66:67]
    s_waitcnt lgkmcnt(0)
    s_waitcnt vmcnt(1)
    s_barrier
    s_barrier
L_k4_com_90:
    v_lshrrev_b32 v49, 3, v1
    s_lshl_b32 s32, s3, 4
    v_add_u32 v48, s32, v49
    v_and_b32 v2, 7, v1
    v_lshlrev_b32 v2, 1, v2
    v_xor_b32 v2, v2, v49
    v_lshlrev_b32 v2, 4, v2
    v_lshl_add_u32 v2, v48, 8, v2
    v_xor_b32 v3, 16, v2
    v_and_b32 v50, 7, v1
    v_bfe_u32 v51, v1, 2, 1
    v_and_b32 v52, 3, v1
    v_add_u32 v222, 0x10000, v2
    v_add_u32 v223, 0x10000, v3
    v_lshlrev_b32 v6, 4, v50
    v_lshl_add_u32 v7, v48, 12, v6
    v_add_u32 v6, 135168, v6
    v_lshl_add_u32 v53, v51, 3, v48
    v_lshlrev_b32 v8, 4, v52
    v_add_u32 v224, 135168, v8
    v_lshl_add_u32 v8, v53, 12, v8
    v_lshlrev_b32 v4, 1, v52
    v_xor_b32 v4, v4, v49
    v_xor_b32 v4, v4, v51
    v_lshlrev_b32 v4, 4, v4
    v_lshl_add_u32 v4, v53, 7, v4
    v_add_u32 v4, 98304, v4
    v_xor_b32 v5, 16, v4
    v_lshlrev_b32 v54, 3, v48
    v_lshl_add_u32 v9, v50, 11, v54
    v_add_u32 v54, 137216, v54
    ds_read_b64 v[16:17], v54
    ds_read_b64 v[18:19], v54 offset:64
    v_lshlrev_b32 v14, 5, v50
    v_lshl_add_u32 v14, v49, 2, v14
    v_lshlrev_b32 v15, 3, v1
    v_cvt_f32_u32 v23, v51
    v_sub_f32 v22, 1.0, v23
    s_lshl_b32 s32, s5, 10
    s_lshl_b32 s6, s3, 7
    s_add_u32 s32, s32, s6
    s_mov_b32 s68, 0xf0f0f0f0
    s_mov_b32 s69, s68
    s_mov_b32 s70, 0xbdd2d3e8
    s_mov_b32 s71, s70
    v_mov_b32 v10, 0xc0135761
    v_mov_b32 v11, v10
    v_mov_b32 v12, 1.0
    v_mov_b32 v13, 1.0
    s_cmp_ge_u32 s72, 3584
    s_cselect_b32 s7, 3584, 0
    s_cselect_b32 s33, 8388608, 0
    s_sub_u32 s72, s72, s7
    s_lshr_b32 s6, s72, 7
    s_add_u32 s6, s6, 4
    s_mul_i32 s6, s6, 37
    s_lshr_b32 s6, s6, 8
    s_lshl_b32 s6, s6, 7
    s_add_u32 s72, s72, s6
    s_add_u32 s72, s72, s33
    s_cmp_ge_u32 s73, 3584
    s_cselect_b32 s7, 3584, 0
    s_cselect_b32 s33, 8388608, 0
    s_sub_u32 s73, s73, s7
    s_lshr_b32 s6, s73, 7
    s_add_u32 s6, s6, 4
    s_mul_i32 s6, s6, 37
    s_lshr_b32 s6, s6, 8
    s_lshl_b32 s6, s6, 7
    s_add_u32 s73, s73, s6
    s_add_u32 s73, s73, s33
    s_cmp_ge_u32 s74, 3584
    s_cselect_b32 s7, 3584, 0
    s_cselect_b32 s33, 8388608, 0
    s_sub_u32 s74, s74, s7
    s_lshr_b32 s6, s74, 7
    s_add_u32 s6, s6, 4
    s_mul_i32 s6, s6, 37
    s_lshr_b32 s6, s6, 8
    s_lshl_b32 s6, s6, 7
    s_add_u32 s74, s74, s6
    s_add_u32 s74, s74, s33
    s_cmp_ge_u32 s75, 3584
    s_cselect_b32 s7, 3584, 0
    s_cselect_b32 s33, 8388608, 0
    s_sub_u32 s75, s75, s7
    s_lshr_b32 s6, s75, 7
    s_add_u32 s6, s6, 4
    s_mul_i32 s6, s6, 37
    s_lshr_b32 s6, s6, 8
    s_lshl_b32 s6, s6, 7
    s_add_u32 s75, s75, s6
    s_add_u32 s75, s75, s33
    s_waitcnt lgkmcnt(0)
    v_cndmask_b32 v20, v16, v18, s[68:69]
    v_cndmask_b32 v21, v17, v19, s[68:69]
    s_barrier
    s_cmp_lg_u32 s98, 0
    s_cbranch_scc1 L_k4_tb_111
    s_setprio 2
    ds_read_b128 v[64:67], v6 offset:0
    ds_read_b128 v[68:71], v6 offset:128
    ds_read_b128 v[72:75], v6 offset:256
    ds_read_b128 v[76:79], v6 offset:384
    ds_read_b128 v[112:115], v2 offset:0
    ds_read_b128 v[116:119], v3 offset:0
    ds_read_b128 v[120:123], v2 offset:2048
    ds_read_b128 v[124:127], v3 offset:2048
    ds_read_b128 v[128:131], v2 offset:32768
    ds_read_b128 v[132:135], v3 offset:32768
    ds_read_b128 v[136:139], v2 offset:34816
    ds_read_b128 v[140:143], v3 offset:34816
    s_waitcnt lgkmcnt(4)
    v_pk_fma_f32 v[48:49], v[64:65], v[16:17], v[72:73] op_sel:[0,1,0] op_sel_hi:[1,1,1]
    v_pk_fma_f32 v[50:51], v[66:67], v[16:17], v[74:75] op_sel:[0,1,0] op_sel_hi:[1,1,1]
    v_pk_fma_f32 v[52:53], v[68:69], v[16:17], v[76:77] op_sel:[0,1,0] op_sel_hi:[1,1,1]
    v_pk_fma_f32 v[54:55], v[70:71], v[16:17], v[78:79] op_sel:[0,1,0] op_sel_hi:[1,1,1]
    v_pk_fma_f32 v[56:57], v[64:65], v[18:19], v[72:73] op_sel:[0,1,0] op_sel_hi:[1,1,1]
    v_pk_fma_f32 v[58:59], v[66:67], v[18:19], v[74:75] op_sel:[0,1,0] op_sel_hi:[1,1,1]
    v_pk_fma_f32 v[60:61], v[68:69], v[18:19], v[76:77] op_sel:[0,1,0] op_sel_hi:[1,1,1]
    v_pk_fma_f32 v[62:63], v[70:71], v[18:19], v[78:79] op_sel:[0,1,0] op_sel_hi:[1,1,1]
    v_pk_fma_f32 v[112:113], v[112:113], v[16:17], v[48:49] op_sel_hi:[1,0,1]
    v_pk_fma_f32 v[114:115], v[114:115], v[16:17], v[50:51] op_sel_hi:[1,0,1]
    v_pk_fma_f32 v[116:117], v[116:117], v[16:17], v[52:53] op_sel_hi:[1,0,1]
    v_pk_fma_f32 v[118:119], v[118:119], v[16:17], v[54:55] op_sel_hi:[1,0,1]
    v_pk_fma_f32 v[120:121], v[120:121], v[18:19], v[56:57] op_sel_hi:[1,0,1]
    v_pk_fma_f32 v[122:123], v[122:123], v[18:19], v[58:59] op_sel_hi:[1,0,1]
    v_pk_fma_f32 v[124:125], v[124:125], v[18:19], v[60:61] op_sel_hi:[1,0,1]
    v_pk_fma_f32 v[126:127], v[126:127], v[18:19], v[62:63] op_sel_hi:[1,0,1]
    v_pk_mul_f32 v[48:49], v[112:113], v[112:113]
    v_pk_mul_f32 v[50:51], v[114:115], v[114:115]
    v_pk_mul_f32 v[52:53], v[116:117], v[116:117]
    v_pk_mul_f32 v[54:55], v[118:119], v[118:119]
    v_pk_mul_f32 v[56:57], v[120:121], v[120:121]
    v_pk_mul_f32 v[58:59], v[122:123], v[122:123]
    v_pk_mul_f32 v[60:61], v[124:125], v[124:125]
    v_pk_mul_f32 v[62:63], v[126:127], v[126:127]
    v_pk_fma_f32 v[48:49], v[48:49], s[70:71], v[10:11]
    v_pk_fma_f32 v[50:51], v[50:51], s[70:71], v[10:11]
    v_pk_fma_f32 v[52:53], v[52:53], s[70:71], v[10:11]
    v_pk_fma_f32 v[54:55], v[54:55], s[70:71], v[10:11]
    v_pk_fma_f32 v[56:57], v[56:57], s[70:71], v[10:11]
    v_pk_fma_f32 v[58:59], v[58:59], s[70:71], v[10:11]
    v_pk_fma_f32 v[60:61], v[60:61], s[70:71], v[10:11]
    v_pk_fma_f32 v[62:63], v[62:63], s[70:71], v[10:11]
    v_pk_mul_f32 v[48:49], v[48:49], v[112:113]
    v_pk_mul_f32 v[50:51], v[50:51], v[114:115]
    v_pk_mul_f32 v[52:53], v[52:53], v[116:117]
    v_pk_mul_f32 v[54:55], v[54:55], v[118:119]
    v_pk_mul_f32 v[56:57], v[56:57], v[120:121]
    v_pk_mul_f32 v[58:59], v[58:59], v[122:123]
    v_pk_mul_f32 v[60:61], v[60:61], v[124:125]
    v_pk_mul_f32 v[62:63], v[62:63], v[126:127]
    v_exp_f32 v48, v48
    v_exp_f32 v49, v49
    v_exp_f32 v50, v50
    v_exp_f32 v51, v51
    v_exp_f32 v52, v52
    v_exp_f32 v53, v53
    v_exp_f32 v54, v54
    v_exp_f32 v55, v55
    v_exp_f32 v56, v56
    v_exp_f32 v57, v57
    v_exp_f32 v58, v58
    v_exp_f32 v59, v59
    v_exp_f32 v60, v60
    v_exp_f32 v61, v61
    v_exp_f32 v62, v62
    v_exp_f32 v63, v63
    v_pk_add_f32 v[48:49], v[48:49], v[12:13]
    v_pk_add_f32 v[50:51], v[50:51], v[12:13]
    v_pk_add_f32 v[52:53], v[52:53], v[12:13]
    v_pk_add_f32 v[54:55], v[54:55], v[12:13]
    v_pk_add_f32 v[56:57], v[56:57], v[12:13]
    v_pk_add_f32 v[58:59], v[58:59], v[12:13]
    v_pk_add_f32 v[60:61], v[60:61], v[12:13]
    v_pk_add_f32 v[62:63], v[62:63], v[12:13]
    v_rcp_f32 v48, v48
    v_rcp_f32 v49, v49
    v_rcp_f32 v50, v50
    v_rcp_f32 v51, v51
    v_rcp_f32 v52, v52
    v_rcp_f32 v53, v53
    v_rcp_f32 v54, v54
    v_rcp_f32 v55, v55
    v_rcp_f32 v56, v56
    v_rcp_f32 v57, v57
    v_rcp_f32 v58, v58
    v_rcp_f32 v59, v59
    v_rcp_f32 v60, v60
    v_rcp_f32 v61, v61
    v_rcp_f32 v62, v62
    v_rcp_f32 v63, v63
    v_pk_mul_f32 v[48:49], v[48:49], v[112:113]
    v_pk_mul_f32 v[50:51], v[50:51], v[114:115]
    v_pk_mul_f32 v[52:53], v[52:53], v[116:117]
    v_pk_mul_f32 v[54:55], v[54:55], v[118:119]
    v_pk_mul_f32 v[56:57], v[56:57], v[120:121]
    v_pk_mul_f32 v[58:59], v[58:59], v[122:123]
    v_pk_mul_f32 v[60:61], v[60:61], v[124:125]
    v_pk_mul_f32 v[62:63], v[62:63], v[126:127]
    ds_read_b128 v[64:67], v6 offset:512
    ds_read_b128 v[68:71], v6 offset:640
    ds_read_b128 v[72:75], v6 offset:768
    ds_read_b128 v[76:79], v6 offset:896
    v_cvt_pk_bf16_f32 v176, v48, v49
    v_cvt_pk_bf16_f32 v177, v50, v51
    v_cvt_pk_bf16_f32 v178, v52, v53
    v_cvt_pk_bf16_f32 v179, v54, v55
    v_cvt_pk_bf16_f32 v180, v56, v57
    v_cvt_pk_bf16_f32 v181, v58, v59
    v_cvt_pk_bf16_f32 v182, v60, v61
    v_cvt_pk_bf16_f32 v183, v62, v63
    v_lshlrev_b32 v80, 16, v176
    v_and_b32 v81, 0xffff0000, v176
    v_lshlrev_b32 v82, 16, v177
    v_and_b32 v83, 0xffff0000, v177
    v_lshlrev_b32 v84, 16, v178
    v_and_b32 v85, 0xffff0000, v178
    v_lshlrev_b32 v86, 16, v179
    v_and_b32 v87, 0xffff0000, v179
    v_lshlrev_b32 v88, 16, v180
    v_and_b32 v89, 0xffff0000, v180
    v_lshlrev_b32 v90, 16, v181
    v_and_b32 v91, 0xffff0000, v181
    v_lshlrev_b32 v92, 16, v182
    v_and_b32 v93, 0xffff0000, v182
    v_lshlrev_b32 v94, 16, v183
    v_and_b32 v95, 0xffff0000, v183
    v_pk_add_f32 v[24:25], v[80:81], v[82:83]
    v_pk_mul_f32 v[26:27], v[80:81], v[80:81]
    v_pk_fma_f32 v[26:27], v[82:83], v[82:83], v[26:27]
    v_pk_add_f32 v[24:25], v[24:25], v[84:85]
    v_pk_fma_f32 v[26:27], v[84:85], v[84:85], v[26:27]
    v_pk_add_f32 v[24:25], v[24:25], v[86:87]
    v_pk_fma_f32 v[26:27], v[86:87], v[86:87], v[26:27]
    v_pk_add_f32 v[28:29], v[88:89], v[90:91]
    v_pk_mul_f32 v[30:31], v[88:89], v[88:89]
    v_pk_fma_f32 v[30:31], v[90:91], v[90:91], v[30:31]
    v_pk_add_f32 v[28:29], v[28:29], v[92:93]
    v_pk_fma_f32 v[30:31], v[92:93], v[92:93], v[30:31]
    v_pk_add_f32 v[28:29], v[28:29], v[94:95]
    v_pk_fma_f32 v[30:31], v[94:95], v[94:95], v[30:31]
    s_waitcnt lgkmcnt(0)
    v_pk_fma_f32 v[48:49], v[64:65], v[16:17], v[72:73] op_sel:[0,1,0] op_sel_hi:[1,1,1]
    v_pk_fma_f32 v[50:51], v[66:67], v[16:17], v[74:75] op_sel:[0,1,0] op_sel_hi:[1,1,1]
    v_pk_fma_f32 v[52:53], v[68:69], v[16:17], v[76:77] op_sel:[0,1,0] op_sel_hi:[1,1,1]
    v_pk_fma_f32 v[54:55], v[70:71], v[16:17], v[78:79] op_sel:[0,1,0] op_sel_hi:[1,1,1]
    v_pk_fma_f32 v[56:57], v[64:65], v[18:19], v[72:73] op_sel:[0,1,0] op_sel_hi:[1,1,1]
    v_pk_fma_f32 v[58:59], v[66:67], v[18:19], v[74:75] op_sel:[0,1,0] op_sel_hi:[1,1,1]
    v_pk_fma_f32 v[60:61], v[68:69], v[18:19], v[76:77] op_sel:[0,1,0] op_sel_hi:[1,1,1]
    v_pk_fma_f32 v[62:63], v[70:71], v[18:19], v[78:79] op_sel:[0,1,0] op_sel_hi:[1,1,1]
    v_pk_fma_f32 v[128:129], v[128:129], v[16:17], v[48:49] op_sel_hi:[1,0,1]
    v_pk_fma_f32 v[130:131], v[130:131], v[16:17], v[50:51] op_sel_hi:[1,0,1]
    v_pk_fma_f32 v[132:133], v[132:133], v[16:17], v[52:53] op_sel_hi:[1,0,1]
    v_pk_fma_f32 v[134:135], v[134:135], v[16:17], v[54:55] op_sel_hi:[1,0,1]
    v_pk_fma_f32 v[136:137], v[136:137], v[18:19], v[56:57] op_sel_hi:[1,0,1]
    v_pk_fma_f32 v[138:139], v[138:139], v[18:19], v[58:59] op_sel_hi:[1,0,1]
    v_pk_fma_f32 v[140:141], v[140:141], v[18:19], v[60:61] op_sel_hi:[1,0,1]
    v_pk_fma_f32 v[142:143], v[142:143], v[18:19], v[62:63] op_sel_hi:[1,0,1]
    v_pk_mul_f32 v[48:49], v[128:129], v[128:129]
    v_pk_mul_f32 v[50:51], v[130:131], v[130:131]
    v_pk_mul_f32 v[52:53], v[132:133], v[132:133]
    v_pk_mul_f32 v[54:55], v[134:135], v[134:135]
    v_pk_mul_f32 v[56:57], v[136:137], v[136:137]
    v_pk_mul_f32 v[58:59], v[138:139], v[138:139]
    v_pk_mul_f32 v[60:61], v[140:141], v[140:141]
    v_pk_mul_f32 v[62:63], v[142:143], v[142:143]
    v_pk_fma_f32 v[48:49], v[48:49], s[70:71], v[10:11]
    v_pk_fma_f32 v[50:51], v[50:51], s[70:71], v[10:11]
    v_pk_fma_f32 v[52:53], v[52:53], s[70:71], v[10:11]
    v_pk_fma_f32 v[54:55], v[54:55], s[70:71], v[10:11]
    v_pk_fma_f32 v[56:57], v[56:57], s[70:71], v[10:11]
    v_pk_fma_f32 v[58:59], v[58:59], s[70:71], v[10:11]
    v_pk_fma_f32 v[60:61], v[60:61], s[70:71], v[10:11]
    v_pk_fma_f32 v[62:63], v[62:63], s[70:71], v[10:11]
    v_pk_mul_f32 v[48:49], v[48:49], v[128:129]
    v_pk_mul_f32 v[50:51], v[50:51], v[130:131]
    v_pk_mul_f32 v[52:53], v[52:53], v[132:133]
    v_pk_mul_f32 v[54:55], v[54:55], v[134:135]
    v_pk_mul_f32 v[56:57], v[56:57], v[136:137]
    v_pk_mul_f32 v[58:59], v[58:59], v[138:139]
    v_pk_mul_f32 v[60:61], v[60:61], v[140:141]
    v_pk_mul_f32 v[62:63], v[62:63], v[142:143]
    v_exp_f32 v48, v48
    v_exp_f32 v49, v49
    v_exp_f32 v50, v50
    v_exp_f32 v51, v51
    v_exp_f32 v52, v52
    v_exp_f32 v53, v53
    v_exp_f32 v54, v54
    v_exp_f32 v55, v55
    v_exp_f32 v56, v56
    v_exp_f32 v57, v57
    v_exp_f32 v58, v58
    v_exp_f32 v59, v59
    v_exp_f32 v60, v60
    v_exp_f32 v61, v61
    v_exp_f32 v62, v62
    v_exp_f32 v63, v63
    v_pk_add_f32 v[48:49], v[48:49], v[12:13]
    v_pk_add_f32 v[50:51], v[50:51], v[12:13]
    v_pk_add_f32 v[52:53], v[52:53], v[12:13]
    v_pk_add_f32 v[54:55], v[54:55], v[12:13]
    v_pk_add_f32 v[56:57], v[56:57], v[12:13]
    v_pk_add_f32 v[58:59], v[58:59], v[12:13]
    v_pk_add_f32 v[60:61], v[60:61], v[12:13]
    v_pk_add_f32 v[62:63], v[62:63], v[12:13]
    v_rcp_f32 v48, v48
    v_rcp_f32 v49, v49
    v_rcp_f32 v50, v50
    v_rcp_f32 v51, v51
    v_rcp_f32 v52, v52
    v_rcp_f32 v53, v53
    v_rcp_f32 v54, v54
    v_rcp_f32 v55, v55
    v_rcp_f32 v56, v56
    v_rcp_f32 v57, v57
    v_rcp_f32 v58, v58
    v_rcp_f32 v59, v59
    v_rcp_f32 v60, v60
    v_rcp_f32 v61, v61
    v_rcp_f32 v62, v62
    v_rcp_f32 v63, v63
    v_pk_mul_f32 v[48:49], v[48:49], v[128:129]
    v_pk_mul_f32 v[50:51], v[50:51], v[130:131]
    v_pk_mul_f32 v[52:53], v[52:53], v[132:133]
    v_pk_mul_f32 v[54:55], v[54:55], v[134:135]
    v_pk_mul_f32 v[56:57], v[56:57], v[136:137]
    v_pk_mul_f32 v[58:59], v[58:59], v[138:139]
    v_pk_mul_f32 v[60:61], v[60:61], v[140:141]
    v_pk_mul_f32 v[62:63], v[62:63], v[142:143]
    ds_read_b128 v[64:67], v6 offset:1024
    ds_read_b128 v[68:71], v6 offset:1152
    ds_read_b128 v[72:75], v6 offset:1280
    ds_read_b128 v[76:79], v6 offset:1408
    ds_read_b128 v[144:147], v222 offset:0
    ds_read_b128 v[148:151], v223 offset:0
    ds_read_b128 v[152:155], v222 offset:2048
    ds_read_b128 v[156:159], v223 offset:2048
    ds_read_b128 v[160:163], v4
    ds_read_b128 v[164:167], v5
    v_cvt_pk_bf16_f32 v176, v48, v49
    v_cvt_pk_bf16_f32 v177, v50, v51
    v_cvt_pk_bf16_f32 v178, v52, v53
    v_cvt_pk_bf16_f32 v179, v54, v55
    v_cvt_pk_bf16_f32 v180, v56, v57
    v_cvt_pk_bf16_f32 v181, v58, v59
    v_cvt_pk_bf16_f32 v182, v60, v61
    v_cvt_pk_bf16_f32 v183, v62, v63
    v_lshlrev_b32 v96, 16, v176
    v_and_b32 v97, 0xffff0000, v176
    v_lshlrev_b32 v98, 16, v177
    v_and_b32 v99, 0xffff0000, v177
    v_lshlrev_b32 v100, 16, v178
    v_and_b32 v101, 0xffff0000, v178
    v_lshlrev_b32 v102, 16, v179
    v_and_b32 v103, 0xffff0000, v179
    v_lshlrev_b32 v104, 16, v180
    v_and_b32 v105, 0xffff0000, v180
    v_lshlrev_b32 v106, 16, v181
    v_and_b32 v107, 0xffff0000, v181
    v_lshlrev_b32 v108, 16, v182
    v_and_b32 v109, 0xffff0000, v182
    v_lshlrev_b32 v110, 16, v183
    v_and_b32 v111, 0xffff0000, v183
    v_pk_add_f32 v[24:25], v[24:25], v[96:97]
    v_pk_fma_f32 v[26:27], v[96:97], v[96:97], v[26:27]
    v_pk_add_f32 v[24:25], v[24:25], v[98:99]
    v_pk_fma_f32 v[26:27], v[98:99], v[98:99], v[26:27]
    v_pk_add_f32 v[24:25], v[24:25], v[100:101]
    v_pk_fma_f32 v[26:27], v[100:101], v[100:101], v[26:27]
    v_pk_add_f32 v[24:25], v[24:25], v[102:103]
    v_pk_fma_f32 v[26:27], v[102:103], v[102:103], v[26:27]
    v_pk_add_f32 v[28:29], v[28:29], v[104:105]
    v_pk_fma_f32 v[30:31], v[104:105], v[104:105], v[30:31]
    v_pk_add_f32 v[28:29], v[28:29], v[106:107]
    v_pk_fma_f32 v[30:31], v[106:107], v[106:107], v[30:31]
    v_pk_add_f32 v[28:29], v[28:29], v[108:109]
    v_pk_fma_f32 v[30:31], v[108:109], v[108:109], v[30:31]
    v_pk_add_f32 v[28:29], v[28:29], v[110:111]
    v_pk_fma_f32 v[30:31], v[110:111], v[110:111], v[30:31]
    v_add_f32 v24, v24, v25
    v_add_f32 v26, v26, v27
    v_add_f32 v28, v28, v29
    v_add_f32 v30, v30, v31
    v_add_f32_dpp v24, v24, v24 quad_perm:[1,0,3,2] row_mask:0xf bank_mask:0xf
    v_add_f32_dpp v26, v26, v26 quad_perm:[1,0,3,2] row_mask:0xf bank_mask:0xf
    v_add_f32_dpp v28, v28, v28 quad_perm:[1,0,3,2] row_mask:0xf bank_mask:0xf
    v_add_f32_dpp v30, v30, v30 quad_perm:[1,0,3,2] row_mask:0xf bank_mask:0xf
    v_add_f32_dpp v24, v24, v24 quad_perm:[2,3,0,1] row_mask:0xf bank_mask:0xf
    v_add_f32_dpp v26, v26, v26 quad_perm:[2,3,0,1] row_mask:0xf bank_mask:0xf
    v_add_f32_dpp v28, v28, v28 quad_perm:[2,3,0,1] row_mask:0xf bank_mask:0xf
    v_add_f32_dpp v30, v30, v30 quad_perm:[2,3,0,1] row_mask:0xf bank_mask:0xf
    v_add_f32_dpp v24, v24, v24 row_half_mirror row_mask:0xf bank_mask:0xf
    v_add_f32_dpp v26, v26, v26 row_half_mirror row_mask:0xf bank_mask:0xf
    v_add_f32_dpp v28, v28, v28 row_half_mirror row_mask:0xf bank_mask:0xf
    v_add_f32_dpp v30, v30, v30 row_half_mirror row_mask:0xf bank_mask:0xf
    s_mov_b32 s66, 0x02020202
    s_mov_b32 s67, s66
    v_cndmask_b32 v24, v24, v28, s[66:67]
    v_cndmask_b32 v25, v26, v30, s[66:67]
    ds_bpermute_b32 v24, v14, v24
    v_and_b32 v25, -2, v25
    ds_bpermute_b32 v25, v14, v25
    s_mov_b64 exec, 0xffff
    s_waitcnt lgkmcnt(0)
    buffer_store_dwordx2 v[24:25], v15, s[28:31], s32 offen sc1
    s_mov_b64 exec, -1
    s_setprio 0
    v_pk_fma_f32 v[48:49], v[64:65], v[16:17], v[72:73] op_sel:[0,1,0] op_sel_hi:[1,1,1]
    v_pk_fma_f32 v[50:51], v[66:67], v[16:17], v[74:75] op_sel:[0,1,0] op_sel_hi:[1,1,1]
    v_pk_fma_f32 v[52:53], v[68:69], v[16:17], v[76:77] op_sel:[0,1,0] op_sel_hi:[1,1,1]
    v_pk_fma_f32 v[54:55], v[70:71], v[16:17], v[78:79] op_sel:[0,1,0] op_sel_hi:[1,1,1]
    v_pk_fma_f32 v[56:57], v[64:65], v[18:19], v[72:73] op_sel:[0,1,0] op_sel_hi:[1,1,1]
    v_pk_fma_f32 v[58:59], v[66:67], v[18:19], v[74:75] op_sel:[0,1,0] op_sel_hi:[1,1,1]
    v_pk_fma_f32 v[60:61], v[68:69], v[18:19], v[76:77] op_sel:[0,1,0] op_sel_hi:[1,1,1]
    v_pk_fma_f32 v[62:63], v[70:71], v[18:19], v[78:79] op_sel:[0,1,0] op_sel_hi:[1,1,1]
    v_pk_fma_f32 v[144:145], v[144:145], v[16:17], v[48:49] op_sel_hi:[1,0,1]
    v_pk_fma_f32 v[146:147], v[146:147], v[16:17], v[50:51] op_sel_hi:[1,0,1]
    v_pk_fma_f32 v[148:149], v[148:149], v[16:17], v[52:53] op_sel_hi:[1,0,1]
    v_pk_fma_f32 v[150:151], v[150:151], v[16:17], v[54:55] op_sel_hi:[1,0,1]
    v_pk_fma_f32 v[152:153], v[152:153], v[18:19], v[56:57] op_sel_hi:[1,0,1]
    v_pk_fma_f32 v[154:155], v[154:155], v[18:19], v[58:59] op_sel_hi:[1,0,1]
    v_pk_fma_f32 v[156:157], v[156:157], v[18:19], v[60:61] op_sel_hi:[1,0,1]
    v_pk_fma_f32 v[158:159], v[158:159], v[18:19], v[62:63] op_sel_hi:[1,0,1]
    v_pk_mul_f32 v[48:49], v[144:145], v[144:145]
    v_pk_mul_f32 v[50:51], v[146:147], v[146:147]
    v_pk_mul_f32 v[52:53], v[148:149], v[148:149]
    v_pk_mul_f32 v[54:55], v[150:151], v[150:151]
    v_pk_mul_f32 v[56:57], v[152:153], v[152:153]
    v_pk_mul_f32 v[58:59], v[154:155], v[154:155]
    v_pk_mul_f32 v[60:61], v[156:157], v[156:157]
    v_pk_mul_f32 v[62:63], v[158:159], v[158:159]
    v_pk_fma_f32 v[48:49], v[48:49], s[70:71], v[10:11]
    v_pk_fma_f32 v[50:51], v[50:51], s[70:71], v[10:11]
    v_pk_fma_f32 v[52:53], v[52:53], s[70:71], v[10:11]
    v_pk_fma_f32 v[54:55], v[54:55], s[70:71], v[10:11]
    v_pk_fma_f32 v[56:57], v[56:57], s[70:71], v[10:11]
    v_pk_fma_f32 v[58:59], v[58:59], s[70:71], v[10:11]
    v_pk_fma_f32 v[60:61], v[60:61], s[70:71], v[10:11]
    v_pk_fma_f32 v[62:63], v[62:63], s[70:71], v[10:11]
    v_pk_mul_f32 v[48:49], v[48:49], v[144:145]
    v_pk_mul_f32 v[50:51], v[50:51], v[146:147]
    v_pk_mul_f32 v[52:53], v[52:53], v[148:149]
    v_pk_mul_f32 v[54:55], v[54:55], v[150:151]
    v_pk_mul_f32 v[56:57], v[56:57], v[152:153]
    v_pk_mul_f32 v[58:59], v[58:59], v[154:155]
    v_pk_mul_f32 v[60:61], v[60:61], v[156:157]
    v_pk_mul_f32 v[62:63], v[62:63], v[158:159]
    v_exp_f32 v48, v48
    v_exp_f32 v49, v49
    v_exp_f32 v50, v50
    v_exp_f32 v51, v51
    v_exp_f32 v52, v52
    v_exp_f32 v53, v53
    v_exp_f32 v54, v54
    v_exp_f32 v55, v55
    v_exp_f32 v56, v56
    v_exp_f32 v57, v57
    v_exp_f32 v58, v58
    v_exp_f32 v59, v59
    v_exp_f32 v60, v60
    v_exp_f32 v61, v61
    v_exp_f32 v62, v62
    v_exp_f32 v63, v63
    v_pk_add_f32 v[48:49], v[48:49], v[12:13]
    v_pk_add_f32 v[50:51], v[50:51], v[12:13]
    v_pk_add_f32 v[52:53], v[52:53], v[12:13]
    v_pk_add_f32 v[54:55], v[54:55], v[12:13]
    v_pk_add_f32 v[56:57], v[56:57], v[12:13]
    v_pk_add_f32 v[58:59], v[58:59], v[12:13]
    v_pk_add_f32 v[60:61], v[60:61], v[12:13]
    v_pk_add_f32 v[62:63], v[62:63], v[12:13]
    v_rcp_f32 v48, v48
    v_rcp_f32 v49, v49
    v_rcp_f32 v50, v50
    v_rcp_f32 v51, v51
    v_rcp_f32 v52, v52
    v_rcp_f32 v53, v53
    v_rcp_f32 v54, v54
    v_rcp_f32 v55, v55
    v_rcp_f32 v56, v56
    v_rcp_f32 v57, v57
    v_rcp_f32 v58, v58
    v_rcp_f32 v59, v59
    v_rcp_f32 v60, v60
    v_rcp_f32 v61, v61
    v_rcp_f32 v62, v62
    v_rcp_f32 v63, v63
    v_pk_mul_f32 v[48:49], v[48:49], v[144:145]
    v_pk_mul_f32 v[50:51], v[50:51], v[146:147]
    v_pk_mul_f32 v[52:53], v[52:53], v[148:149]
    v_pk_mul_f32 v[54:55], v[54:55], v[150:151]
    v_pk_mul_f32 v[56:57], v[56:57], v[152:153]
    v_pk_mul_f32 v[58:59], v[58:59], v[154:155]
    v_pk_mul_f32 v[60:61], v[60:61], v[156:157]
    v_pk_mul_f32 v[62:63], v[62:63], v[158:159]
    ds_read_b128 v[64:67], v224 offset:1536
    ds_read_b128 v[68:71], v224 offset:1664
    ds_read_b128 v[72:75], v224 offset:1792
    ds_read_b128 v[76:79], v224 offset:1920
    v_cvt_pk_bf16_f32 v144, v48, v49
    v_cvt_pk_bf16_f32 v145, v50, v51
    v_cvt_pk_bf16_f32 v146, v52, v53
    v_cvt_pk_bf16_f32 v147, v54, v55
    v_cvt_pk_bf16_f32 v148, v56, v57
    v_cvt_pk_bf16_f32 v149, v58, v59
    v_cvt_pk_bf16_f32 v150, v60, v61
    v_cvt_pk_bf16_f32 v151, v62, v63
    s_add_u32 s6, s74, 0x8000
    buffer_store_dwordx4 v[144:147], v7, s[24:27], s74 offen sc1
    buffer_store_dwordx4 v[148:151], v7, s[24:27], s6 offen sc1
    s_waitcnt lgkmcnt(0)
    v_pk_fma_f32 v[48:49], v[64:65], v[20:21], v[72:73] op_sel:[0,1,0] op_sel_hi:[1,1,1]
    v_pk_fma_f32 v[50:51], v[66:67], v[20:21], v[74:75] op_sel:[0,1,0] op_sel_hi:[1,1,1]
    v_pk_fma_f32 v[52:53], v[68:69], v[20:21], v[76:77] op_sel:[0,1,0] op_sel_hi:[1,1,1]
    v_pk_fma_f32 v[54:55], v[70:71], v[20:21], v[78:79] op_sel:[0,1,0] op_sel_hi:[1,1,1]
    v_pk_fma_f32 v[160:161], v[160:161], v[20:21], v[48:49] op_sel_hi:[1,0,1]
    v_pk_fma_f32 v[162:163], v[162:163], v[20:21], v[50:51] op_sel_hi:[1,0,1]
    v_pk_fma_f32 v[164:165], v[164:165], v[20:21], v[52:53] op_sel_hi:[1,0,1]
    v_pk_fma_f32 v[166:167], v[166:167], v[20:21], v[54:55] op_sel_hi:[1,0,1]
    v_pk_mul_f32 v[48:49], v[160:161], v[160:161]
    v_pk_mul_f32 v[50:51], v[162:163], v[162:163]
    v_pk_mul_f32 v[52:53], v[164:165], v[164:165]
    v_pk_mul_f32 v[54:55], v[166:167], v[166:167]
    v_pk_fma_f32 v[48:49], v[48:49], s[70:71], v[10:11]
    v_pk_fma_f32 v[50:51], v[50:51], s[70:71], v[10:11]
    v_pk_fma_f32 v[52:53], v[52:53], s[70:71], v[10:11]
    v_pk_fma_f32 v[54:55], v[54:55], s[70:71], v[10:11]
    v_pk_mul_f32 v[48:49], v[48:49], v[160:161]
    v_pk_mul_f32 v[50:51], v[50:51], v[162:163]
    v_pk_mul_f32 v[52:53], v[52:53], v[164:165]
    v_pk_mul_f32 v[54:55], v[54:55], v[166:167]
    v_exp_f32 v48, v48
    v_exp_f32 v49, v49
    v_exp_f32 v50, v50
    v_exp_f32 v51, v51
    v_exp_f32 v52, v52
    v_exp_f32 v53, v53
    v_exp_f32 v54, v54
    v_exp_f32 v55, v55
    v_pk_add_f32 v[48:49], v[48:49], v[12:13]
    v_pk_add_f32 v[50:51], v[50:51], v[12:13]
    v_pk_add_f32 v[52:53], v[52:53], v[12:13]
    v_pk_add_f32 v[54:55], v[54:55], v[12:13]
    v_rcp_f32 v48, v48
    v_rcp_f32 v49, v49
    v_rcp_f32 v50, v50
    v_rcp_f32 v51, v51
    v_rcp_f32 v52, v52
    v_rcp_f32 v53, v53
    v_rcp_f32 v54, v54
    v_rcp_f32 v55, v55
    v_pk_mul_f32 v[48:49], v[48:49], v[160:161]
    v_pk_mul_f32 v[50:51], v[50:51], v[162:163]
    v_pk_mul_f32 v[52:53], v[52:53], v[164:165]
    v_pk_mul_f32 v[54:55], v[54:55], v[166:167]
    v_cvt_pk_bf16_f32 v160, v48, v49
    v_cvt_pk_bf16_f32 v161, v50, v51
    v_cvt_pk_bf16_f32 v162, v52, v53
    v_cvt_pk_bf16_f32 v163, v54, v55
    buffer_load_dwordx2 v[32:33], v9, s[28:31], 0 offen offset:0 sc1
    buffer_load_dwordx2 v[34:35], v9, s[28:31], 0 offen offset:1024 sc1
    buffer_load_dwordx2 v[36:37], v9, s[28:31], 0 offen offset:64 sc1
    buffer_load_dwordx2 v[38:39], v9, s[28:31], 0 offen offset:1088 sc1
    buffer_store_dwordx4 v[160:163], v8, s[24:27], s75 offen sc1
    s_mov_b32 s66, 0x40000
    s_waitcnt vmcnt(1)
    s_branch L_k4_pchk_115
L_k4_poll_113:
    buffer_load_dwordx2 v[32:33], v9, s[28:31], 0 offen offset:0 sc1
    buffer_load_dwordx2 v[34:35], v9, s[28:31], 0 offen offset:1024 sc1
    buffer_load_dwordx2 v[36:37], v9, s[28:31], 0 offen offset:64 sc1
    buffer_load_dwordx2 v[38:39], v9, s[28:31], 0 offen offset:1088 sc1
    s_waitcnt vmcnt(0)
L_k4_pchk_115:
    v_max_u32 v48, v33, v35
    v_max3_u32 v48, v48, v37, v39
    v_cmp_eq_u32 vcc, -1, v48
    s_sub_u32 s66, s66, 1
    s_cbranch_scc1 L_k4_pdone_114
    s_cbranch_vccz L_k4_pdone_114
    s_sleep 1
    s_branch L_k4_poll_113
L_k4_pdone_114:
    v_pk_add_f32 v[32:33], v[32:33], v[34:35]
    v_pk_add_f32 v[36:37], v[36:37], v[38:39]
    s_nop 0
    v_add_f32_dpp v32, v32, v32 quad_perm:[1,0,3,2] row_mask:0xf bank_mask:0xf
    v_add_f32_dpp v33, v33, v33 quad_perm:[1,0,3,2] row_mask:0xf bank_mask:0xf
    v_add_f32_dpp v36, v36, v36 quad_perm:[1,0,3,2] row_mask:0xf bank_mask:0xf
    v_add_f32_dpp v37, v37, v37 quad_perm:[1,0,3,2] row_mask:0xf bank_mask:0xf
    v_add_f32_dpp v32, v32, v32 quad_perm:[2,3,0,1] row_mask:0xf bank_mask:0xf
    v_add_f32_dpp v33, v33, v33 quad_perm:[2,3,0,1] row_mask:0xf bank_mask:0xf
    v_add_f32_dpp v36, v36, v36 quad_perm:[2,3,0,1] row_mask:0xf bank_mask:0xf
    v_add_f32_dpp v37, v37, v37 quad_perm:[2,3,0,1] row_mask:0xf bank_mask:0xf
    v_add_f32_dpp v32, v32, v32 row_half_mirror row_mask:0xf bank_mask:0xf
    v_add_f32_dpp v33, v33, v33 row_half_mirror row_mask:0xf bank_mask:0xf
    v_add_f32_dpp v36, v36, v36 row_half_mirror row_mask:0xf bank_mask:0xf
    v_add_f32_dpp v37, v37, v37 row_half_mirror row_mask:0xf bank_mask:0xf
    v_mul_f32 v32, 0x3a124925, v32
    v_mul_f32 v36, 0x3a124925, v36
    v_mul_f32 v16, 0x3a124925, v33
    v_mul_f32 v18, 0x3a124925, v37
    v_fma_f32 v16, -v32, v32, v16
    v_fma_f32 v18, -v36, v36, v18
    v_max_f32 v16, 0, v16
    v_max_f32 v18, 0, v18
    v_add_f32 v16, 0x3727c5ac, v16
    v_add_f32 v18, 0x3727c5ac, v18
    v_rsq_f32 v16, v16
    v_rsq_f32 v18, v18
    s_nop 0
    v_mul_f32 v17, -v32, v16
    v_mul_f32 v19, -v36, v18
    v_pk_fma_f32 v[80:81], v[80:81], v[16:17], v[16:17] op_sel:[0,0,1] op_sel_hi:[1,0,1]
    v_pk_fma_f32 v[82:83], v[82:83], v[16:17], v[16:17] op_sel:[0,0,1] op_sel_hi:[1,0,1]
    v_pk_fma_f32 v[84:85], v[84:85], v[16:17], v[16:17] op_sel:[0,0,1] op_sel_hi:[1,0,1]
    v_pk_fma_f32 v[86:87], v[86:87], v[16:17], v[16:17] op_sel:[0,0,1] op_sel_hi:[1,0,1]
    v_pk_fma_f32 v[88:89], v[88:89], v[18:19], v[18:19] op_sel:[0,0,1] op_sel_hi:[1,0,1]
    v_pk_fma_f32 v[90:91], v[90:91], v[18:19], v[18:19] op_sel:[0,0,1] op_sel_hi:[1,0,1]
    v_pk_fma_f32 v[92:93], v[92:93], v[18:19], v[18:19] op_sel:[0,0,1] op_sel_hi:[1,0,1]
    v_pk_fma_f32 v[94:95], v[94:95], v[18:19], v[18:19] op_sel:[0,0,1] op_sel_hi:[1,0,1]
    v_cvt_pk_bf16_f32 v48, v80, v81
    v_cvt_pk_bf16_f32 v49, v82, v83
    v_cvt_pk_bf16_f32 v50, v84, v85
    v_cvt_pk_bf16_f32 v51, v86, v87
    v_cvt_pk_bf16_f32 v52, v88, v89
    v_cvt_pk_bf16_f32 v53, v90, v91
    v_cvt_pk_bf16_f32 v54, v92, v93
    v_cvt_pk_bf16_f32 v55, v94, v95
    s_add_u32 s6, s72, 0x8000
    buffer_store_dwordx4 v[48:51], v7, s[24:27], s72 offen sc1
    buffer_store_dwordx4 v[52:55], v7, s[24:27], s6 offen sc1
    v_pk_fma_f32 v[96:97], v[96:97], v[16:17], v[16:17] op_sel:[0,0,1] op_sel_hi:[1,0,1]
    v_pk_fma_f32 v[98:99], v[98:99], v[16:17], v[16:17] op_sel:[0,0,1] op_sel_hi:[1,0,1]
    v_pk_fma_f32 v[100:101], v[100:101], v[16:17], v[16:17] op_sel:[0,0,1] op_sel_hi:[1,0,1]
    v_pk_fma_f32 v[102:103], v[102:103], v[16:17], v[16:17] op_sel:[0,0,1] op_sel_hi:[1,0,1]
    v_pk_fma_f32 v[104:105], v[104:105], v[18:19], v[18:19] op_sel:[0,0,1] op_sel_hi:[1,0,1]
    v_pk_fma_f32 v[106:107], v[106:107], v[18:19], v[18:19] op_sel:[0,0,1] op_sel_hi:[1,0,1]
    v_pk_fma_f32 v[108:109], v[108:109], v[18:19], v[18:19] op_sel:[0,0,1] op_sel_hi:[1,0,1]
    v_pk_fma_f32 v[110:111], v[110:111], v[18:19], v[18:19] op_sel:[0,0,1] op_sel_hi:[1,0,1]
    v_cvt_pk_bf16_f32 v56, v96, v97
    v_cvt_pk_bf16_f32 v57, v98, v99
    v_cvt_pk_bf16_f32 v58, v100, v101
    v_cvt_pk_bf16_f32 v59, v102, v103
    v_cvt_pk_bf16_f32 v60, v104, v105
    v_cvt_pk_bf16_f32 v61, v106, v107
    v_cvt_pk_bf16_f32 v62, v108, v109
    v_cvt_pk_bf16_f32 v63, v110, v111
    s_add_u32 s6, s73, 0x8000
    buffer_store_dwordx4 v[56:59], v7, s[24:27], s73 offen sc1
    buffer_store_dwordx4 v[60:63], v7, s[24:27], s6 offen sc1
    s_branch L_k4_te_112
L_k4_tb_111:
    s_setprio 2
    ds_read_b128 v[64:67], v6 offset:0
    ds_read_b128 v[68:71], v6 offset:128
    ds_read_b128 v[72:75], v6 offset:256
    ds_read_b128 v[76:79], v6 offset:384
    ds_read_b128 v[112:115], v2 offset:0
    ds_read_b128 v[116:119], v3 offset:0
    ds_read_b128 v[120:123], v2 offset:2048
    ds_read_b128 v[124:127], v3 offset:2048
    ds_read_b128 v[160:163], v4
    ds_read_b128 v[164:167], v5
    s_waitcnt lgkmcnt(2)
    v_pk_fma_f32 v[48:49], v[64:65], v[16:17], v[72:73] op_sel:[0,1,0] op_sel_hi:[1,1,1]
    v_pk_fma_f32 v[50:51], v[66:67], v[16:17], v[74:75] op_sel:[0,1,0] op_sel_hi:[1,1,1]
    v_pk_fma_f32 v[52:53], v[68:69], v[16:17], v[76:77] op_sel:[0,1,0] op_sel_hi:[1,1,1]
    v_pk_fma_f32 v[54:55], v[70:71], v[16:17], v[78:79] op_sel:[0,1,0] op_sel_hi:[1,1,1]
    v_pk_fma_f32 v[56:57], v[64:65], v[18:19], v[72:73] op_sel:[0,1,0] op_sel_hi:[1,1,1]
    v_pk_fma_f32 v[58:59], v[66:67], v[18:19], v[74:75] op_sel:[0,1,0] op_sel_hi:[1,1,1]
    v_pk_fma_f32 v[60:61], v[68:69], v[18:19], v[76:77] op_sel:[0,1,0] op_sel_hi:[1,1,1]
    v_pk_fma_f32 v[62:63], v[70:71], v[18:19], v[78:79] op_sel:[0,1,0] op_sel_hi:[1,1,1]
    v_pk_fma_f32 v[112:113], v[112:113], v[16:17], v[48:49] op_sel_hi:[1,0,1]
    v_pk_fma_f32 v[114:115], v[114:115], v[16:17], v[50:51] op_sel_hi:[1,0,1]
    v_pk_fma_f32 v[116:117], v[116:117], v[16:17], v[52:53] op_sel_hi:[1,0,1]
    v_pk_fma_f32 v[118:119], v[118:119], v[16:17], v[54:55] op_sel_hi:[1,0,1]
    v_pk_fma_f32 v[120:121], v[120:121], v[18:19], v[56:57] op_sel_hi:[1,0,1]
    v_pk_fma_f32 v[122:123], v[122:123], v[18:19], v[58:59] op_sel_hi:[1,0,1]
    v_pk_fma_f32 v[124:125], v[124:125], v[18:19], v[60:61] op_sel_hi:[1,0,1]
    v_pk_fma_f32 v[126:127], v[126:127], v[18:19], v[62:63] op_sel_hi:[1,0,1]
    v_pk_mul_f32 v[48:49], v[112:113], v[112:113]
    v_pk_mul_f32 v[50:51], v[114:115], v[114:115]
    v_pk_mul_f32 v[52:53], v[116:117], v[116:117]
    v_pk_mul_f32 v[54:55], v[118:119], v[118:119]
    v_pk_mul_f32 v[56:57], v[120:121], v[120:121]
    v_pk_mul_f32 v[58:59], v[122:123], v[122:123]
    v_pk_mul_f32 v[60:61], v[124:125], v[124:125]
    v_pk_mul_f32 v[62:63], v[126:127], v[126:127]
    v_pk_fma_f32 v[48:49], v[48:49], s[70:71], v[10:11]
    v_pk_fma_f32 v[50:51], v[50:51], s[70:71], v[10:11]
    v_pk_fma_f32 v[52:53], v[52:53], s[70:71], v[10:11]
    v_pk_fma_f32 v[54:55], v[54:55], s[70:71], v[10:11]
    v_pk_fma_f32 v[56:57], v[56:57], s[70:71], v[10:11]
    v_pk_fma_f32 v[58:59], v[58:59], s[70:71], v[10:11]
    v_pk_fma_f32 v[60:61], v[60:61], s[70:71], v[10:11]
    v_pk_fma_f32 v[62:63], v[62:63], s[70:71], v[10:11]
    v_pk_mul_f32 v[48:49], v[48:49], v[112:113]
    v_pk_mul_f32 v[50:51], v[50:51], v[114:115]
    v_pk_mul_f32 v[52:53], v[52:53], v[116:117]
    v_pk_mul_f32 v[54:55], v[54:55], v[118:119]
    v_pk_mul_f32 v[56:57], v[56:57], v[120:121]
    v_pk_mul_f32 v[58:59], v[58:59], v[122:123]
    v_pk_mul_f32 v[60:61], v[60:61], v[124:125]
    v_pk_mul_f32 v[62:63], v[62:63], v[126:127]
    v_exp_f32 v48, v48
    v_exp_f32 v49, v49
    v_exp_f32 v50, v50
    v_exp_f32 v51, v51
    v_exp_f32 v52, v52
    v_exp_f32 v53, v53
    v_exp_f32 v54, v54
    v_exp_f32 v55, v55
    v_exp_f32 v56, v56
    v_exp_f32 v57, v57
    v_exp_f32 v58, v58
    v_exp_f32 v59, v59
    v_exp_f32 v60, v60
    v_exp_f32 v61, v61
    v_exp_f32 v62, v62
    v_exp_f32 v63, v63
    v_pk_add_f32 v[48:49], v[48:49], v[12:13]
    v_pk_add_f32 v[50:51], v[50:51], v[12:13]
    v_pk_add_f32 v[52:53], v[52:53], v[12:13]
    v_pk_add_f32 v[54:55], v[54:55], v[12:13]
    v_pk_add_f32 v[56:57], v[56:57], v[12:13]
    v_pk_add_f32 v[58:59], v[58:59], v[12:13]
    v_pk_add_f32 v[60:61], v[60:61], v[12:13]
    v_pk_add_f32 v[62:63], v[62:63], v[12:13]
    v_rcp_f32 v48, v48
    v_rcp_f32 v49, v49
    v_rcp_f32 v50, v50
    v_rcp_f32 v51, v51
    v_rcp_f32 v52, v52
    v_rcp_f32 v53, v53
    v_rcp_f32 v54, v54
    v_rcp_f32 v55, v55
    v_rcp_f32 v56, v56
    v_rcp_f32 v57, v57
    v_rcp_f32 v58, v58
    v_rcp_f32 v59, v59
    v_rcp_f32 v60, v60
    v_rcp_f32 v61, v61
    v_rcp_f32 v62, v62
    v_rcp_f32 v63, v63
    v_pk_mul_f32 v[48:49], v[48:49], v[112:113]
    v_pk_mul_f32 v[50:51], v[50:51], v[114:115]
    v_pk_mul_f32 v[52:53], v[52:53], v[116:117]
    v_pk_mul_f32 v[54:55], v[54:55], v[118:119]
    v_pk_mul_f32 v[56:57], v[56:57], v[120:121]
    v_pk_mul_f32 v[58:59], v[58:59], v[122:123]
    v_pk_mul_f32 v[60:61], v[60:61], v[124:125]
    v_pk_mul_f32 v[62:63], v[62:63], v[126:127]
    ds_read_b128 v[64:67], v224 offset:1536
    ds_read_b128 v[68:71], v224 offset:1664
    ds_read_b128 v[72:75], v224 offset:1792
    ds_read_b128 v[76:79], v224 offset:1920
    v_cvt_pk_bf16_f32 v176, v48, v49
    v_cvt_pk_bf16_f32 v177, v50, v51
    v_cvt_pk_bf16_f32 v178, v52, v53
    v_cvt_pk_bf16_f32 v179, v54, v55
    v_cvt_pk_bf16_f32 v180, v56, v57
    v_cvt_pk_bf16_f32 v181, v58, v59
    v_cvt_pk_bf16_f32 v182, v60, v61
    v_cvt_pk_bf16_f32 v183, v62, v63
    v_lshlrev_b32 v80, 16, v176
    v_and_b32 v81, 0xffff0000, v176
    v_lshlrev_b32 v82, 16, v177
    v_and_b32 v83, 0xffff0000, v177
    v_lshlrev_b32 v84, 16, v178
    v_and_b32 v85, 0xffff0000, v178
    v_lshlrev_b32 v86, 16, v179
    v_and_b32 v87, 0xffff0000, v179
    v_lshlrev_b32 v88, 16, v180
    v_and_b32 v89, 0xffff0000, v180
    v_lshlrev_b32 v90, 16, v181
    v_and_b32 v91, 0xffff0000, v181
    v_lshlrev_b32 v92, 16, v182
    v_and_b32 v93, 0xffff0000, v182
    v_lshlrev_b32 v94, 16, v183
    v_and_b32 v95, 0xffff0000, v183
    v_pk_add_f32 v[24:25], v[80:81], v[82:83]
    v_pk_mul_f32 v[26:27], v[80:81], v[80:81]
    v_pk_fma_f32 v[26:27], v[82:83], v[82:83], v[26:27]
    v_pk_add_f32 v[24:25], v[24:25], v[84:85]
    v_pk_fma_f32 v[26:27], v[84:85], v[84:85], v[26:27]
    v_pk_add_f32 v[24:25], v[24:25], v[86:87]
    v_pk_fma_f32 v[26:27], v[86:87], v[86:87], v[26:27]
    v_pk_add_f32 v[28:29], v[88:89], v[90:91]
    v_pk_mul_f32 v[30:31], v[88:89], v[88:89]
    v_pk_fma_f32 v[30:31], v[90:91], v[90:91], v[30:31]
    v_pk_add_f32 v[28:29], v[28:29], v[92:93]
    v_pk_fma_f32 v[30:31], v[92:93], v[92:93], v[30:31]
    v_pk_add_f32 v[28:29], v[28:29], v[94:95]
    v_pk_fma_f32 v[30:31], v[94:95], v[94:95], v[30:31]
    s_waitcnt lgkmcnt(0)
    v_pk_fma_f32 v[48:49], v[64:65], v[20:21], v[72:73] op_sel:[0,1,0] op_sel_hi:[1,1,1]
    v_pk_fma_f32 v[50:51], v[66:67], v[20:21], v[74:75] op_sel:[0,1,0] op_sel_hi:[1,1,1]
    v_pk_fma_f32 v[52:53], v[68:69], v[20:21], v[76:77] op_sel:[0,1,0] op_sel_hi:[1,1,1]
    v_pk_fma_f32 v[54:55], v[70:71], v[20:21], v[78:79] op_sel:[0,1,0] op_sel_hi:[1,1,1]
    v_pk_fma_f32 v[160:161], v[160:161], v[20:21], v[48:49] op_sel_hi:[1,0,1]
    v_pk_fma_f32 v[162:163], v[162:163], v[20:21], v[50:51] op_sel_hi:[1,0,1]
    v_pk_fma_f32 v[164:165], v[164:165], v[20:21], v[52:53] op_sel_hi:[1,0,1]
    v_pk_fma_f32 v[166:167], v[166:167], v[20:21], v[54:55] op_sel_hi:[1,0,1]
    v_pk_mul_f32 v[48:49], v[160:161], v[160:161]
    v_pk_mul_f32 v[50:51], v[162:163], v[162:163]
    v_pk_mul_f32 v[52:53], v[164:165], v[164:165]
    v_pk_mul_f32 v[54:55], v[166:167], v[166:167]
    v_pk_fma_f32 v[48:49], v[48:49], s[70:71], v[10:11]
    v_pk_fma_f32 v[50:51], v[50:51], s[70:71], v[10:11]
    v_pk_fma_f32 v[52:53], v[52:53], s[70:71], v[10:11]
    v_pk_fma_f32 v[54:55], v[54:55], s[70:71], v[10:11]
    v_pk_mul_f32 v[48:49], v[48:49], v[160:161]
    v_pk_mul_f32 v[50:51], v[50:51], v[162:163]
    v_pk_mul_f32 v[52:53], v[52:53], v[164:165]
    v_pk_mul_f32 v[54:55], v[54:55], v[166:167]
    v_exp_f32 v48, v48
    v_exp_f32 v49, v49
    v_exp_f32 v50, v50
    v_exp_f32 v51, v51
    v_exp_f32 v52, v52
    v_exp_f32 v53, v53
    v_exp_f32 v54, v54
    v_exp_f32 v55, v55
    v_pk_add_f32 v[48:49], v[48:49], v[12:13]
    v_pk_add_f32 v[50:51], v[50:51], v[12:13]
    v_pk_add_f32 v[52:53], v[52:53], v[12:13]
    v_pk_add_f32 v[54:55], v[54:55], v[12:13]
    v_rcp_f32 v48, v48
    v_rcp_f32 v49, v49
    v_rcp_f32 v50, v50
    v_rcp_f32 v51, v51
    v_rcp_f32 v52, v52
    v_rcp_f32 v53, v53
    v_rcp_f32 v54, v54
    v_rcp_f32 v55, v55
    v_pk_mul_f32 v[48:49], v[48:49], v[160:161]
    v_pk_mul_f32 v[50:51], v[50:51], v[162:163]
    v_pk_mul_f32 v[52:53], v[52:53], v[164:165]
    v_pk_mul_f32 v[54:55], v[54:55], v[166:167]
    ds_read_b128 v[64:67], v6 offset:512
    ds_read_b128 v[68:71], v6 offset:640
    ds_read_b128 v[72:75], v6 offset:768
    ds_read_b128 v[76:79], v6 offset:896
    ds_read_b128 v[128:131], v2 offset:32768
    ds_read_b128 v[132:135], v3 offset:32768
    ds_read_b128 v[136:139], v2 offset:34816
    ds_read_b128 v[140:143], v3 offset:34816
    ds_read_b128 v[144:147], v222 offset:0
    ds_read_b128 v[148:151], v223 offset:0
    ds_read_b128 v[152:155], v222 offset:2048
    ds_read_b128 v[156:159], v223 offset:2048
    v_cvt_pk_bf16_f32 v176, v48, v49
    v_cvt_pk_bf16_f32 v177, v50, v51
    v_cvt_pk_bf16_f32 v178, v52, v53
    v_cvt_pk_bf16_f32 v179, v54, v55
    v_lshlrev_b32 v96, 16, v176
    v_and_b32 v97, 0xffff0000, v176
    v_lshlrev_b32 v98, 16, v177
    v_and_b32 v99, 0xffff0000, v177
    v_lshlrev_b32 v100, 16, v178
    v_and_b32 v101, 0xffff0000, v178
    v_lshlrev_b32 v102, 16, v179
    v_and_b32 v103, 0xffff0000, v179
    v_pk_add_f32 v[48:49], v[96:97], v[98:99]
    v_pk_mul_f32 v[50:51], v[96:97], v[96:97]
    v_pk_fma_f32 v[50:51], v[98:99], v[98:99], v[50:51]
    v_pk_add_f32 v[48:49], v[48:49], v[100:101]
    v_pk_fma_f32 v[50:51], v[100:101], v[100:101], v[50:51]
    v_pk_add_f32 v[48:49], v[48:49], v[102:103]
    v_pk_fma_f32 v[50:51], v[102:103], v[102:103], v[50:51]
    v_pk_fma_f32 v[24:25], v[48:49], v[22:23], v[24:25] op_sel:[0,0,0] op_sel_hi:[1,0,1]
    v_pk_fma_f32 v[26:27], v[50:51], v[22:23], v[26:27] op_sel:[0,0,0] op_sel_hi:[1,0,1]
    v_pk_fma_f32 v[28:29], v[48:49], v[22:23], v[28:29] op_sel:[0,1,0] op_sel_hi:[1,1,1]
    v_pk_fma_f32 v[30:31], v[50:51], v[22:23], v[30:31] op_sel:[0,1,0] op_sel_hi:[1,1,1]
    v_add_f32 v24, v24, v25
    v_add_f32 v26, v26, v27
    v_add_f32 v28, v28, v29
    v_add_f32 v30, v30, v31
    v_add_f32_dpp v24, v24, v24 quad_perm:[1,0,3,2] row_mask:0xf bank_mask:0xf
    v_add_f32_dpp v26, v26, v26 quad_perm:[1,0,3,2] row_mask:0xf bank_mask:0xf
    v_add_f32_dpp v28, v28, v28 quad_perm:[1,0,3,2] row_mask:0xf bank_mask:0xf
    v_add_f32_dpp v30, v30, v30 quad_perm:[1,0,3,2] row_mask:0xf bank_mask:0xf
    v_add_f32_dpp v24, v24, v24 quad_perm:[2,3,0,1] row_mask:0xf bank_mask:0xf
    v_add_f32_dpp v26, v26, v26 quad_perm:[2,3,0,1] row_mask:0xf bank_mask:0xf
    v_add_f32_dpp v28, v28, v28 quad_perm:[2,3,0,1] row_mask:0xf bank_mask:0xf
    v_add_f32_dpp v30, v30, v30 quad_perm:[2,3,0,1] row_mask:0xf bank_mask:0xf
    v_add_f32_dpp v24, v24, v24 row_half_mirror row_mask:0xf bank_mask:0xf
    v_add_f32_dpp v26, v26, v26 row_half_mirror row_mask:0xf bank_mask:0xf
    v_add_f32_dpp v28, v28, v28 row_half_mirror row_mask:0xf bank_mask:0xf
    v_add_f32_dpp v30, v30, v30 row_half_mirror row_mask:0xf bank_mask:0xf
    s_mov_b32 s66, 0x02020202
    s_mov_b32 s67, s66
    v_cndmask_b32 v24, v24, v28, s[66:67]
    v_cndmask_b32 v25, v26, v30, s[66:67]
    ds_bpermute_b32 v24, v14, v24
    v_and_b32 v25, -2, v25
    ds_bpermute_b32 v25, v14, v25
    s_mov_b64 exec, 0xffff
    s_waitcnt lgkmcnt(0)
    buffer_store_dwordx2 v[24:25], v15, s[28:31], s32 offen sc1
    s_mov_b64 exec, -1
    s_setprio 0
    v_pk_fma_f32 v[48:49], v[64:65], v[16:17], v[72:73] op_sel:[0,1,0] op_sel_hi:[1,1,1]
    v_pk_fma_f32 v[50:51], v[66:67], v[16:17], v[74:75] op_sel:[0,1,0] op_sel_hi:[1,1,1]
    v_pk_fma_f32 v[52:53], v[68:69], v[16:17], v[76:77] op_sel:[0,1,0] op_sel_hi:[1,1,1]
    v_pk_fma_f32 v[54:55], v[70:71], v[16:17], v[78:79] op_sel:[0,1,0] op_sel_hi:[1,1,1]
    v_pk_fma_f32 v[56:57], v[64:65], v[18:19], v[72:73] op_sel:[0,1,0] op_sel_hi:[1,1,1]
    v_pk_fma_f32 v[58:59], v[66:67], v[18:19], v[74:75] op_sel:[0,1,0] op_sel_hi:[1,1,1]
    v_pk_fma_f32 v[60:61], v[68:69], v[18:19], v[76:77] op_sel:[0,1,0] op_sel_hi:[1,1,1]
    v_pk_fma_f32 v[62:63], v[70:71], v[18:19], v[78:79] op_sel:[0,1,0] op_sel_hi:[1,1,1]
    v_pk_fma_f32 v[128:129], v[128:129], v[16:17], v[48:49] op_sel_hi:[1,0,1]
    v_pk_fma_f32 v[130:131], v[130:131], v[16:17], v[50:51] op_sel_hi:[1,0,1]
    v_pk_fma_f32 v[132:133], v[132:133], v[16:17], v[52:53] op_sel_hi:[1,0,1]
    v_pk_fma_f32 v[134:135], v[134:135], v[16:17], v[54:55] op_sel_hi:[1,0,1]
    v_pk_fma_f32 v[136:137], v[136:137], v[18:19], v[56:57] op_sel_hi:[1,0,1]
    v_pk_fma_f32 v[138:139], v[138:139], v[18:19], v[58:59] op_sel_hi:[1,0,1]
    v_pk_fma_f32 v[140:141], v[140:141], v[18:19], v[60:61] op_sel_hi:[1,0,1]
    v_pk_fma_f32 v[142:143], v[142:143], v[18:19], v[62:63] op_sel_hi:[1,0,1]
    v_pk_mul_f32 v[48:49], v[128:129], v[128:129]
    v_pk_mul_f32 v[50:51], v[130:131], v[130:131]
    v_pk_mul_f32 v[52:53], v[132:133], v[132:133]
    v_pk_mul_f32 v[54:55], v[134:135], v[134:135]
    v_pk_mul_f32 v[56:57], v[136:137], v[136:137]
    v_pk_mul_f32 v[58:59], v[138:139], v[138:139]
    v_pk_mul_f32 v[60:61], v[140:141], v[140:141]
    v_pk_mul_f32 v[62:63], v[142:143], v[142:143]
    v_pk_fma_f32 v[48:49], v[48:49], s[70:71], v[10:11]
    v_pk_fma_f32 v[50:51], v[50:51], s[70:71], v[10:11]
    v_pk_fma_f32 v[52:53], v[52:53], s[70:71], v[10:11]
    v_pk_fma_f32 v[54:55], v[54:55], s[70:71], v[10:11]
    v_pk_fma_f32 v[56:57], v[56:57], s[70:71], v[10:11]
    v_pk_fma_f32 v[58:59], v[58:59], s[70:71], v[10:11]
    v_pk_fma_f32 v[60:61], v[60:61], s[70:71], v[10:11]
    v_pk_fma_f32 v[62:63], v[62:63], s[70:71], v[10:11]
    v_pk_mul_f32 v[48:49], v[48:49], v[128:129]
    v_pk_mul_f32 v[50:51], v[50:51], v[130:131]
    v_pk_mul_f32 v[52:53], v[52:53], v[132:133]
    v_pk_mul_f32 v[54:55], v[54:55], v[134:135]
    v_pk_mul_f32 v[56:57], v[56:57], v[136:137]
    v_pk_mul_f32 v[58:59], v[58:59], v[138:139]
    v_pk_mul_f32 v[60:61], v[60:61], v[140:141]
    v_pk_mul_f32 v[62:63], v[62:63], v[142:143]
    v_exp_f32 v48, v48
    v_exp_f32 v49, v49
    v_exp_f32 v50, v50
    v_exp_f32 v51, v51
    v_exp_f32 v52, v52
    v_exp_f32 v53, v53
    v_exp_f32 v54, v54
    v_exp_f32 v55, v55
    v_exp_f32 v56, v56
    v_exp_f32 v57, v57
    v_exp_f32 v58, v58
    v_exp_f32 v59, v59
    v_exp_f32 v60, v60
    v_exp_f32 v61, v61
    v_exp_f32 v62, v62
    v_exp_f32 v63, v63
    v_pk_add_f32 v[48:49], v[48:49], v[12:13]
    v_pk_add_f32 v[50:51], v[50:51], v[12:13]
    v_pk_add_f32 v[52:53], v[52:53], v[12:13]
    v_pk_add_f32 v[54:55], v[54:55], v[12:13]
    v_pk_add_f32 v[56:57], v[56:57], v[12:13]
    v_pk_add_f32 v[58:59], v[58:59], v[12:13]
    v_pk_add_f32 v[60:61], v[60:61], v[12:13]
    v_pk_add_f32 v[62:63], v[62:63], v[12:13]
    v_rcp_f32 v48, v48
    v_rcp_f32 v49, v49
    v_rcp_f32 v50, v50
    v_rcp_f32 v51, v51
    v_rcp_f32 v52, v52
    v_rcp_f32 v53, v53
    v_rcp_f32 v54, v54
    v_rcp_f32 v55, v55
    v_rcp_f32 v56, v56
    v_rcp_f32 v57, v57
    v_rcp_f32 v58, v58
    v_rcp_f32 v59, v59
    v_rcp_f32 v60, v60
    v_rcp_f32 v61, v61
    v_rcp_f32 v62, v62
    v_rcp_f32 v63, v63
    v_pk_mul_f32 v[48:49], v[48:49], v[128:129]
    v_pk_mul_f32 v[50:51], v[50:51], v[130:131]
    v_pk_mul_f32 v[52:53], v[52:53], v[132:133]
    v_pk_mul_f32 v[54:55], v[54:55], v[134:135]
    v_pk_mul_f32 v[56:57], v[56:57], v[136:137]
    v_pk_mul_f32 v[58:59], v[58:59], v[138:139]
    v_pk_mul_f32 v[60:61], v[60:61], v[140:141]
    v_pk_mul_f32 v[62:63], v[62:63], v[142:143]
    ds_read_b128 v[64:67], v6 offset:1024
    ds_read_b128 v[68:71], v6 offset:1152
    ds_read_b128 v[72:75], v6 offset:1280
    ds_read_b128 v[76:79], v6 offset:1408
    v_cvt_pk_bf16_f32 v128, v48, v49
    v_cvt_pk_bf16_f32 v129, v50, v51
    v_cvt_pk_bf16_f32 v130, v52, v53
    v_cvt_pk_bf16_f32 v131, v54, v55
    v_cvt_pk_bf16_f32 v132, v56, v57
    v_cvt_pk_bf16_f32 v133, v58, v59
    v_cvt_pk_bf16_f32 v134, v60, v61
    v_cvt_pk_bf16_f32 v135, v62, v63
    s_add_u32 s6, s73, 0x8000
    buffer_store_dwordx4 v[128:131], v7, s[24:27], s73 offen sc1
    buffer_store_dwordx4 v[132:135], v7, s[24:27], s6 offen sc1
    s_waitcnt lgkmcnt(0)
    v_pk_fma_f32 v[48:49], v[64:65], v[16:17], v[72:73] op_sel:[0,1,0] op_sel_hi:[1,1,1]
    v_pk_fma_f32 v[50:51], v[66:67], v[16:17], v[74:75] op_sel:[0,1,0] op_sel_hi:[1,1,1]
    v_pk_fma_f32 v[52:53], v[68:69], v[16:17], v[76:77] op_sel:[0,1,0] op_sel_hi:[1,1,1]
    v_pk_fma_f32 v[54:55], v[70:71], v[16:17], v[78:79] op_sel:[0,1,0] op_sel_hi:[1,1,1]
    v_pk_fma_f32 v[56:57], v[64:65], v[18:19], v[72:73] op_sel:[0,1,0] op_sel_hi:[1,1,1]
    v_pk_fma_f32 v[58:59], v[66:67], v[18:19], v[74:75] op_sel:[0,1,0] op_sel_hi:[1,1,1]
    v_pk_fma_f32 v[60:61], v[68:69], v[18:19], v[76:77] op_sel:[0,1,0] op_sel_hi:[1,1,1]
    v_pk_fma_f32 v[62:63], v[70:71], v[18:19], v[78:79] op_sel:[0,1,0] op_sel_hi:[1,1,1]
    v_pk_fma_f32 v[144:145], v[144:145], v[16:17], v[48:49] op_sel_hi:[1,0,1]
    v_pk_fma_f32 v[146:147], v[146:147], v[16:17], v[50:51] op_sel_hi:[1,0,1]
    v_pk_fma_f32 v[148:149], v[148:149], v[16:17], v[52:53] op_sel_hi:[1,0,1]
    v_pk_fma_f32 v[150:151], v[150:151], v[16:17], v[54:55] op_sel_hi:[1,0,1]
    v_pk_fma_f32 v[152:153], v[152:153], v[18:19], v[56:57] op_sel_hi:[1,0,1]
    v_pk_fma_f32 v[154:155], v[154:155], v[18:19], v[58:59] op_sel_hi:[1,0,1]
    v_pk_fma_f32 v[156:157], v[156:157], v[18:19], v[60:61] op_sel_hi:[1,0,1]
    v_pk_fma_f32 v[158:159], v[158:159], v[18:19], v[62:63] op_sel_hi:[1,0,1]
    v_pk_mul_f32 v[48:49], v[144:145], v[144:145]
    v_pk_mul_f32 v[50:51], v[146:147], v[146:147]
    v_pk_mul_f32 v[52:53], v[148:149], v[148:149]
    v_pk_mul_f32 v[54:55], v[150:151], v[150:151]
    v_pk_mul_f32 v[56:57], v[152:153], v[152:153]
    v_pk_mul_f32 v[58:59], v[154:155], v[154:155]
    v_pk_mul_f32 v[60:61], v[156:157], v[156:157]
    v_pk_mul_f32 v[62:63], v[158:159], v[158:159]
    v_pk_fma_f32 v[48:49], v[48:49], s[70:71], v[10:11]
    v_pk_fma_f32 v[50:51], v[50:51], s[70:71], v[10:11]
    v_pk_fma_f32 v[52:53], v[52:53], s[70:71], v[10:11]
    v_pk_fma_f32 v[54:55], v[54:55], s[70:71], v[10:11]
    v_pk_fma_f32 v[56:57], v[56:57], s[70:71], v[10:11]
    v_pk_fma_f32 v[58:59], v[58:59], s[70:71], v[10:11]
    v_pk_fma_f32 v[60:61], v[60:61], s[70:71], v[10:11]
    v_pk_fma_f32 v[62:63], v[62:63], s[70:71], v[10:11]
    v_pk_mul_f32 v[48:49], v[48:49], v[144:145]
    v_pk_mul_f32 v[50:51], v[50:51], v[146:147]
    v_pk_mul_f32 v[52:53], v[52:53], v[148:149]
    v_pk_mul_f32 v[54:55], v[54:55], v[150:151]
    v_pk_mul_f32 v[56:57], v[56:57], v[152:153]
    v_pk_mul_f32 v[58:59], v[58:59], v[154:155]
    v_pk_mul_f32 v[60:61], v[60:61], v[156:157]
    v_pk_mul_f32 v[62:63], v[62:63], v[158:159]
    v_exp_f32 v48, v48
    v_exp_f32 v49, v49
    v_exp_f32 v50, v50
    v_exp_f32 v51, v51
    v_exp_f32 v52, v52
    v_exp_f32 v53, v53
    v_exp_f32 v54, v54
    v_exp_f32 v55, v55
    v_exp_f32 v56, v56
    v_exp_f32 v57, v57
    v_exp_f32 v58, v58
    v_exp_f32 v59, v59
    v_exp_f32 v60, v60
    v_exp_f32 v61, v61
    v_exp_f32 v62, v62
    v_exp_f32 v63, v63
    v_pk_add_f32 v[48:49], v[48:49], v[12:13]
    v_pk_add_f32 v[50:51], v[50:51], v[12:13]
    v_pk_add_f32 v[52:53], v[52:53], v[12:13]
    v_pk_add_f32 v[54:55], v[54:55], v[12:13]
    v_pk_add_f32 v[56:57], v[56:57], v[12:13]
    v_pk_add_f32 v[58:59], v[58:59], v[12:13]
    v_pk_add_f32 v[60:61], v[60:61], v[12:13]
    v_pk_add_f32 v[62:63], v[62:63], v[12:13]
    v_rcp_f32 v48, v48
    v_rcp_f32 v49, v49
    v_rcp_f32 v50, v50
    v_rcp_f32 v51, v51
    v_rcp_f32 v52, v52
    v_rcp_f32 v53, v53
    v_rcp_f32 v54, v54
    v_rcp_f32 v55, v55
    v_rcp_f32 v56, v56
    v_rcp_f32 v57, v57
    v_rcp_f32 v58, v58
    v_rcp_f32 v59, v59
    v_rcp_f32 v60, v60
    v_rcp_f32 v61, v61
    v_rcp_f32 v62, v62
    v_rcp_f32 v63, v63
    v_pk_mul_f32 v[48:49], v[48:49], v[144:145]
    v_pk_mul_f32 v[50:51], v[50:51], v[146:147]
    v_pk_mul_f32 v[52:53], v[52:53], v[148:149]
    v_pk_mul_f32 v[54:55], v[54:55], v[150:151]
    v_pk_mul_f32 v[56:57], v[56:57], v[152:153]
    v_pk_mul_f32 v[58:59], v[58:59], v[154:155]
    v_pk_mul_f32 v[60:61], v[60:61], v[156:157]
    v_pk_mul_f32 v[62:63], v[62:63], v[158:159]
    v_cvt_pk_bf16_f32 v144, v48, v49
    v_cvt_pk_bf16_f32 v145, v50, v51
    v_cvt_pk_bf16_f32 v146, v52, v53
    v_cvt_pk_bf16_f32 v147, v54, v55
    v_cvt_pk_bf16_f32 v148, v56, v57
    v_cvt_pk_bf16_f32 v149, v58, v59
    v_cvt_pk_bf16_f32 v150, v60, v61
    v_cvt_pk_bf16_f32 v151, v62, v63
    buffer_load_dwordx2 v[32:33], v9, s[28:31], 0 offen offset:0 sc1
    buffer_load_dwordx2 v[34:35], v9, s[28:31], 0 offen offset:1024 sc1
    buffer_load_dwordx2 v[36:37], v9, s[28:31], 0 offen offset:64 sc1
    buffer_load_dwordx2 v[38:39], v9, s[28:31], 0 offen offset:1088 sc1
    s_add_u32 s6, s74, 0x8000
    buffer_store_dwordx4 v[144:147], v7, s[24:27], s74 offen sc1
    buffer_store_dwordx4 v[148:151], v7, s[24:27], s6 offen sc1
    s_mov_b32 s66, 0x40000
    s_waitcnt vmcnt(2)
    s_branch L_k4_pchk_118
L_k4_poll_116:
    buffer_load_dwordx2 v[32:33], v9, s[28:31], 0 offen offset:0 sc1
    buffer_load_dwordx2 v[34:35], v9, s[28:31], 0 offen offset:1024 sc1
    buffer_load_dwordx2 v[36:37], v9, s[28:31], 0 offen offset:64 sc1
    buffer_load_dwordx2 v[38:39], v9, s[28:31], 0 offen offset:1088 sc1
    s_waitcnt vmcnt(0)
L_k4_pchk_118:
    v_max_u32 v48, v33, v35
    v_max3_u32 v48, v48, v37, v39
    v_cmp_eq_u32 vcc, -1, v48
    s_sub_u32 s66, s66, 1
    s_cbranch_scc1 L_k4_pdone_117
    s_cbranch_vccz L_k4_pdone_117
    s_sleep 1
    s_branch L_k4_poll_116
L_k4_pdone_117:
    v_pk_add_f32 v[32:33], v[32:33], v[34:35]
    v_pk_add_f32 v[36:37], v[36:37], v[38:39]
    s_nop 0
    v_add_f32_dpp v32, v32, v32 quad_perm:[1,0,3,2] row_mask:0xf bank_mask:0xf
    v_add_f32_dpp v33, v33, v33 quad_perm:[1,0,3,2] row_mask:0xf bank_mask:0xf
    v_add_f32_dpp v36, v36, v36 quad_perm:[1,0,3,2] row_mask:0xf bank_mask:0xf
    v_add_f32_dpp v37, v37, v37 quad_perm:[1,0,3,2] row_mask:0xf bank_mask:0xf
    v_add_f32_dpp v32, v32, v32 quad_perm:[2,3,0,1] row_mask:0xf bank_mask:0xf
    v_add_f32_dpp v33, v33, v33 quad_perm:[2,3,0,1] row_mask:0xf bank_mask:0xf
    v_add_f32_dpp v36, v36, v36 quad_perm:[2,3,0,1] row_mask:0xf bank_mask:0xf
    v_add_f32_dpp v37, v37, v37 quad_perm:[2,3,0,1] row_mask:0xf bank_mask:0xf
    v_add_f32_dpp v32, v32, v32 row_half_mirror row_mask:0xf bank_mask:0xf
    v_add_f32_dpp v33, v33, v33 row_half_mirror row_mask:0xf bank_mask:0xf
    v_add_f32_dpp v36, v36, v36 row_half_mirror row_mask:0xf bank_mask:0xf
    v_add_f32_dpp v37, v37, v37 row_half_mirror row_mask:0xf bank_mask:0xf
    v_mul_f32 v32, 0x3a124925, v32
    v_mul_f32 v36, 0x3a124925, v36
    v_mul_f32 v16, 0x3a124925, v33
    v_mul_f32 v18, 0x3a124925, v37
    v_fma_f32 v16, -v32, v32, v16
    v_fma_f32 v18, -v36, v36, v18
    v_max_f32 v16, 0, v16
    v_max_f32 v18, 0, v18
    v_add_f32 v16, 0x3727c5ac, v16
    v_add_f32 v18, 0x3727c5ac, v18
    v_rsq_f32 v16, v16
    v_rsq_f32 v18, v18
    s_nop 0
    v_mul_f32 v17, -v32, v16
    v_mul_f32 v19, -v36, v18
    v_cndmask_b32 v20, v16, v18, s[68:69]
    v_cndmask_b32 v21, v17, v19, s[68:69]
    v_pk_fma_f32 v[80:81], v[80:81], v[16:17], v[16:17] op_sel:[0,0,1] op_sel_hi:[1,0,1]
    v_pk_fma_f32 v[82:83], v[82:83], v[16:17], v[16:17] op_sel:[0,0,1] op_sel_hi:[1,0,1]
    v_pk_fma_f32 v[84:85], v[84:85], v[16:17], v[16:17] op_sel:[0,0,1] op_sel_hi:[1,0,1]
    v_pk_fma_f32 v[86:87], v[86:87], v[16:17], v[16:17] op_sel:[0,0,1] op_sel_hi:[1,0,1]
    v_pk_fma_f32 v[88:89], v[88:89], v[18:19], v[18:19] op_sel:[0,0,1] op_sel_hi:[1,0,1]
    v_pk_fma_f32 v[90:91], v[90:91], v[18:19], v[18:19] op_sel:[0,0,1] op_sel_hi:[1,0,1]
    v_pk_fma_f32 v[92:93], v[92:93], v[18:19], v[18:19] op_sel:[0,0,1] op_sel_hi:[1,0,1]
    v_pk_fma_f32 v[94:95], v[94:95], v[18:19], v[18:19] op_sel:[0,0,1] op_sel_hi:[1,0,1]
    v_cvt_pk_bf16_f32 v48, v80, v81
    v_cvt_pk_bf16_f32 v49, v82, v83
    v_cvt_pk_bf16_f32 v50, v84, v85
    v_cvt_pk_bf16_f32 v51, v86, v87
    v_cvt_pk_bf16_f32 v52, v88, v89
    v_cvt_pk_bf16_f32 v53, v90, v91
    v_cvt_pk_bf16_f32 v54, v92, v93
    v_cvt_pk_bf16_f32 v55, v94, v95
    s_add_u32 s6, s72, 0x8000
    buffer_store_dwordx4 v[48:51], v7, s[24:27], s72 offen sc1
    buffer_store_dwordx4 v[52:55], v7, s[24:27], s6 offen sc1
    v_pk_fma_f32 v[96:97], v[96:97], v[20:21], v[20:21] op_sel:[0,0,1] op_sel_hi:[1,0,1]
    v_pk_fma_f32 v[98:99], v[98:99], v[20:21], v[20:21] op_sel:[0,0,1] op_sel_hi:[1,0,1]
    v_pk_fma_f32 v[100:101], v[100:101], v[20:21], v[20:21] op_sel:[0,0,1] op_sel_hi:[1,0,1]
    v_pk_fma_f32 v[102:103], v[102:103], v[20:21], v[20:21] op_sel:[0,0,1] op_sel_hi:[1,0,1]
    v_cvt_pk_bf16_f32 v56, v96, v97
    v_cvt_pk_bf16_f32 v57, v98, v99
    v_cvt_pk_bf16_f32 v58, v100, v101
    v_cvt_pk_bf16_f32 v59, v102, v103
    buffer_store_dwordx4 v[56:59], v8, s[24:27], s75 offen sc1
L_k4_te_112:
.p2align 3
L_code_k5:
L_phase_k5:
    s_mov_b64 exec, -1
    s_lshr_b32 s6, s2, 3
    s_and_b32 s4, s6, 3
    s_and_b32 s7, s2, 3
    s_lshl_b32 s7, s7, 2
    s_add_u32 s4, s4, s7
    s_lshr_b32 s5, s6, 2
    s_bfe_u32 s7, s2, 0x10002
    s_mul_i32 s7, s7, 7
    s_add_u32 s5, s5, s7
    s_cmp_ge_u32 s2, 224
    s_cbranch_scc1 L_k5_x_120
    s_mul_i32 s6, s4, 524288
    s_add_u32 s8, s48, s6
    s_addc_u32 s9, s49, 0
    s_mov_b32 s10, 0x80000
    s_mov_b32 s11, 0x00020000
    s_mul_i32 s6, s5, 0
    s_sub_u32 s7, 0x800000, s6
    s_add_u32 s6, s6, 0x2000000
    s_add_u32 s12, s62, s6
    s_addc_u32 s13, s63, 0
    s_mov_b32 s14, s7
    s_mov_b32 s15, 0x00020000
    s_lshl_b32 s6, s4, 19
    s_add_u32 s32, s6, 0x1800000
    s_add_u32 s20, s62, s32
    s_addc_u32 s21, s63, 0
    s_mov_b32 s22, 0x80000
    s_mov_b32 s23, 0x00020000
    s_add_u32 s32, s6, 0x2800000
    s_add_u32 s24, s62, s32
    s_addc_u32 s25, s63, 0
    s_mov_b32 s26, 0x80000
    s_mov_b32 s27, 0x00020000
    s_lshl_b32 s6, s4, 8
    s_add_u32 s28, s50, s6
    s_addc_u32 s29, s51, 0
    s_mov_b32 s30, 0x100
    s_mov_b32 s31, 0x00020000
    s_lshl_b32 s7, s5, 1
    s_add_u32 s6, s7, 4
    s_mul_i32 s6, s6, 37
    s_lshr_b32 s6, s6, 8
    s_add_u32 s72, s7, s6
    s_lshl_b32 s72, s72, 7
    s_add_u32 s7, s7, 1
    s_add_u32 s6, s7, 4
    s_mul_i32 s6, s6, 37
    s_lshr_b32 s6, s6, 8
    s_add_u32 s73, s7, s6
    s_lshl_b32 s73, s73, 7
    s_add_u32 s74, s72, 0x8000
    s_add_u32 s75, s73, 0x8000
    s_cmp_ge_u32 s3, 4
    s_cbranch_scc1 L_k5_ldr_119
    s_setprio 2
    v_and_b32 v1, 63, v0
    s_lshr_b32 s34, s3, 1
    s_mul_i32 s34, s34, 64
    s_and_b32 s35, s3, 1
    v_and_b32 v10, 31, v1
    v_bfe_u32 v11, v1, 1, 3
    v_lshrrev_b32 v12, 5, v1
    v_xor_b32 v11, v11, v12
    v_add_u32 v10, s34, v10
    v_lshlrev_b32 v10, 7, v10
    v_lshl_add_u32 v2, v11, 4, v10
    v_xor_b32 v3, 32, v2
    v_xor_b32 v4, 64, v2
    v_xor_b32 v5, 96, v2
    v_bfe_u32 v10, v1, 2, 2
    v_lshl_add_u32 v10, v12, 3, v10
    v_bfe_u32 v11, v1, 4, 1
    v_lshlrev_b32 v11, 5, v11
    v_and_b32 v13, 1, v1
    v_lshl_add_u32 v11, v13, 4, v11
    v_bfe_u32 v13, v1, 1, 1
    v_lshl_add_u32 v11, v13, 3, v11
    v_bfe_u32 v13, v1, 3, 1
    v_lshl_add_u32 v11, v13, 6, v11
    v_lshl_add_u32 v6, v10, 7, v11
    s_lshl_b32 s6, s35, 6
    v_xor_b32 v6, s6, v6
    v_and_b32 v10, 31, v1
    v_add_u32 v10, s34, v10
    v_lshrrev_b32 v136, 5, v1
    v_lshlrev_b32 v136, 1, v136
    v_and_b32 v137, 7, v1
    v_xor_b32 v136, v136, v137
    v_lshlrev_b32 v136, 4, v136
    v_lshl_add_u32 v136, v10, 8, v136
    s_lshl_b32 s6, s35, 7
    v_add_u32 v136, s6, v136
    v_xor_b32 v137, 16, v136
    v_xor_b32 v138, 64, v136
    v_xor_b32 v139, 80, v136
    v_lshrrev_b32 v240, 5, v1
    v_lshlrev_b32 v240, 7, v240
    v_bfe_u32 v241, v1, 1, 4
    v_lshl_add_u32 v240, v241, 2, v240
    s_mul_i32 s6, s5, 74
    s_add_u32 s6, s6, 37
    s_lshr_b32 s6, s6, 8
    s_lshl_b32 s6, s6, 9
    s_add_u32 s6, s6, 4096
    v_add_u32 v241, s6, v240
    s_mul_i32 s6, s5, 74
    s_lshr_b32 s6, s6, 8
    s_lshl_b32 s6, s6, 9
    s_add_u32 s6, s6, 4096
    v_add_u32 v240, s6, v240
    v_mov_b32 v48, 0
    v_mov_b32 v49, 0
    v_mov_b32 v50, 0
    v_mov_b32 v51, 0
    v_mov_b32 v52, 0
    v_mov_b32 v53, 0
    v_mov_b32 v54, 0
    v_mov_b32 v55, 0
    v_mov_b32 v56, 0
    v_mov_b32 v57, 0
    v_mov_b32 v58, 0
    v_mov_b32 v59, 0
    v_mov_b32 v60, 0
    v_mov_b32 v61, 0
    v_mov_b32 v62, 0
    v_mov_b32 v63, 0
    v_mov_b32 v64, 0
    v_mov_b32 v65, 0
    v_mov_b32 v66, 0
    v_mov_b32 v67, 0
    v_mov_b32 v68, 0
    v_mov_b32 v69, 0
    v_mov_b32 v70, 0
    v_mov_b32 v71, 0
    v_mov_b32 v72, 0
    v_mov_b32 v73, 0
    v_mov_b32 v74, 0
    v_mov_b32 v75, 0
    v_mov_b32 v76, 0
    v_mov_b32 v77, 0
    v_mov_b32 v78, 0
    v_mov_b32 v79, 0
    v_mov_b32 v80, 0
    v_mov_b32 v81, 0
    v_mov_b32 v82, 0
    v_mov_b32 v83, 0
    v_mov_b32 v84, 0
    v_mov_b32 v85, 0
    v_mov_b32 v86, 0
    v_mov_b32 v87, 0
    v_mov_b32 v88, 0
    v_mov_b32 v89, 0
    v_mov_b32 v90, 0
    v_mov_b32 v91, 0
    v_mov_b32 v92, 0
    v_mov_b32 v93, 0
    v_mov_b32 v94, 0
    v_mov_b32 v95, 0
    v_mov_b32 v96, 0
    v_mov_b32 v97, 0
    v_mov_b32 v98, 0
    v_mov_b32 v99, 0
    v_mov_b32 v100, 0
    v_mov_b32 v101, 0
    v_mov_b32 v102, 0
    v_mov_b32 v103, 0
    v_mov_b32 v104, 0
    v_mov_b32 v105, 0
    v_mov_b32 v106, 0
    v_mov_b32 v107, 0
    v_mov_b32 v108, 0
    v_mov_b32 v109, 0
    v_mov_b32 v110, 0
    v_mov_b32 v111, 0
    s_waitcnt vmcnt(0)
    s_barrier
    s_add_u32 s68, s62, 0xc0000
    s_addc_u32 s69, s63, 0
    s_mov_b32 s70, 0x6000
    s_mov_b32 s71, 0x00020000
    v_mov_b32 v10, 0
    s_cmp_eq_u32 s3, 0
    s_cselect_b64 exec, 1, 0
    buffer_store_dword v10, v10, s[68:71], s100 offen sc1
    s_mov_b64 exec, -1
    s_cmp_lg_u32 s3, 1
    s_cbranch_scc1 L_k5_np_121
    s_mov_b32 s66, 262144
L_k5_dl_122:
    buffer_load_dword v242, v240, s[68:71], 0 offen offset:0 sc1
    buffer_load_dword v243, v240, s[68:71], 0 offen offset:256 sc1
    buffer_load_dword v244, v241, s[68:71], 0 offen offset:0 sc1
    buffer_load_dword v245, v241, s[68:71], 0 offen offset:256 sc1
    s_waitcnt vmcnt(0)
    v_max3_u32 v242, v242, v243, v244
    v_max_u32 v242, v242, v245
    v_cmp_ne_u32 vcc, -1, v242
    s_and_b32 s67, vcc_lo, vcc_hi
    s_sub_u32 s66, s66, 1
    s_cselect_b32 s67, 0xffffffff, s67
    s_bcnt1_i32_b32 s6, s67
    s_lshl_b32 s65, s4, 1
    s_bitcmp1_b32 s67, s65
    s_cselect_b32 s6, s6, 0
    s_cmp_ge_u32 s6, 16
    s_cbranch_scc1 L_k5_dd_123
    s_sleep 1
    s_branch L_k5_dl_122
L_k5_dd_123:
    v_mov_b32 v240, s67
    v_mov_b32 v241, 163832
    ds_write_b32 v241, v240
    s_waitcnt lgkmcnt(0)
L_k5_np_121:
    s_barrier
    s_lshl_b32 s100, s4, 7
    s_lshl_b32 s6, s5, 2
    s_add_u32 s100, s100, s6
    s_add_u32 s100, s100, 6144
    s_mov_b32 s64, 0
    s_mov_b32 s67, 32768
    s_mov_b32 s6, 32
    s_barrier
    ds_read_b64_tr_b16 v[24:25], v6 offset:16384
    ds_read_b64_tr_b16 v[26:27], v6 offset:16896
    ds_read_b128 v[16:19], v2 offset:0
    ds_read_b128 v[20:23], v2 offset:4096
    ds_read_b64_tr_b16 v[28:29], v6 offset:24576
    ds_read_b64_tr_b16 v[30:31], v6 offset:25088
    v_lshrrev_b32 v10, 3, v1
    s_lshl_b32 s32, s3, 4
    v_add_u32 v132, s32, v10
    v_and_b32 v134, 7, v1
    v_lshlrev_b32 v134, 1, v134
    v_xor_b32 v134, v134, v10
    v_lshlrev_b32 v134, 4, v134
    v_lshl_add_u32 v134, v132, 8, v134
    v_xor_b32 v135, 16, v134
    v_lshlrev_b32 v12, 1, v132
    v_and_b32 v11, 7, v1
    v_lshlrev_b32 v11, 4, v11
    v_lshl_add_u32 v132, v132, 12, v11
    buffer_load_ushort v128, v12, s[28:31], 0 offen offset:0
    buffer_load_ushort v130, v12, s[28:31], 0 offen offset:16
    buffer_load_dwordx4 v[112:115], v132, s[20:23], s72 offen sc1
    buffer_load_dwordx4 v[116:119], v132, s[20:23], s73 offen sc1
    buffer_load_dwordx4 v[120:123], v132, s[20:23], s74 offen sc1
    buffer_load_dwordx4 v[124:127], v132, s[20:23], s75 offen sc1
.p2align 4
L_k5_cl_124:
    s_add_u32 s64, s64, 32768
    s_cmp_eq_u32 s64, 131072
    s_cselect_b32 s65, 0xfffe8000, s67
    s_cselect_b32 s64, 0, s64
    s_waitcnt lgkmcnt(0)
    v_mfma_f32_32x32x16_bf16 v[48:63], v[24:27], v[16:19], v[48:63]
    ds_read_b64_tr_b16 v[40:41], v6 offset:18432
    ds_read_b64_tr_b16 v[42:43], v6 offset:18944
    ds_read_b128 v[32:35], v3 offset:0
    v_mfma_f32_32x32x16_bf16 v[64:79], v[24:27], v[20:23], v[64:79]
    ds_read_b128 v[36:39], v3 offset:4096
    ds_read_b64_tr_b16 v[44:45], v6 offset:26624
    ds_read_b64_tr_b16 v[46:47], v6 offset:27136
    v_mfma_f32_32x32x16_bf16 v[80:95], v[28:31], v[16:19], v[80:95]
    v_add_u32 v3, s65, v3
    v_add_u32 v2, s65, v2
    v_mfma_f32_32x32x16_bf16 v[96:111], v[28:31], v[20:23], v[96:111]
    s_waitcnt lgkmcnt(0)
    v_mfma_f32_32x32x16_bf16 v[48:63], v[40:43], v[32:35], v[48:63]
    ds_read_b64_tr_b16 v[24:25], v6 offset:20480
    ds_read_b64_tr_b16 v[26:27], v6 offset:20992
    ds_read_b128 v[16:19], v4 offset:0
    v_mfma_f32_32x32x16_bf16 v[64:79], v[40:43], v[36:39], v[64:79]
    ds_read_b128 v[20:23], v4 offset:4096
    ds_read_b64_tr_b16 v[28:29], v6 offset:28672
    ds_read_b64_tr_b16 v[30:31], v6 offset:29184
    v_mfma_f32_32x32x16_bf16 v[80:95], v[44:47], v[32:35], v[80:95]
    v_add_u32 v4, s65, v4
    v_mfma_f32_32x32x16_bf16 v[96:111], v[44:47], v[36:39], v[96:111]
    s_waitcnt lgkmcnt(0)
    v_mfma_f32_32x32x16_bf16 v[48:63], v[24:27], v[16:19], v[48:63]
    ds_read_b64_tr_b16 v[40:41], v6 offset:22528
    ds_read_b64_tr_b16 v[42:43], v6 offset:23040
    ds_read_b128 v[32:35], v5 offset:0
    v_mfma_f32_32x32x16_bf16 v[64:79], v[24:27], v[20:23], v[64:79]
    ds_read_b128 v[36:39], v5 offset:4096
    ds_read_b64_tr_b16 v[44:45], v6 offset:30720
    ds_read_b64_tr_b16 v[46:47], v6 offset:31232
    v_mfma_f32_32x32x16_bf16 v[80:95], v[28:31], v[16:19], v[80:95]
    v_add_u32 v5, s65, v5
    v_add_u32 v6, s65, v6
    v_mfma_f32_32x32x16_bf16 v[96:111], v[28:31], v[20:23], v[96:111]
    s_waitcnt lgkmcnt(0)
    v_mfma_f32_32x32x16_bf16 v[48:63], v[40:43], v[32:35], v[48:63]
    s_sub_u32 s6, s6, 1
    s_barrier
    ds_read_b64_tr_b16 v[24:25], v6 offset:16384
    ds_read_b64_tr_b16 v[26:27], v6 offset:16896
    v_mfma_f32_32x32x16_bf16 v[64:79], v[40:43], v[36:39], v[64:79]
    ds_read_b128 v[16:19], v2 offset:0
    ds_read_b128 v[20:23], v2 offset:4096
    v_mfma_f32_32x32x16_bf16 v[80:95], v[44:47], v[32:35], v[80:95]
    ds_read_b64_tr_b16 v[28:29], v6 offset:24576
    ds_read_b64_tr_b16 v[30:31], v6 offset:25088
    v_mfma_f32_32x32x16_bf16 v[96:111], v[44:47], v[36:39], v[96:111]
    s_cmp_lg_u32 s6, 0
    s_cbranch_scc1 L_k5_cl_124
    s_waitcnt lgkmcnt(0)
    s_nop 10
    ds_write_b128 v136, v[48:51] offset:0
    ds_write_b128 v137, v[52:55] offset:0
    ds_write_b128 v138, v[56:59] offset:0
    ds_write_b128 v139, v[60:63] offset:0
    ds_write_b128 v136, v[64:67] offset:8192
    ds_write_b128 v137, v[68:71] offset:8192
    ds_write_b128 v138, v[72:75] offset:8192
    ds_write_b128 v139, v[76:79] offset:8192
    ds_write_b128 v136, v[80:83] offset:32768
    ds_write_b128 v137, v[84:87] offset:32768
    ds_write_b128 v138, v[88:91] offset:32768
    ds_write_b128 v139, v[92:95] offset:32768
    ds_write_b128 v136, v[96:99] offset:40960
    ds_write_b128 v137, v[100:103] offset:40960
    ds_write_b128 v138, v[104:107] offset:40960
    ds_write_b128 v139, v[108:111] offset:40960
    s_setprio 0
    s_branch L_k5_com_125
L_k5_ldr_119:
    s_sub_u32 s34, s3, 4
    v_and_b32 v1, 63, v0
    v_lshrrev_b32 v2, 3, v1
    v_and_b32 v3, 7, v1
    s_lshl_b32 s6, s34, 3
    v_add_u32 v2, s6, v2
    v_bfe_u32 v4, v2, 1, 3
    v_xor_b32 v4, v4, v3
    s_mov_b32 s6, 4096
    v_mul_lo_u32 v5, s6, v2
    v_lshl_add_u32 v16, v4, 4, v5
    v_add_u32 v17, 131072, v16
    v_add_u32 v18, 131072, v17
    v_add_u32 v19, 131072, v18
    v_bfe_u32 v4, v2, 1, 1
    v_lshlrev_b32 v4, 2, v4
    v_xor_b32 v4, v4, v3
    s_mov_b32 s6, 4096
    v_mul_lo_u32 v5, s6, v2
    v_lshl_add_u32 v5, v4, 4, v5
    v_add_u32 v20, s72, v5
    v_add_u32 v21, 131072, v20
    v_add_u32 v22, s73, v5
    v_add_u32 v23, 131072, v22
    s_lshl_b32 s64, s34, 10
    s_add_u32 s65, s64, 131072
    s_mov_b32 s7, 0
    s_mov_b32 s33, 0
    s_setprio 0
    s_waitcnt vmcnt(0)
    s_barrier
    s_mov_b32 s6, 0
    s_add_u32 m0, s64, 0
    s_nop 0
    buffer_load_dwordx4 v16, s[8:11], s6 offen lds
    s_add_u32 m0, s64, 4096
    s_nop 0
    buffer_load_dwordx4 v17, s[8:11], s6 offen lds
    s_add_u32 m0, s64, 8192
    s_nop 0
    buffer_load_dwordx4 v18, s[8:11], s6 offen lds
    s_add_u32 m0, s64, 12288
    s_nop 0
    buffer_load_dwordx4 v19, s[8:11], s6 offen lds
    s_mov_b32 s6, 128
    s_add_u32 m0, s64, 32768
    s_nop 0
    buffer_load_dwordx4 v16, s[8:11], s6 offen lds
    s_add_u32 m0, s64, 36864
    s_nop 0
    buffer_load_dwordx4 v17, s[8:11], s6 offen lds
    s_add_u32 m0, s64, 40960
    s_nop 0
    buffer_load_dwordx4 v18, s[8:11], s6 offen lds
    s_add_u32 m0, s64, 45056
    s_nop 0
    buffer_load_dwordx4 v19, s[8:11], s6 offen lds
    s_mov_b32 s6, 256
    s_add_u32 m0, s64, 65536
    s_nop 0
    buffer_load_dwordx4 v16, s[8:11], s6 offen lds
    s_add_u32 m0, s64, 69632
    s_nop 0
    buffer_load_dwordx4 v17, s[8:11], s6 offen lds
    s_add_u32 m0, s64, 73728
    s_nop 0
    buffer_load_dwordx4 v18, s[8:11], s6 offen lds
    s_add_u32 m0, s64, 77824
    s_nop 0
    buffer_load_dwordx4 v19, s[8:11], s6 offen lds
    v_lshrrev_b32 v30, 5, v1
    v_lshlrev_b32 v30, 7, v30
    v_bfe_u32 v31, v1, 1, 4
    v_lshl_add_u32 v30, v31, 2, v30
    s_mul_i32 s6, s5, 74
    s_add_u32 s6, s6, 37
    s_lshr_b32 s6, s6, 8
    s_lshl_b32 s6, s6, 9
    s_add_u32 s6, s6, 4096
    v_add_u32 v31, s6, v30
    s_mul_i32 s6, s5, 74
    s_lshr_b32 s6, s6, 8
    s_lshl_b32 s6, s6, 9
    s_add_u32 s6, s6, 4096
    v_add_u32 v30, s6, v30
    v_mov_b32 v32, -1
    v_mov_b32 v33, -1
    v_mov_b32 v34, -1
    v_mov_b32 v35, -1
    v_mov_b32 v36, 163832
    s_barrier
    ds_read_b32 v36, v36
    s_waitcnt lgkmcnt(0)
    v_readfirstlane_b32 s99, v36
    s_andn2_b32 s101, 0xffffffff, s99
    s_and_b32 s6, s101, 7
    s_cbranch_scc1 L_k5_slow_128
    s_mov_b32 s6, 0
    s_add_u32 m0, s64, 16384
    s_nop 0
    buffer_load_dwordx4 v20, s[12:15], s6 offen sc1 lds
    s_add_u32 m0, s64, 20480
    s_nop 0
    buffer_load_dwordx4 v21, s[12:15], s6 offen sc1 lds
    s_add_u32 m0, s64, 24576
    s_nop 0
    buffer_load_dwordx4 v22, s[12:15], s6 offen sc1 lds
    s_add_u32 m0, s64, 28672
    s_nop 0
    buffer_load_dwordx4 v23, s[12:15], s6 offen sc1 lds
    s_mov_b32 s6, 262144
    s_add_u32 m0, s64, 49152
    s_nop 0
    buffer_load_dwordx4 v20, s[12:15], s6 offen sc1 lds
    s_add_u32 m0, s64, 53248
    s_nop 0
    buffer_load_dwordx4 v21, s[12:15], s6 offen sc1 lds
    s_add_u32 m0, s64, 57344
    s_nop 0
    buffer_load_dwordx4 v22, s[12:15], s6 offen sc1 lds
    s_add_u32 m0, s64, 61440
    s_nop 0
    buffer_load_dwordx4 v23, s[12:15], s6 offen sc1 lds
    s_mov_b32 s6, 524288
    s_add_u32 m0, s64, 81920
    s_nop 0
    buffer_load_dwordx4 v20, s[12:15], s6 offen sc1 lds
    s_add_u32 m0, s64, 86016
    s_nop 0
    buffer_load_dwordx4 v21, s[12:15], s6 offen sc1 lds
    s_add_u32 m0, s64, 90112
    s_nop 0
    buffer_load_dwordx4 v22, s[12:15], s6 offen sc1 lds
    s_add_u32 m0, s64, 94208
    s_nop 0
    buffer_load_dwordx4 v23, s[12:15], s6 offen sc1 lds
    s_andn2_b32 s99, s99, 7
L_k5_pdone_127:
    s_ff1_i32_b32 s6, s99
    s_bitset0_b32 s99, s6
    s_mul_i32 s33, s6, 262144
    s_lshl_b32 s7, s6, 7
    s_add_u32 s64, s64, 98304
    s_lshl_b32 s100, s4, 7
    s_lshl_b32 s6, s5, 2
    s_add_u32 s100, s100, s6
    s_add_u32 s100, s100, 6144
    v_and_b32 v2, 255, v0
    v_lshlrev_b32 v2, 7, v2
    s_getpc_b64 s[68:69]
L_pc_129:
    s_sub_u32 s68, s68, L_pc_129-L_code_k5
    s_subb_u32 s69, s69, 0
    s_mov_b32 s70, L_code_end-L_code_k5
    s_mov_b32 s71, 0x00020000
    buffer_load_dword v3, v2, s[68:71], 0 offen
    s_add_u32 s68, s62, 0xc0000
    s_addc_u32 s69, s63, 0
    s_mov_b32 s70, 0x6000
    s_mov_b32 s71, 0x00020000
    s_waitcnt vmcnt(9)
    s_barrier
    s_add_u32 m0, s64, 0
    s_nop 0
    buffer_load_dwordx4 v16, s[8:11], s7 offen lds
    s_add_u32 m0, s64, 4096
    s_nop 0
    buffer_load_dwordx4 v17, s[8:11], s7 offen lds
    s_add_u32 m0, s64, 8192
    s_nop 0
    buffer_load_dwordx4 v18, s[8:11], s7 offen lds
    s_add_u32 m0, s64, 12288
    s_nop 0
    buffer_load_dwordx4 v19, s[8:11], s7 offen lds
    s_add_u32 m0, s64, 16384
    s_nop 0
    buffer_load_dwordx4 v20, s[12:15], s33 offen sc1 lds
    s_add_u32 m0, s64, 20480
    s_nop 0
    buffer_load_dwordx4 v21, s[12:15], s33 offen sc1 lds
    s_add_u32 m0, s64, 24576
    s_nop 0
    buffer_load_dwordx4 v22, s[12:15], s33 offen sc1 lds
    s_add_u32 m0, s64, 28672
    s_nop 0
    buffer_load_dwordx4 v23, s[12:15], s33 offen sc1 lds
    s_cmp_eq_u32 s99, 0
    s_cbranch_scc1 L_k5_lt_130
L_k5_ltb_131:
    s_ff1_i32_b32 s6, s99
    s_bitset0_b32 s99, s6
    s_mul_i32 s33, s6, 262144
    s_lshl_b32 s7, s6, 7
    s_bcnt1_i32_b32 s6, s99
    s_cmp_eq_u32 s6, 2
    s_cbranch_scc1 L_k5_pp_132
L_k5_ppb_133:
    s_add_u32 s64, s64, 32768
    s_cmp_eq_u32 s64, s65
    s_cselect_b32 s6, 131072, 0
    s_sub_u32 s64, s64, s6
    s_waitcnt vmcnt(13)
    s_barrier
    s_add_u32 m0, s64, 0
    s_nop 0
    buffer_load_dwordx4 v16, s[8:11], s7 offen lds
    s_add_u32 m0, s64, 4096
    s_nop 0
    buffer_load_dwordx4 v17, s[8:11], s7 offen lds
    s_add_u32 m0, s64, 8192
    s_nop 0
    buffer_load_dwordx4 v18, s[8:11], s7 offen lds
    s_add_u32 m0, s64, 12288
    s_nop 0
    buffer_load_dwordx4 v19, s[8:11], s7 offen lds
    s_add_u32 m0, s64, 16384
    s_nop 0
    buffer_load_dwordx4 v20, s[12:15], s33 offen sc1 lds
    s_add_u32 m0, s64, 20480
    s_nop 0
    buffer_load_dwordx4 v21, s[12:15], s33 offen sc1 lds
    s_add_u32 m0, s64, 24576
    s_nop 0
    buffer_load_dwordx4 v22, s[12:15], s33 offen sc1 lds
    s_add_u32 m0, s64, 28672
    s_nop 0
    buffer_load_dwordx4 v23, s[12:15], s33 offen sc1 lds
    s_cmp_eq_u32 s99, 0
    s_cbranch_scc1 L_k5_lt_134
L_k5_ltb_135:
    s_ff1_i32_b32 s6, s99
    s_bitset0_b32 s99, s6
    s_mul_i32 s33, s6, 262144
    s_lshl_b32 s7, s6, 7
    s_bcnt1_i32_b32 s6, s99
    s_cmp_eq_u32 s6, 2
    s_cbranch_scc1 L_k5_pp_136
L_k5_ppb_137:
    s_add_u32 s64, s64, 32768
    s_cmp_eq_u32 s64, s65
    s_cselect_b32 s6, 131072, 0
    s_sub_u32 s64, s64, s6
    s_mov_b32 s66, 27
.p2align 4
L_k5_ll_138:
    s_waitcnt vmcnt(16)
    s_barrier
    s_add_u32 m0, s64, 0
    s_nop 0
    buffer_load_dwordx4 v16, s[8:11], s7 offen lds
    s_add_u32 m0, s64, 4096
    s_nop 0
    buffer_load_dwordx4 v17, s[8:11], s7 offen lds
    s_add_u32 m0, s64, 8192
    s_nop 0
    buffer_load_dwordx4 v18, s[8:11], s7 offen lds
    s_add_u32 m0, s64, 12288
    s_nop 0
    buffer_load_dwordx4 v19, s[8:11], s7 offen lds
    s_add_u32 m0, s64, 16384
    s_nop 0
    buffer_load_dwordx4 v20, s[12:15], s33 offen sc1 lds
    s_add_u32 m0, s64, 20480
    s_nop 0
    buffer_load_dwordx4 v21, s[12:15], s33 offen sc1 lds
    s_add_u32 m0, s64, 24576
    s_nop 0
    buffer_load_dwordx4 v22, s[12:15], s33 offen sc1 lds
    s_add_u32 m0, s64, 28672
    s_nop 0
    buffer_load_dwordx4 v23, s[12:15], s33 offen sc1 lds
    s_cmp_eq_u32 s99, 0
    s_cbranch_scc1 L_k5_lt_139
L_k5_ltb_140:
    s_ff1_i32_b32 s6, s99
    s_bitset0_b32 s99, s6
    s_mul_i32 s33, s6, 262144
    s_lshl_b32 s7, s6, 7
    s_bcnt1_i32_b32 s6, s99
    s_cmp_eq_u32 s6, 2
    s_cbranch_scc1 L_k5_pp_141
L_k5_ppb_142:
    s_add_u32 s64, s64, 32768
    s_cmp_eq_u32 s64, s65
    s_cselect_b32 s6, 131072, 0
    s_sub_u32 s64, s64, s6
    s_sub_u32 s66, s66, 1
    s_cmp_lg_u32 s66, 0
    s_cbranch_scc1 L_k5_ll_138
    s_waitcnt vmcnt(16)
    s_barrier
    v_lshrrev_b32 v10, 3, v1
    s_lshl_b32 s32, s3, 4
    v_add_u32 v132, s32, v10
    v_and_b32 v134, 7, v1
    v_lshlrev_b32 v134, 1, v134
    v_xor_b32 v134, v134, v10
    v_lshlrev_b32 v134, 4, v134
    v_lshl_add_u32 v134, v132, 8, v134
    v_xor_b32 v135, 16, v134
    v_lshlrev_b32 v12, 1, v132
    v_and_b32 v11, 7, v1
    v_lshlrev_b32 v11, 4, v11
    v_lshl_add_u32 v132, v132, 12, v11
    buffer_load_ushort v128, v12, s[28:31], 0 offen offset:0
    buffer_load_ushort v130, v12, s[28:31], 0 offen offset:16
    buffer_load_dwordx4 v[112:115], v132, s[20:23], s72 offen sc1
    buffer_load_dwordx4 v[116:119], v132, s[20:23], s73 offen sc1
    buffer_load_dwordx4 v[120:123], v132, s[20:23], s74 offen sc1
    buffer_load_dwordx4 v[124:127], v132, s[20:23], s75 offen sc1
    s_waitcnt vmcnt(14)
    s_barrier
    s_waitcnt vmcnt(6)
    s_barrier
    s_barrier
L_k5_com_125:
    s_waitcnt vmcnt(0)
    v_lshlrev_b32 v128, 16, v128
    v_lshlrev_b32 v130, 16, v130
    s_waitcnt lgkmcnt(0)
    s_barrier
    ds_read_b128 v[140:143], v134 offset:0
    ds_read_b128 v[144:147], v135 offset:0
    ds_read_b128 v[148:151], v134 offset:32768
    ds_read_b128 v[152:155], v135 offset:32768
    ds_read_b128 v[156:159], v134 offset:2048
    ds_read_b128 v[160:163], v135 offset:2048
    ds_read_b128 v[164:167], v134 offset:34816
    ds_read_b128 v[168:171], v135 offset:34816
    v_lshlrev_b32 v172, 16, v112
    v_and_b32 v173, 0xffff0000, v112
    v_lshlrev_b32 v174, 16, v113
    v_and_b32 v175, 0xffff0000, v113
    v_lshlrev_b32 v176, 16, v114
    v_and_b32 v177, 0xffff0000, v114
    v_lshlrev_b32 v178, 16, v115
    v_and_b32 v179, 0xffff0000, v115
    s_waitcnt lgkmcnt(6)
    v_pk_add_f32 v[140:141], v[140:141], v[128:129] op_sel_hi:[1,0]
    v_pk_add_f32 v[142:143], v[142:143], v[128:129] op_sel_hi:[1,0]
    v_pk_add_f32 v[144:145], v[144:145], v[128:129] op_sel_hi:[1,0]
    v_pk_add_f32 v[146:147], v[146:147], v[128:129] op_sel_hi:[1,0]
    v_pk_mul_f32 v[140:141], v[140:141], v[172:173]
    v_pk_mul_f32 v[142:143], v[142:143], v[174:175]
    v_pk_mul_f32 v[144:145], v[144:145], v[176:177]
    v_pk_mul_f32 v[146:147], v[146:147], v[178:179]
    v_cvt_pk_bf16_f32 v112, v140, v141
    v_cvt_pk_bf16_f32 v113, v142, v143
    v_cvt_pk_bf16_f32 v114, v144, v145
    v_cvt_pk_bf16_f32 v115, v146, v147
    buffer_store_dwordx4 v[112:115], v132, s[24:27], s72 offen sc1
    v_lshlrev_b32 v180, 16, v116
    v_and_b32 v181, 0xffff0000, v116
    v_lshlrev_b32 v182, 16, v117
    v_and_b32 v183, 0xffff0000, v117
    v_lshlrev_b32 v184, 16, v118
    v_and_b32 v185, 0xffff0000, v118
    v_lshlrev_b32 v186, 16, v119
    v_and_b32 v187, 0xffff0000, v119
    s_waitcnt lgkmcnt(4)
    v_pk_add_f32 v[148:149], v[148:149], v[128:129] op_sel_hi:[1,0]
    v_pk_add_f32 v[150:151], v[150:151], v[128:129] op_sel_hi:[1,0]
    v_pk_add_f32 v[152:153], v[152:153], v[128:129] op_sel_hi:[1,0]
    v_pk_add_f32 v[154:155], v[154:155], v[128:129] op_sel_hi:[1,0]
    v_pk_mul_f32 v[148:149], v[148:149], v[180:181]
    v_pk_mul_f32 v[150:151], v[150:151], v[182:183]
    v_pk_mul_f32 v[152:153], v[152:153], v[184:185]
    v_pk_mul_f32 v[154:155], v[154:155], v[186:187]
    v_cvt_pk_bf16_f32 v116, v148, v149
    v_cvt_pk_bf16_f32 v117, v150, v151
    v_cvt_pk_bf16_f32 v118, v152, v153
    v_cvt_pk_bf16_f32 v119, v154, v155
    buffer_store_dwordx4 v[116:119], v132, s[24:27], s73 offen sc1
    v_lshlrev_b32 v172, 16, v120
    v_and_b32 v173, 0xffff0000, v120
    v_lshlrev_b32 v174, 16, v121
    v_and_b32 v175, 0xffff0000, v121
    v_lshlrev_b32 v176, 16, v122
    v_and_b32 v177, 0xffff0000, v122
    v_lshlrev_b32 v178, 16, v123
    v_and_b32 v179, 0xffff0000, v123
    s_waitcnt lgkmcnt(2)
    v_pk_add_f32 v[156:157], v[156:157], v[130:131] op_sel_hi:[1,0]
    v_pk_add_f32 v[158:159], v[158:159], v[130:131] op_sel_hi:[1,0]
    v_pk_add_f32 v[160:161], v[160:161], v[130:131] op_sel_hi:[1,0]
    v_pk_add_f32 v[162:163], v[162:163], v[130:131] op_sel_hi:[1,0]
    v_pk_mul_f32 v[156:157], v[156:157], v[172:173]
    v_pk_mul_f32 v[158:159], v[158:159], v[174:175]
    v_pk_mul_f32 v[160:161], v[160:161], v[176:177]
    v_pk_mul_f32 v[162:163], v[162:163], v[178:179]
    v_cvt_pk_bf16_f32 v120, v156, v157
    v_cvt_pk_bf16_f32 v121, v158, v159
    v_cvt_pk_bf16_f32 v122, v160, v161
    v_cvt_pk_bf16_f32 v123, v162, v163
    buffer_store_dwordx4 v[120:123], v132, s[24:27], s74 offen sc1
    v_lshlrev_b32 v180, 16, v124
    v_and_b32 v181, 0xffff0000, v124
    v_lshlrev_b32 v182, 16, v125
    v_and_b32 v183, 0xffff0000, v125
    v_lshlrev_b32 v184, 16, v126
    v_and_b32 v185, 0xffff0000, v126
    v_lshlrev_b32 v186, 16, v127
    v_and_b32 v187, 0xffff0000, v127
    s_waitcnt lgkmcnt(0)
    v_pk_add_f32 v[164:165], v[164:165], v[130:131] op_sel_hi:[1,0]
    v_pk_add_f32 v[166:167], v[166:167], v[130:131] op_sel_hi:[1,0]
    v_pk_add_f32 v[168:169], v[168:169], v[130:131] op_sel_hi:[1,0]
    v_pk_add_f32 v[170:171], v[170:171], v[130:131] op_sel_hi:[1,0]
    v_pk_mul_f32 v[164:165], v[164:165], v[180:181]
    v_pk_mul_f32 v[166:167], v[166:167], v[182:183]
    v_pk_mul_f32 v[168:169], v[168:169], v[184:185]
    v_pk_mul_f32 v[170:171], v[170:171], v[186:187]
    v_cvt_pk_bf16_f32 v124, v164, v165
    v_cvt_pk_bf16_f32 v125, v166, v167
    v_cvt_pk_bf16_f32 v126, v168, v169
    v_cvt_pk_bf16_f32 v127, v170, v171
    buffer_store_dwordx4 v[124:127], v132, s[24:27], s75 offen sc1
.p2align 3
L_code_k6:
L_phase_k6:
    s_mov_b64 exec, -1
    s_lshr_b32 s6, s2, 3
    s_and_b32 s4, s6, 3
    s_and_b32 s7, s2, 3
    s_lshl_b32 s7, s7, 2
    s_add_u32 s4, s4, s7
    s_lshr_b32 s5, s6, 2
    s_bfe_u32 s7, s2, 0x10002
    s_lshl_b32 s7, s7, 3
    s_add_u32 s5, s5, s7
    s_mul_i32 s6, s4, 524288
    s_add_u32 s6, s6, 0x2800000
    s_add_u32 s8, s62, s6
    s_addc_u32 s9, s63, 0
    s_mov_b32 s10, 0x80000
    s_mov_b32 s11, 0x00020000
    s_mul_i32 s6, s5, 128
    s_sub_u32 s7, 0x380000, s6
    s_and_b32 s14, s5, 7
    s_cmp_eq_u32 s14, 3
    s_cselect_b64 s[12:13], s[62:63], s[52:53]
    s_cselect_b32 s14, 0x5c00080, 0
    s_add_u32 s6, s6, s14
    s_add_u32 s12, s12, s6
    s_addc_u32 s13, s13, 0
    s_mov_b32 s14, s7
    s_mov_b32 s15, 0x00020000
    s_lshl_b32 s6, s4, 18
    s_lshl_b32 s7, s5, 7
    s_add_u32 s6, s6, s7
    s_sub_u32 s7, 4194304, s6
    s_add_u32 s32, s6, 0x4800000
    s_add_u32 s16, s62, s32
    s_addc_u32 s17, s63, 0
    s_mov_b32 s18, s7
    s_mov_b32 s19, 0x00020000
    s_add_u32 s20, s58, s6
    s_addc_u32 s21, s59, 0
    s_mov_b32 s22, s7
    s_mov_b32 s23, 0x00020000
    s_lshl_b32 s6, s5, 8
    s_add_u32 s6, s6, 110592
    s_add_u32 s24, s62, s6
    s_addc_u32 s25, s63, 0
    s_mov_b32 s26, 0x2100
    s_mov_b32 s27, 0x00020000
    s_movk_i32 s96, 0x4000
    s_mov_b32 s97, 0x8000
    s_movk_i32 s98, 0x2000
    s_cmp_ge_u32 s3, 4
    s_cbranch_scc1 L_k6_ldr_143
    s_setprio 2
    v_and_b32 v1, 63, v0
    s_mul_i32 s34, s3, 32
    s_mov_b32 s35, 0
    v_and_b32 v10, 31, v1
    v_bfe_u32 v11, v1, 1, 3
    v_lshrrev_b32 v12, 5, v1
    v_xor_b32 v11, v11, v12
    v_add_u32 v10, s34, v10
    v_lshlrev_b32 v10, 7, v10
    v_lshl_add_u32 v2, v11, 4, v10
    v_xor_b32 v3, 32, v2
    v_xor_b32 v4, 64, v2
    v_xor_b32 v5, 96, v2
    v_bfe_u32 v10, v1, 2, 2
    v_lshl_add_u32 v10, v12, 3, v10
    v_bfe_u32 v11, v1, 4, 1
    v_lshlrev_b32 v11, 5, v11
    v_and_b32 v13, 1, v1
    v_lshl_add_u32 v11, v13, 4, v11
    v_bfe_u32 v13, v1, 1, 1
    v_lshl_add_u32 v11, v13, 3, v11
    v_bfe_u32 v13, v1, 3, 1
    v_lshl_add_u32 v11, v13, 6, v11
    v_lshl_add_u32 v6, v10, 7, v11
    v_xor_b32 v7, 64, v6
    v_and_b32 v10, 31, v1
    v_add_u32 v10, s34, v10
    v_lshrrev_b32 v136, 5, v1
    v_lshlrev_b32 v136, 1, v136
    v_and_b32 v137, 7, v1
    v_xor_b32 v136, v136, v137
    v_lshlrev_b32 v136, 4, v136
    v_lshl_add_u32 v136, v10, 8, v136
    v_xor_b32 v137, 16, v136
    v_xor_b32 v138, 64, v136
    v_xor_b32 v139, 80, v136
    v_lshrrev_b32 v240, 1, v1
    v_min_u32 v240, 13, v240
    s_lshl_b32 s6, s4, 7
    s_add_u32 s6, s6, 6144
    v_lshl_add_u32 v240, v240, 2, s6
    v_mov_b32 v40, 0
    v_mov_b32 v41, 0
    v_mov_b32 v42, 0
    v_mov_b32 v43, 0
    v_mov_b32 v44, 0
    v_mov_b32 v45, 0
    v_mov_b32 v46, 0
    v_mov_b32 v47, 0
    v_mov_b32 v48, 0
    v_mov_b32 v49, 0
    v_mov_b32 v50, 0
    v_mov_b32 v51, 0
    v_mov_b32 v52, 0
    v_mov_b32 v53, 0
    v_mov_b32 v54, 0
    v_mov_b32 v55, 0
    v_mov_b32 v56, 0
    v_mov_b32 v57, 0
    v_mov_b32 v58, 0
    v_mov_b32 v59, 0
    v_mov_b32 v60, 0
    v_mov_b32 v61, 0
    v_mov_b32 v62, 0
    v_mov_b32 v63, 0
    v_mov_b32 v64, 0
    v_mov_b32 v65, 0
    v_mov_b32 v66, 0
    v_mov_b32 v67, 0
    v_mov_b32 v68, 0
    v_mov_b32 v69, 0
    v_mov_b32 v70, 0
    v_mov_b32 v71, 0
    s_waitcnt vmcnt(0)
    s_barrier
    s_add_u32 s68, s62, 0xc0000
    s_addc_u32 s69, s63, 0
    s_mov_b32 s70, 0x6000
    s_mov_b32 s71, 0x00020000
    v_mov_b32 v10, 0
    s_cmp_eq_u32 s3, 0
    s_cselect_b64 exec, 1, 0
    buffer_store_dword v10, v10, s[68:71], s100 offen sc1
    s_mov_b64 exec, -1
    s_cmp_lg_u32 s3, 1
    s_cbranch_scc1 L_k6_np_145
    s_mov_b32 s66, 262144
L_k6_dl_146:
    buffer_load_dword v242, v240, s[68:71], 0 offen sc1
    s_waitcnt vmcnt(0)
    v_cmp_ne_u32 vcc, -1, v242
    s_and_b32 s67, vcc_lo, 0xfffffff
    s_sub_u32 s66, s66, 1
    s_cselect_b32 s67, 0xfffffff, s67
    s_bcnt1_i32_b32 s6, s67
    s_cmp_ge_u32 s6, 14
    s_cbranch_scc1 L_k6_dd_147
    s_sleep 1
    s_branch L_k6_dl_146
L_k6_dd_147:
    v_mov_b32 v240, s67
    v_mov_b32 v241, 163832
    ds_write_b32 v241, v240
    s_waitcnt lgkmcnt(0)
L_k6_np_145:
    s_barrier
    s_mov_b32 s64, 0
    s_mov_b32 s67, 24576
    s_mov_b32 s6, 28
    s_barrier
    ds_read_b64_tr_b16 v[20:21], v6 offset:16384
    ds_read_b64_tr_b16 v[22:23], v6 offset:16896
    ds_read_b128 v[16:19], v2 offset:0
    ds_read_b64_tr_b16 v[24:25], v7 offset:16384
    ds_read_b64_tr_b16 v[26:27], v7 offset:16896
    v_lshrrev_b32 v10, 3, v1
    s_lshl_b32 s32, s3, 4
    v_add_u32 v97, s32, v10
    v_and_b32 v98, 7, v1
    v_lshlrev_b32 v98, 1, v98
    v_xor_b32 v98, v98, v10
    v_lshlrev_b32 v98, 4, v98
    v_lshl_add_u32 v98, v97, 8, v98
    v_xor_b32 v99, 16, v98
    v_and_b32 v11, 7, v1
    v_lshlrev_b32 v12, 5, v11
    v_lshlrev_b32 v11, 4, v11
    v_lshl_add_u32 v96, v97, 11, v11
    v_lshl_add_u32 v97, v97, 12, v11
    buffer_load_dwordx4 v[72:75], v96, s[16:19], 0 offen sc1
    buffer_load_dwordx4 v[76:79], v96, s[16:19], s96 offen sc1
    v_add_u32 v102, 98304, v12
.p2align 4
L_k6_cl_148:
    s_add_u32 s64, s64, 24576
    s_cmp_eq_u32 s64, 98304
    s_cselect_b32 s65, 0xfffee000, s67
    s_cselect_b32 s64, 0, s64
    s_waitcnt lgkmcnt(0)
    v_mfma_f32_32x32x16_bf16 v[40:55], v[20:23], v[16:19], v[40:55]
    ds_read_b64_tr_b16 v[32:33], v6 offset:18432
    ds_read_b64_tr_b16 v[34:35], v6 offset:18944
    ds_read_b128 v[28:31], v3 offset:0
    ds_read_b64_tr_b16 v[36:37], v7 offset:18432
    ds_read_b64_tr_b16 v[38:39], v7 offset:18944
    v_add_u32 v3, s65, v3
    v_add_u32 v2, s65, v2
    v_mfma_f32_32x32x16_bf16 v[56:71], v[24:27], v[16:19], v[56:71]
    s_waitcnt lgkmcnt(0)
    v_mfma_f32_32x32x16_bf16 v[40:55], v[32:35], v[28:31], v[40:55]
    ds_read_b64_tr_b16 v[20:21], v6 offset:20480
    ds_read_b64_tr_b16 v[22:23], v6 offset:20992
    ds_read_b128 v[16:19], v4 offset:0
    ds_read_b64_tr_b16 v[24:25], v7 offset:20480
    ds_read_b64_tr_b16 v[26:27], v7 offset:20992
    v_add_u32 v4, s65, v4
    v_mfma_f32_32x32x16_bf16 v[56:71], v[36:39], v[28:31], v[56:71]
    s_waitcnt lgkmcnt(0)
    v_mfma_f32_32x32x16_bf16 v[40:55], v[20:23], v[16:19], v[40:55]
    ds_read_b64_tr_b16 v[32:33], v6 offset:22528
    ds_read_b64_tr_b16 v[34:35], v6 offset:23040
    ds_read_b128 v[28:31], v5 offset:0
    ds_read_b64_tr_b16 v[36:37], v7 offset:22528
    ds_read_b64_tr_b16 v[38:39], v7 offset:23040
    v_add_u32 v5, s65, v5
    v_add_u32 v6, s65, v6
    v_add_u32 v7, s65, v7
    v_mfma_f32_32x32x16_bf16 v[56:71], v[24:27], v[16:19], v[56:71]
    s_waitcnt lgkmcnt(0)
    v_mfma_f32_32x32x16_bf16 v[40:55], v[32:35], v[28:31], v[40:55]
    s_sub_u32 s6, s6, 1
    s_barrier
    ds_read_b64_tr_b16 v[20:21], v6 offset:16384
    ds_read_b64_tr_b16 v[22:23], v6 offset:16896
    ds_read_b128 v[16:19], v2 offset:0
    ds_read_b64_tr_b16 v[24:25], v7 offset:16384
    ds_read_b64_tr_b16 v[26:27], v7 offset:16896
    v_mfma_f32_32x32x16_bf16 v[56:71], v[36:39], v[28:31], v[56:71]
    s_cmp_lg_u32 s6, 0
    s_cbranch_scc1 L_k6_cl_148
    s_waitcnt lgkmcnt(0)
    s_nop 10
    ds_write_b128 v136, v[40:43] offset:0
    ds_write_b128 v137, v[44:47] offset:0
    ds_write_b128 v138, v[48:51] offset:0
    ds_write_b128 v139, v[52:55] offset:0
    ds_write_b128 v136, v[56:59] offset:128
    ds_write_b128 v137, v[60:63] offset:128
    ds_write_b128 v138, v[64:67] offset:128
    ds_write_b128 v139, v[68:71] offset:128
    s_setprio 0
    s_waitcnt vmcnt(0)
    s_branch L_k6_com_149
L_k6_ldr_143:
    s_sub_u32 s34, s3, 4
    v_and_b32 v1, 63, v0
    v_lshrrev_b32 v2, 3, v1
    v_and_b32 v3, 7, v1
    s_lshl_b32 s6, s34, 3
    v_add_u32 v2, s6, v2
    v_bfe_u32 v4, v2, 1, 3
    v_xor_b32 v4, v4, v3
    s_mov_b32 s6, 4096
    v_mul_lo_u32 v5, s6, v2
    v_lshl_add_u32 v16, v4, 4, v5
    v_add_u32 v17, 131072, v16
    v_add_u32 v18, 131072, v17
    v_add_u32 v19, 131072, v18
    v_bfe_u32 v4, v2, 1, 1
    v_lshlrev_b32 v4, 2, v4
    v_xor_b32 v4, v4, v3
    s_mov_b32 s6, 2048
    v_mul_lo_u32 v5, s6, v2
    v_lshl_add_u32 v5, v4, 4, v5
    v_add_u32 v20, 0, v5
    v_add_u32 v21, 65536, v20
    s_lshl_b32 s64, s34, 10
    s_add_u32 s65, s64, 98304
    s_mov_b32 s7, 0
    s_mov_b32 s33, 0
    s_setprio 0
    s_waitcnt vmcnt(0)
    s_barrier
    s_mov_b32 s6, 0
    s_add_u32 m0, s64, 16384
    s_nop 0
    buffer_load_dwordx4 v20, s[12:15], s6 offen lds
    s_add_u32 m0, s64, 20480
    s_nop 0
    buffer_load_dwordx4 v21, s[12:15], s6 offen lds
    s_mov_b32 s6, 131072
    s_add_u32 m0, s64, 40960
    s_nop 0
    buffer_load_dwordx4 v20, s[12:15], s6 offen lds
    s_add_u32 m0, s64, 45056
    s_nop 0
    buffer_load_dwordx4 v21, s[12:15], s6 offen lds
    s_mov_b32 s6, 262144
    s_add_u32 m0, s64, 65536
    s_nop 0
    buffer_load_dwordx4 v20, s[12:15], s6 offen lds
    s_add_u32 m0, s64, 69632
    s_nop 0
    buffer_load_dwordx4 v21, s[12:15], s6 offen lds
    v_lshrrev_b32 v30, 1, v1
    v_min_u32 v30, 13, v30
    s_lshl_b32 s6, s4, 7
    s_add_u32 s6, s6, 6144
    v_lshl_add_u32 v30, v30, 2, s6
    v_mov_b32 v32, -1
    v_mov_b32 v33, -1
    v_mov_b32 v34, -1
    v_mov_b32 v35, -1
    v_mov_b32 v36, 163832
    s_barrier
    ds_read_b32 v36, v36
    s_waitcnt lgkmcnt(0)
    v_readfirstlane_b32 s99, v36
    s_andn2_b32 s101, 0xfffffff, s99
    s_and_b32 s6, s101, 7
    s_cbranch_scc1 L_k6_slow_152
    s_mov_b32 s6, 0
    s_add_u32 m0, s64, 0
    s_nop 0
    buffer_load_dwordx4 v16, s[8:11], s6 offen sc1 lds
    s_add_u32 m0, s64, 4096
    s_nop 0
    buffer_load_dwordx4 v17, s[8:11], s6 offen sc1 lds
    s_add_u32 m0, s64, 8192
    s_nop 0
    buffer_load_dwordx4 v18, s[8:11], s6 offen sc1 lds
    s_add_u32 m0, s64, 12288
    s_nop 0
    buffer_load_dwordx4 v19, s[8:11], s6 offen sc1 lds
    s_mov_b32 s6, 128
    s_add_u32 m0, s64, 24576
    s_nop 0
    buffer_load_dwordx4 v16, s[8:11], s6 offen sc1 lds
    s_add_u32 m0, s64, 28672
    s_nop 0
    buffer_load_dwordx4 v17, s[8:11], s6 offen sc1 lds
    s_add_u32 m0, s64, 32768
    s_nop 0
    buffer_load_dwordx4 v18, s[8:11], s6 offen sc1 lds
    s_add_u32 m0, s64, 36864
    s_nop 0
    buffer_load_dwordx4 v19, s[8:11], s6 offen sc1 lds
    s_mov_b32 s6, 256
    s_add_u32 m0, s64, 49152
    s_nop 0
    buffer_load_dwordx4 v16, s[8:11], s6 offen sc1 lds
    s_add_u32 m0, s64, 53248
    s_nop 0
    buffer_load_dwordx4 v17, s[8:11], s6 offen sc1 lds
    s_add_u32 m0, s64, 57344
    s_nop 0
    buffer_load_dwordx4 v18, s[8:11], s6 offen sc1 lds
    s_add_u32 m0, s64, 61440
    s_nop 0
    buffer_load_dwordx4 v19, s[8:11], s6 offen sc1 lds
    s_andn2_b32 s99, s99, 7
L_k6_pdone_151:
    s_ff1_i32_b32 s6, s99
    s_bitset0_b32 s99, s6
    s_mul_i32 s33, s6, 131072
    s_add_u32 s7, s6, 4
    s_mul_i32 s7, s7, 37
    s_lshr_b32 s7, s7, 8
    s_add_u32 s7, s6, s7
    s_lshl_b32 s7, s7, 7
    s_add_u32 s64, s64, 73728
    v_and_b32 v2, 255, v0
    v_lshlrev_b32 v2, 7, v2
    s_getpc_b64 s[68:69]
L_pc_153:
    s_sub_u32 s68, s68, L_pc_153-L_code_k6
    s_subb_u32 s69, s69, 0
    s_mov_b32 s70, L_code_end-L_code_k6
    s_mov_b32 s71, 0x00020000
    buffer_load_dword v3, v2, s[68:71], 0 offen
    s_add_u32 s68, s62, 0xc0000
    s_addc_u32 s69, s63, 0
    s_mov_b32 s70, 0x6000
    s_mov_b32 s71, 0x00020000
    s_waitcnt vmcnt(9)
    s_barrier
    s_add_u32 m0, s64, 0
    s_nop 0
    buffer_load_dwordx4 v16, s[8:11], s7 offen sc1 lds
    s_add_u32 m0, s64, 4096
    s_nop 0
    buffer_load_dwordx4 v17, s[8:11], s7 offen sc1 lds
    s_add_u32 m0, s64, 8192
    s_nop 0
    buffer_load_dwordx4 v18, s[8:11], s7 offen sc1 lds
    s_add_u32 m0, s64, 12288
    s_nop 0
    buffer_load_dwordx4 v19, s[8:11], s7 offen sc1 lds
    s_add_u32 m0, s64, 16384
    s_nop 0
    buffer_load_dwordx4 v20, s[12:15], s33 offen lds
    s_add_u32 m0, s64, 20480
    s_nop 0
    buffer_load_dwordx4 v21, s[12:15], s33 offen lds
    s_cmp_eq_u32 s99, 0
    s_cbranch_scc1 L_k6_lt_154
L_k6_ltb_155:
    s_ff1_i32_b32 s6, s99
    s_bitset0_b32 s99, s6
    s_mul_i32 s33, s6, 131072
    s_add_u32 s7, s6, 4
    s_mul_i32 s7, s7, 37
    s_lshr_b32 s7, s7, 8
    s_add_u32 s7, s6, s7
    s_lshl_b32 s7, s7, 7
    s_bcnt1_i32_b32 s6, s99
    s_cmp_eq_u32 s6, 2
    s_cbranch_scc1 L_k6_pp_156
L_k6_ppb_157:
    s_add_u32 s64, s64, 24576
    s_cmp_eq_u32 s64, s65
    s_cselect_b32 s6, 98304, 0
    s_sub_u32 s64, s64, s6
    s_waitcnt vmcnt(11)
    s_barrier
    s_add_u32 m0, s64, 0
    s_nop 0
    buffer_load_dwordx4 v16, s[8:11], s7 offen sc1 lds
    s_add_u32 m0, s64, 4096
    s_nop 0
    buffer_load_dwordx4 v17, s[8:11], s7 offen sc1 lds
    s_add_u32 m0, s64, 8192
    s_nop 0
    buffer_load_dwordx4 v18, s[8:11], s7 offen sc1 lds
    s_add_u32 m0, s64, 12288
    s_nop 0
    buffer_load_dwordx4 v19, s[8:11], s7 offen sc1 lds
    s_add_u32 m0, s64, 16384
    s_nop 0
    buffer_load_dwordx4 v20, s[12:15], s33 offen lds
    s_add_u32 m0, s64, 20480
    s_nop 0
    buffer_load_dwordx4 v21, s[12:15], s33 offen lds
    s_cmp_eq_u32 s99, 0
    s_cbranch_scc1 L_k6_lt_158
L_k6_ltb_159:
    s_ff1_i32_b32 s6, s99
    s_bitset0_b32 s99, s6
    s_mul_i32 s33, s6, 131072
    s_add_u32 s7, s6, 4
    s_mul_i32 s7, s7, 37
    s_lshr_b32 s7, s7, 8
    s_add_u32 s7, s6, s7
    s_lshl_b32 s7, s7, 7
    s_bcnt1_i32_b32 s6, s99
    s_cmp_eq_u32 s6, 2
    s_cbranch_scc1 L_k6_pp_160
L_k6_ppb_161:
    s_add_u32 s64, s64, 24576
    s_cmp_eq_u32 s64, s65
    s_cselect_b32 s6, 98304, 0
    s_sub_u32 s64, s64, s6
    s_mov_b32 s66, 23
.p2align 4
L_k6_ll_162:
    s_waitcnt vmcnt(12)
    s_barrier
    s_add_u32 m0, s64, 0
    s_nop 0
    buffer_load_dwordx4 v16, s[8:11], s7 offen sc1 lds
    s_add_u32 m0, s64, 4096
    s_nop 0
    buffer_load_dwordx4 v17, s[8:11], s7 offen sc1 lds
    s_add_u32 m0, s64, 8192
    s_nop 0
    buffer_load_dwordx4 v18, s[8:11], s7 offen sc1 lds
    s_add_u32 m0, s64, 12288
    s_nop 0
    buffer_load_dwordx4 v19, s[8:11], s7 offen sc1 lds
    s_add_u32 m0, s64, 16384
    s_nop 0
    buffer_load_dwordx4 v20, s[12:15], s33 offen lds
    s_add_u32 m0, s64, 20480
    s_nop 0
    buffer_load_dwordx4 v21, s[12:15], s33 offen lds
    s_cmp_eq_u32 s99, 0
    s_cbranch_scc1 L_k6_lt_163
L_k6_ltb_164:
    s_ff1_i32_b32 s6, s99
    s_bitset0_b32 s99, s6
    s_mul_i32 s33, s6, 131072
    s_add_u32 s7, s6, 4
    s_mul_i32 s7, s7, 37
    s_lshr_b32 s7, s7, 8
    s_add_u32 s7, s6, s7
    s_lshl_b32 s7, s7, 7
    s_bcnt1_i32_b32 s6, s99
    s_cmp_eq_u32 s6, 2
    s_cbranch_scc1 L_k6_pp_165
L_k6_ppb_166:
    s_add_u32 s64, s64, 24576
    s_cmp_eq_u32 s64, s65
    s_cselect_b32 s6, 98304, 0
    s_sub_u32 s64, s64, s6
    s_sub_u32 s66, s66, 1
    s_cmp_lg_u32 s66, 0
    s_cbranch_scc1 L_k6_ll_162
    s_waitcnt vmcnt(12)
    s_barrier
    v_lshlrev_b32 v9, 2, v1
    buffer_load_dword v40, v9, s[24:27], 0 offen sc1
    v_lshrrev_b32 v10, 3, v1
    s_lshl_b32 s32, s3, 4
    v_add_u32 v97, s32, v10
    v_and_b32 v98, 7, v1
    v_lshlrev_b32 v98, 1, v98
    v_xor_b32 v98, v98, v10
    v_lshlrev_b32 v98, 4, v98
    v_lshl_add_u32 v98, v97, 8, v98
    v_xor_b32 v99, 16, v98
    v_and_b32 v11, 7, v1
    v_lshlrev_b32 v12, 5, v11
    v_lshlrev_b32 v11, 4, v11
    v_lshl_add_u32 v96, v97, 11, v11
    v_lshl_add_u32 v97, v97, 12, v11
    buffer_load_dwordx4 v[72:75], v96, s[16:19], 0 offen sc1
    buffer_load_dwordx4 v[76:79], v96, s[16:19], s96 offen sc1
    v_add_u32 v102, 98304, v12
    s_waitcnt vmcnt(9)
    s_barrier
    s_waitcnt vmcnt(3)
    s_barrier
    s_barrier
    v_add_u32 v9, 98304, v9
    s_waitcnt vmcnt(2)
    v_cvt_pk_bf16_f32 v40, v40, v40
    v_lshlrev_b32 v40, 16, v40
    ds_write_b32 v9, v40
    s_waitcnt vmcnt(0)
    s_load_dword s6, s[62:63], 0xc8000
    s_add_u32 s68, s62, 0xc8000
    s_addc_u32 s69, s63, 0
    s_mov_b32 s70, 0x4
    s_mov_b32 s71, 0x00020000
    s_lshl_b32 s7, s2, 3
    s_add_u32 s7, s7, s3
    v_mov_b32 v41, 0
    s_waitcnt lgkmcnt(0)
    s_add_u32 s6, s6, 1
    v_mov_b32 v40, s6
    s_cmp_eq_u32 s7, 4
    s_cselect_b64 exec, 1, 0
    buffer_store_dword v40, v41, s[68:71], 0 offen sc1
    s_mov_b64 exec, -1
L_k6_com_149:
    s_waitcnt lgkmcnt(0)
    s_barrier
    ds_read_b128 v[80:83], v102 offset:0
    ds_read_b128 v[84:87], v102 offset:16
    ds_read_b128 v[104:107], v98 offset:0
    ds_read_b128 v[108:111], v99 offset:0
    ds_read_b128 v[112:115], v98 offset:2048
    ds_read_b128 v[116:119], v99 offset:2048
    v_lshlrev_b32 v120, 16, v72
    v_and_b32 v121, 0xffff0000, v72
    v_lshlrev_b32 v122, 16, v73
    v_and_b32 v123, 0xffff0000, v73
    v_lshlrev_b32 v124, 16, v74
    v_and_b32 v125, 0xffff0000, v74
    v_lshlrev_b32 v126, 16, v75
    v_and_b32 v127, 0xffff0000, v75
    v_lshlrev_b32 v128, 16, v76
    v_and_b32 v129, 0xffff0000, v76
    v_lshlrev_b32 v130, 16, v77
    v_and_b32 v131, 0xffff0000, v77
    v_lshlrev_b32 v132, 16, v78
    v_and_b32 v133, 0xffff0000, v78
    v_lshlrev_b32 v134, 16, v79
    v_and_b32 v135, 0xffff0000, v79
    s_waitcnt lgkmcnt(2)
    v_pk_fma_f32 v[104:105], v[104:105], v[80:81], v[120:121]
    v_pk_fma_f32 v[106:107], v[106:107], v[82:83], v[122:123]
    v_pk_fma_f32 v[108:109], v[108:109], v[84:85], v[124:125]
    v_pk_fma_f32 v[110:111], v[110:111], v[86:87], v[126:127]
    v_cvt_pk_bf16_f32 v72, v104, v105
    v_cvt_pk_bf16_f32 v73, v106, v107
    v_cvt_pk_bf16_f32 v74, v108, v109
    v_cvt_pk_bf16_f32 v75, v110, v111
    buffer_store_dwordx4 v[72:75], v96, s[20:23], 0 offen nt
    s_waitcnt lgkmcnt(0)
    v_pk_fma_f32 v[112:113], v[112:113], v[80:81], v[128:129]
    v_pk_fma_f32 v[114:115], v[114:115], v[82:83], v[130:131]
    v_pk_fma_f32 v[116:117], v[116:117], v[84:85], v[132:133]
    v_pk_fma_f32 v[118:119], v[118:119], v[86:87], v[134:135]
    v_cvt_pk_bf16_f32 v76, v112, v113
    v_cvt_pk_bf16_f32 v77, v114, v115
    v_cvt_pk_bf16_f32 v78, v116, v117
    v_cvt_pk_bf16_f32 v79, v118, v119
    buffer_store_dwordx4 v[76:79], v96, s[20:23], s96 offen nt
    s_mov_b64 exec, -1
L_k1_end_1:
    s_endpgm
L_k2_slow_28:
    s_ff1_i32_b32 s6, s99
    s_bitset0_b32 s99, s6
    s_mul_i32 s33, s6, 393216
    s_add_u32 s7, s6, 4
    s_mul_i32 s7, s7, 37
    s_lshr_b32 s7, s7, 8
    s_add_u32 s7, s6, s7
    s_lshl_b32 s7, s7, 7
    s_ff1_i32_b32 s6, s99
    s_bitset0_b32 s99, s6
    s_mul_i32 s66, s6, 393216
    s_add_u32 s32, s6, 4
    s_mul_i32 s32, s32, 37
    s_lshr_b32 s32, s32, 8
    s_add_u32 s32, s6, s32
    s_lshl_b32 s32, s32, 7
    s_ff1_i32_b32 s6, s99
    s_bitset0_b32 s99, s6
    s_mul_i32 s67, s6, 393216
    s_add_u32 s35, s6, 4
    s_mul_i32 s35, s35, 37
    s_lshr_b32 s35, s35, 8
    s_add_u32 s35, s6, s35
    s_lshl_b32 s35, s35, 7
    s_add_u32 m0, s64, 16384
    s_nop 0
    buffer_load_dwordx4 v20, s[12:15], s33 offen lds
    s_add_u32 m0, s64, 20480
    s_nop 0
    buffer_load_dwordx4 v21, s[12:15], s33 offen lds
    s_add_u32 m0, s64, 24576
    s_nop 0
    buffer_load_dwordx4 v22, s[12:15], s33 offen lds
    s_add_u32 m0, s64, 28672
    s_nop 0
    buffer_load_dwordx4 v23, s[12:15], s33 offen lds
    s_add_u32 m0, s64, 32768
    s_nop 0
    buffer_load_dwordx4 v24, s[12:15], s33 offen lds
    s_add_u32 m0, s64, 36864
    s_nop 0
    buffer_load_dwordx4 v25, s[12:15], s33 offen lds
    s_add_u32 m0, s64, 57344
    s_nop 0
    buffer_load_dwordx4 v20, s[12:15], s66 offen lds
    s_add_u32 m0, s64, 61440
    s_nop 0
    buffer_load_dwordx4 v21, s[12:15], s66 offen lds
    s_add_u32 m0, s64, 65536
    s_nop 0
    buffer_load_dwordx4 v22, s[12:15], s66 offen lds
    s_add_u32 m0, s64, 69632
    s_nop 0
    buffer_load_dwordx4 v23, s[12:15], s66 offen lds
    s_add_u32 m0, s64, 73728
    s_nop 0
    buffer_load_dwordx4 v24, s[12:15], s66 offen lds
    s_add_u32 m0, s64, 77824
    s_nop 0
    buffer_load_dwordx4 v25, s[12:15], s66 offen lds
    s_add_u32 m0, s64, 98304
    s_nop 0
    buffer_load_dwordx4 v20, s[12:15], s67 offen lds
    s_add_u32 m0, s64, 102400
    s_nop 0
    buffer_load_dwordx4 v21, s[12:15], s67 offen lds
    s_add_u32 m0, s64, 106496
    s_nop 0
    buffer_load_dwordx4 v22, s[12:15], s67 offen lds
    s_add_u32 m0, s64, 110592
    s_nop 0
    buffer_load_dwordx4 v23, s[12:15], s67 offen lds
    s_add_u32 m0, s64, 114688
    s_nop 0
    buffer_load_dwordx4 v24, s[12:15], s67 offen lds
    s_add_u32 m0, s64, 118784
    s_nop 0
    buffer_load_dwordx4 v25, s[12:15], s67 offen lds
    s_add_u32 m0, s64, 0
    s_nop 0
    buffer_load_dwordx4 v16, s[8:11], s7 offen sc1 lds
    s_add_u32 m0, s64, 4096
    s_nop 0
    buffer_load_dwordx4 v17, s[8:11], s7 offen sc1 lds
    s_add_u32 m0, s64, 8192
    s_nop 0
    buffer_load_dwordx4 v18, s[8:11], s7 offen sc1 lds
    s_add_u32 m0, s64, 12288
    s_nop 0
    buffer_load_dwordx4 v19, s[8:11], s7 offen sc1 lds
    s_add_u32 m0, s64, 40960
    s_nop 0
    buffer_load_dwordx4 v16, s[8:11], s32 offen sc1 lds
    s_add_u32 m0, s64, 45056
    s_nop 0
    buffer_load_dwordx4 v17, s[8:11], s32 offen sc1 lds
    s_add_u32 m0, s64, 49152
    s_nop 0
    buffer_load_dwordx4 v18, s[8:11], s32 offen sc1 lds
    s_add_u32 m0, s64, 53248
    s_nop 0
    buffer_load_dwordx4 v19, s[8:11], s32 offen sc1 lds
    s_add_u32 m0, s64, 81920
    s_nop 0
    buffer_load_dwordx4 v16, s[8:11], s35 offen sc1 lds
    s_add_u32 m0, s64, 86016
    s_nop 0
    buffer_load_dwordx4 v17, s[8:11], s35 offen sc1 lds
    s_add_u32 m0, s64, 90112
    s_nop 0
    buffer_load_dwordx4 v18, s[8:11], s35 offen sc1 lds
    s_add_u32 m0, s64, 94208
    s_nop 0
    buffer_load_dwordx4 v19, s[8:11], s35 offen sc1 lds
    s_branch L_k2_pdone_27
L_k2_lt_30:
    s_mov_b32 s99, s101
    s_mov_b32 s101, 0
    s_cmp_eq_u32 s99, 0
    s_cbranch_scc1 L_k2_ltb_31
    s_waitcnt vmcnt(30)
    s_mov_b32 s35, 262144
L_k2_ls_167:
    v_cmp_eq_u32 vcc, v253, v32
    s_and_b32 s6, vcc_lo, 0xffff
    s_cmp_eq_u32 s6, 0xffff
    s_cbranch_scc1 L_k2_ltb_31
    s_sub_u32 s35, s35, 1
    s_cbranch_scc1 L_k2_ltb_31
    s_sleep 2
    buffer_load_dword v32, v30, s[68:71], 0 offen sc1
    s_waitcnt vmcnt(0)
    s_branch L_k2_ls_167
    s_branch L_k2_ltb_31
L_k2_pp_32:
    s_cmp_eq_u32 s101, 0
    s_cbranch_scc1 L_k2_ppb_33
    buffer_load_dword v32, v30, s[68:71], 0 offen sc1
    s_branch L_k2_ppb_33
L_k2_lt_34:
    s_mov_b32 s99, s101
    s_mov_b32 s101, 0
    s_cmp_eq_u32 s99, 0
    s_cbranch_scc1 L_k2_ltb_35
    s_waitcnt vmcnt(30)
    s_mov_b32 s35, 262144
L_k2_ls_168:
    v_cmp_eq_u32 vcc, v253, v32
    s_and_b32 s6, vcc_lo, 0xffff
    s_cmp_eq_u32 s6, 0xffff
    s_cbranch_scc1 L_k2_ltb_35
    s_sub_u32 s35, s35, 1
    s_cbranch_scc1 L_k2_ltb_35
    s_sleep 2
    buffer_load_dword v32, v30, s[68:71], 0 offen sc1
    s_waitcnt vmcnt(0)
    s_branch L_k2_ls_168
    s_branch L_k2_ltb_35
L_k2_pp_36:
    s_cmp_eq_u32 s101, 0
    s_cbranch_scc1 L_k2_ppb_37
    buffer_load_dword v32, v30, s[68:71], 0 offen sc1
    s_branch L_k2_ppb_37
L_k2_lt_39:
    s_mov_b32 s99, s101
    s_mov_b32 s101, 0
    s_cmp_eq_u32 s99, 0
    s_cbranch_scc1 L_k2_ltb_40
    s_waitcnt vmcnt(30)
    s_mov_b32 s35, 262144
L_k2_ls_169:
    v_cmp_eq_u32 vcc, v253, v32
    s_and_b32 s6, vcc_lo, 0xffff
    s_cmp_eq_u32 s6, 0xffff
    s_cbranch_scc1 L_k2_ltb_40
    s_sub_u32 s35, s35, 1
    s_cbranch_scc1 L_k2_ltb_40
    s_sleep 2
    buffer_load_dword v32, v30, s[68:71], 0 offen sc1
    s_waitcnt vmcnt(0)
    s_branch L_k2_ls_169
    s_branch L_k2_ltb_40
L_k2_pp_41:
    s_cmp_eq_u32 s101, 0
    s_cbranch_scc1 L_k2_ppb_42
    buffer_load_dword v32, v30, s[68:71], 0 offen sc1
    s_branch L_k2_ppb_42
L_k3_slow_64:
    s_ff1_i32_b32 s6, s99
    s_bitset0_b32 s99, s6
    s_mul_i32 s33, s6, 131072
    s_add_u32 s7, s6, 4
    s_mul_i32 s7, s7, 37
    s_lshr_b32 s7, s7, 8
    s_add_u32 s7, s6, s7
    s_lshl_b32 s7, s7, 7
    s_ff1_i32_b32 s6, s99
    s_bitset0_b32 s99, s6
    s_mul_i32 s66, s6, 131072
    s_add_u32 s32, s6, 4
    s_mul_i32 s32, s32, 37
    s_lshr_b32 s32, s32, 8
    s_add_u32 s32, s6, s32
    s_lshl_b32 s32, s32, 7
    s_ff1_i32_b32 s6, s99
    s_bitset0_b32 s99, s6
    s_mul_i32 s67, s6, 131072
    s_add_u32 s35, s6, 4
    s_mul_i32 s35, s35, 37
    s_lshr_b32 s35, s35, 8
    s_add_u32 s35, s6, s35
    s_lshl_b32 s35, s35, 7
    s_add_u32 m0, s64, 16384
    s_nop 0
    buffer_load_dwordx4 v20, s[12:15], s33 offen lds
    s_add_u32 m0, s64, 20480
    s_nop 0
    buffer_load_dwordx4 v21, s[12:15], s33 offen lds
    s_add_u32 m0, s64, 40960
    s_nop 0
    buffer_load_dwordx4 v20, s[12:15], s66 offen lds
    s_add_u32 m0, s64, 45056
    s_nop 0
    buffer_load_dwordx4 v21, s[12:15], s66 offen lds
    s_add_u32 m0, s64, 65536
    s_nop 0
    buffer_load_dwordx4 v20, s[12:15], s67 offen lds
    s_add_u32 m0, s64, 69632
    s_nop 0
    buffer_load_dwordx4 v21, s[12:15], s67 offen lds
    s_add_u32 m0, s64, 0
    s_nop 0
    buffer_load_dwordx4 v16, s[8:11], s7 offen sc1 lds
    s_add_u32 m0, s64, 4096
    s_nop 0
    buffer_load_dwordx4 v17, s[8:11], s7 offen sc1 lds
    s_add_u32 m0, s64, 8192
    s_nop 0
    buffer_load_dwordx4 v18, s[8:11], s7 offen sc1 lds
    s_add_u32 m0, s64, 12288
    s_nop 0
    buffer_load_dwordx4 v19, s[8:11], s7 offen sc1 lds
    s_add_u32 m0, s64, 24576
    s_nop 0
    buffer_load_dwordx4 v16, s[8:11], s32 offen sc1 lds
    s_add_u32 m0, s64, 28672
    s_nop 0
    buffer_load_dwordx4 v17, s[8:11], s32 offen sc1 lds
    s_add_u32 m0, s64, 32768
    s_nop 0
    buffer_load_dwordx4 v18, s[8:11], s32 offen sc1 lds
    s_add_u32 m0, s64, 36864
    s_nop 0
    buffer_load_dwordx4 v19, s[8:11], s32 offen sc1 lds
    s_add_u32 m0, s64, 49152
    s_nop 0
    buffer_load_dwordx4 v16, s[8:11], s35 offen sc1 lds
    s_add_u32 m0, s64, 53248
    s_nop 0
    buffer_load_dwordx4 v17, s[8:11], s35 offen sc1 lds
    s_add_u32 m0, s64, 57344
    s_nop 0
    buffer_load_dwordx4 v18, s[8:11], s35 offen sc1 lds
    s_add_u32 m0, s64, 61440
    s_nop 0
    buffer_load_dwordx4 v19, s[8:11], s35 offen sc1 lds
    s_branch L_k3_pdone_63
L_k3_lt_66:
    s_mov_b32 s99, s101
    s_mov_b32 s101, 0
    s_cmp_eq_u32 s99, 0
    s_cbranch_scc1 L_k3_ltb_67
    s_waitcnt vmcnt(18)
    s_mov_b32 s35, 262144
L_k3_ls_170:
    v_cmp_ne_u32 vcc, -1, v32
    s_and_b32 s6, vcc_lo, 0xffff
    s_cmp_eq_u32 s6, 0xffff
    s_cbranch_scc1 L_k3_ltb_67
    s_sub_u32 s35, s35, 1
    s_cbranch_scc1 L_k3_ltb_67
    s_sleep 2
    buffer_load_dword v32, v30, s[68:71], 0 offen sc1
    s_waitcnt vmcnt(0)
    s_branch L_k3_ls_170
    s_branch L_k3_ltb_67
L_k3_pp_68:
    s_cmp_eq_u32 s101, 0
    s_cbranch_scc1 L_k3_ppb_69
    buffer_load_dword v32, v30, s[68:71], 0 offen sc1
    s_branch L_k3_ppb_69
L_k3_lt_70:
    s_mov_b32 s99, s101
    s_mov_b32 s101, 0
    s_cmp_eq_u32 s99, 0
    s_cbranch_scc1 L_k3_ltb_71
    s_waitcnt vmcnt(18)
    s_mov_b32 s35, 262144
L_k3_ls_171:
    v_cmp_ne_u32 vcc, -1, v32
    s_and_b32 s6, vcc_lo, 0xffff
    s_cmp_eq_u32 s6, 0xffff
    s_cbranch_scc1 L_k3_ltb_71
    s_sub_u32 s35, s35, 1
    s_cbranch_scc1 L_k3_ltb_71
    s_sleep 2
    buffer_load_dword v32, v30, s[68:71], 0 offen sc1
    s_waitcnt vmcnt(0)
    s_branch L_k3_ls_171
    s_branch L_k3_ltb_71
L_k3_pp_72:
    s_cmp_eq_u32 s101, 0
    s_cbranch_scc1 L_k3_ppb_73
    buffer_load_dword v32, v30, s[68:71], 0 offen sc1
    s_branch L_k3_ppb_73
L_k3_lt_75:
    s_mov_b32 s99, s101
    s_mov_b32 s101, 0
    s_cmp_eq_u32 s99, 0
    s_cbranch_scc1 L_k3_ltb_76
    s_waitcnt vmcnt(18)
    s_mov_b32 s35, 262144
L_k3_ls_172:
    v_cmp_ne_u32 vcc, -1, v32
    s_and_b32 s6, vcc_lo, 0xffff
    s_cmp_eq_u32 s6, 0xffff
    s_cbranch_scc1 L_k3_ltb_76
    s_sub_u32 s35, s35, 1
    s_cbranch_scc1 L_k3_ltb_76
    s_sleep 2
    buffer_load_dword v32, v30, s[68:71], 0 offen sc1
    s_waitcnt vmcnt(0)
    s_branch L_k3_ls_172
    s_branch L_k3_ltb_76
L_k3_pp_77:
    s_cmp_eq_u32 s101, 0
    s_cbranch_scc1 L_k3_ppb_78
    buffer_load_dword v32, v30, s[68:71], 0 offen sc1
    s_branch L_k3_ppb_78
L_k3_t_79:
    buffer_load_dwordx4 v[44:47], v38, s[68:71], 0 offen offset:0 sc1
    s_branch L_k3_tb_80
L_k4_slow_94:
    s_ff1_i32_b32 s6, s99
    s_bitset0_b32 s99, s6
    s_mul_i32 s33, s6, 458752
    s_add_u32 s7, s6, 4
    s_mul_i32 s7, s7, 37
    s_lshr_b32 s7, s7, 8
    s_add_u32 s7, s6, s7
    s_lshl_b32 s7, s7, 7
    s_ff1_i32_b32 s6, s99
    s_bitset0_b32 s99, s6
    s_mul_i32 s66, s6, 458752
    s_add_u32 s32, s6, 4
    s_mul_i32 s32, s32, 37
    s_lshr_b32 s32, s32, 8
    s_add_u32 s32, s6, s32
    s_lshl_b32 s32, s32, 7
    s_add_u32 m0, s64, 16384
    s_nop 0
    buffer_load_dwordx4 v20, s[12:15], s33 offen lds
    s_add_u32 m0, s64, 20480
    s_nop 0
    buffer_load_dwordx4 v21, s[12:15], s33 offen lds
    s_add_u32 m0, s64, 24576
    s_nop 0
    buffer_load_dwordx4 v22, s[12:15], s33 offen lds
    s_add_u32 m0, s64, 28672
    s_nop 0
    buffer_load_dwordx4 v23, s[12:15], s33 offen lds
    s_add_u32 m0, s64, 32768
    s_nop 0
    buffer_load_dwordx4 v24, s[12:15], s33 offen lds
    s_add_u32 m0, s64, 36864
    s_nop 0
    buffer_load_dwordx4 v25, s[12:15], s33 offen lds
    s_add_u32 m0, s64, 40960
    s_nop 0
    buffer_load_dwordx4 v26, s[12:15], s33 offen lds
    s_add_u32 m0, s64, 61440
    s_nop 0
    buffer_load_dwordx4 v20, s[12:15], s66 offen lds
    s_add_u32 m0, s64, 65536
    s_nop 0
    buffer_load_dwordx4 v21, s[12:15], s66 offen lds
    s_add_u32 m0, s64, 69632
    s_nop 0
    buffer_load_dwordx4 v22, s[12:15], s66 offen lds
    s_add_u32 m0, s64, 73728
    s_nop 0
    buffer_load_dwordx4 v23, s[12:15], s66 offen lds
    s_add_u32 m0, s64, 77824
    s_nop 0
    buffer_load_dwordx4 v24, s[12:15], s66 offen lds
    s_add_u32 m0, s64, 81920
    s_nop 0
    buffer_load_dwordx4 v25, s[12:15], s66 offen lds
    s_add_u32 m0, s64, 86016
    s_nop 0
    buffer_load_dwordx4 v26, s[12:15], s66 offen lds
    s_add_u32 m0, s64, 0
    s_nop 0
    buffer_load_dwordx4 v16, s[8:11], s7 offen sc1 lds
    s_add_u32 m0, s64, 4096
    s_nop 0
    buffer_load_dwordx4 v17, s[8:11], s7 offen sc1 lds
    s_add_u32 m0, s64, 8192
    s_nop 0
    buffer_load_dwordx4 v18, s[8:11], s7 offen sc1 lds
    s_add_u32 m0, s64, 12288
    s_nop 0
    buffer_load_dwordx4 v19, s[8:11], s7 offen sc1 lds
    s_add_u32 m0, s64, 45056
    s_nop 0
    buffer_load_dwordx4 v16, s[8:11], s32 offen sc1 lds
    s_add_u32 m0, s64, 49152
    s_nop 0
    buffer_load_dwordx4 v17, s[8:11], s32 offen sc1 lds
    s_add_u32 m0, s64, 53248
    s_nop 0
    buffer_load_dwordx4 v18, s[8:11], s32 offen sc1 lds
    s_add_u32 m0, s64, 57344
    s_nop 0
    buffer_load_dwordx4 v19, s[8:11], s32 offen sc1 lds
    s_branch L_k4_pdone_93
L_k4_lt_96:
    s_mov_b32 s99, s101
    s_mov_b32 s101, 0
    s_cmp_eq_u32 s99, 0
    s_cbranch_scc1 L_k4_ltb_97
    s_waitcnt vmcnt(22)
    s_mov_b32 s35, 262144
L_k4_ls_173:
    v_cmp_ne_u32 vcc, -1, v32
    s_and_b32 s6, vcc_lo, 0xffff
    s_cmp_eq_u32 s6, 0xffff
    s_cbranch_scc1 L_k4_ltb_97
    s_sub_u32 s35, s35, 1
    s_cbranch_scc1 L_k4_ltb_97
    s_sleep 2
    buffer_load_dword v32, v30, s[68:71], 0 offen sc1
    s_waitcnt vmcnt(0)
    s_branch L_k4_ls_173
    s_branch L_k4_ltb_97
L_k4_pp_98:
    s_cmp_eq_u32 s101, 0
    s_cbranch_scc1 L_k4_ppb_99
    buffer_load_dword v32, v30, s[68:71], 0 offen sc1
    s_branch L_k4_ppb_99
L_k4_lt_101:
    s_mov_b32 s99, s101
    s_mov_b32 s101, 0
    s_cmp_eq_u32 s99, 0
    s_cbranch_scc1 L_k4_ltb_102
    s_waitcnt vmcnt(22)
    s_mov_b32 s35, 262144
L_k4_ls_174:
    v_cmp_ne_u32 vcc, -1, v32
    s_and_b32 s6, vcc_lo, 0xffff
    s_cmp_eq_u32 s6, 0xffff
    s_cbranch_scc1 L_k4_ltb_102
    s_sub_u32 s35, s35, 1
    s_cbranch_scc1 L_k4_ltb_102
    s_sleep 2
    buffer_load_dword v32, v30, s[68:71], 0 offen sc1
    s_waitcnt vmcnt(0)
    s_branch L_k4_ls_174
    s_branch L_k4_ltb_102
L_k4_pp_103:
    s_cmp_eq_u32 s101, 0
    s_cbranch_scc1 L_k4_ppb_104
    buffer_load_dword v32, v30, s[68:71], 0 offen sc1
    s_branch L_k4_ppb_104
L_k4_t_105:
    s_lshl_b32 s6, s2, 2
    s_add_u32 s6, s6, 12288
    v_mov_b32 v40, 0
    s_cmp_eq_u32 s3, 4
    s_cselect_b64 exec, 1, 0
    buffer_store_dword v40, v40, s[68:71], s6 offen sc1
    s_mov_b64 exec, -1
    s_branch L_k4_tb_106
L_k4_t_107:
    buffer_load_dwordx4 v[44:47], v38, s[68:71], 0 offen offset:0 sc1
    s_branch L_k4_tb_108
L_k4_t_109:
    v_max3_u32 v44, v44, v45, v46
    v_max_u32 v44, v44, v47
    v_cmp_eq_u32 vcc, -1, v44
    s_cbranch_vccz L_fok_175
    s_mov_b32 s32, s66
    s_mov_b32 s66, 262144
L_fl_l_176:
    buffer_load_dwordx4 v[44:47], v38, s[68:71], 0 offen offset:0 sc1
    s_waitcnt vmcnt(0)
    v_max3_u32 v44, v44, v45, v46
    v_max_u32 v44, v44, v47
    v_cmp_eq_u32 vcc, -1, v44
    s_sub_u32 s66, s66, 1
    s_cbranch_scc1 L_fl_d_177
    s_cbranch_vccz L_fl_d_177
    s_sleep 4
    s_branch L_fl_l_176
L_fl_d_177:
    s_mov_b32 s66, s32
L_fok_175:
    s_lshl_b32 s6, s4, 9
    s_add_u32 s32, s6, 8192
    buffer_load_dwordx4 v[48:51], v41, s[16:19], 0 offen sc1
    buffer_load_dword v52, v42, s[20:23], s6 offen sc1
    buffer_load_dword v53, v42, s[20:23], s32 offen sc1
    s_branch L_k4_tb_110
L_k5_slow_128:
    s_ff1_i32_b32 s6, s99
    s_bitset0_b32 s99, s6
    s_mul_i32 s33, s6, 262144
    s_lshl_b32 s7, s6, 7
    s_ff1_i32_b32 s6, s99
    s_bitset0_b32 s99, s6
    s_mul_i32 s66, s6, 262144
    s_lshl_b32 s32, s6, 7
    s_ff1_i32_b32 s6, s99
    s_bitset0_b32 s99, s6
    s_mul_i32 s67, s6, 262144
    s_lshl_b32 s35, s6, 7
    s_add_u32 m0, s64, 0
    s_nop 0
    buffer_load_dwordx4 v16, s[8:11], s7 offen lds
    s_add_u32 m0, s64, 4096
    s_nop 0
    buffer_load_dwordx4 v17, s[8:11], s7 offen lds
    s_add_u32 m0, s64, 8192
    s_nop 0
    buffer_load_dwordx4 v18, s[8:11], s7 offen lds
    s_add_u32 m0, s64, 12288
    s_nop 0
    buffer_load_dwordx4 v19, s[8:11], s7 offen lds
    s_add_u32 m0, s64, 32768
    s_nop 0
    buffer_load_dwordx4 v16, s[8:11], s32 offen lds
    s_add_u32 m0, s64, 36864
    s_nop 0
    buffer_load_dwordx4 v17, s[8:11], s32 offen lds
    s_add_u32 m0, s64, 40960
    s_nop 0
    buffer_load_dwordx4 v18, s[8:11], s32 offen lds
    s_add_u32 m0, s64, 45056
    s_nop 0
    buffer_load_dwordx4 v19, s[8:11], s32 offen lds
    s_add_u32 m0, s64, 65536
    s_nop 0
    buffer_load_dwordx4 v16, s[8:11], s35 offen lds
    s_add_u32 m0, s64, 69632
    s_nop 0
    buffer_load_dwordx4 v17, s[8:11], s35 offen lds
    s_add_u32 m0, s64, 73728
    s_nop 0
    buffer_load_dwordx4 v18, s[8:11], s35 offen lds
    s_add_u32 m0, s64, 77824
    s_nop 0
    buffer_load_dwordx4 v19, s[8:11], s35 offen lds
    s_add_u32 m0, s64, 16384
    s_nop 0
    buffer_load_dwordx4 v20, s[12:15], s33 offen sc1 lds
    s_add_u32 m0, s64, 20480
    s_nop 0
    buffer_load_dwordx4 v21, s[12:15], s33 offen sc1 lds
    s_add_u32 m0, s64, 24576
    s_nop 0
    buffer_load_dwordx4 v22, s[12:15], s33 offen sc1 lds
    s_add_u32 m0, s64, 28672
    s_nop 0
    buffer_load_dwordx4 v23, s[12:15], s33 offen sc1 lds
    s_add_u32 m0, s64, 49152
    s_nop 0
    buffer_load_dwordx4 v20, s[12:15], s66 offen sc1 lds
    s_add_u32 m0, s64, 53248
    s_nop 0
    buffer_load_dwordx4 v21, s[12:15], s66 offen sc1 lds
    s_add_u32 m0, s64, 57344
    s_nop 0
    buffer_load_dwordx4 v22, s[12:15], s66 offen sc1 lds
    s_add_u32 m0, s64, 61440
    s_nop 0
    buffer_load_dwordx4 v23, s[12:15], s66 offen sc1 lds
    s_add_u32 m0, s64, 81920
    s_nop 0
    buffer_load_dwordx4 v20, s[12:15], s67 offen sc1 lds
    s_add_u32 m0, s64, 86016
    s_nop 0
    buffer_load_dwordx4 v21, s[12:15], s67 offen sc1 lds
    s_add_u32 m0, s64, 90112
    s_nop 0
    buffer_load_dwordx4 v22, s[12:15], s67 offen sc1 lds
    s_add_u32 m0, s64, 94208
    s_nop 0
    buffer_load_dwordx4 v23, s[12:15], s67 offen sc1 lds
    s_branch L_k5_pdone_127
L_k5_lt_130:
    s_mov_b32 s99, s101
    s_mov_b32 s101, 0
    s_cmp_eq_u32 s99, 0
    s_cbranch_scc1 L_k5_ltb_131
    s_waitcnt vmcnt(24)
    s_mov_b32 s35, 262144
L_k5_ls_178:
    v_max3_u32 v32, v32, v33, v34
    v_max_u32 v32, v32, v35
    v_cmp_ne_u32 vcc, -1, v32
    s_and_b32 s6, vcc_lo, vcc_hi
    s_cmp_eq_u32 s6, 0xffffffff
    s_cbranch_scc1 L_k5_ltb_131
    s_sub_u32 s35, s35, 1
    s_cbranch_scc1 L_k5_ltb_131
    s_sleep 2
    buffer_load_dword v32, v30, s[68:71], 0 offen offset:0 sc1
    buffer_load_dword v33, v30, s[68:71], 0 offen offset:256 sc1
    buffer_load_dword v34, v31, s[68:71], 0 offen offset:0 sc1
    buffer_load_dword v35, v31, s[68:71], 0 offen offset:256 sc1
    s_waitcnt vmcnt(0)
    s_branch L_k5_ls_178
    s_branch L_k5_ltb_131
L_k5_pp_132:
    s_cmp_eq_u32 s101, 0
    s_cbranch_scc1 L_k5_ppb_133
    buffer_load_dword v32, v30, s[68:71], 0 offen offset:0 sc1
    buffer_load_dword v33, v30, s[68:71], 0 offen offset:256 sc1
    buffer_load_dword v34, v31, s[68:71], 0 offen offset:0 sc1
    buffer_load_dword v35, v31, s[68:71], 0 offen offset:256 sc1
    s_branch L_k5_ppb_133
L_k5_lt_134:
    s_mov_b32 s99, s101
    s_mov_b32 s101, 0
    s_cmp_eq_u32 s99, 0
    s_cbranch_scc1 L_k5_ltb_135
    s_waitcnt vmcnt(24)
    s_mov_b32 s35, 262144
L_k5_ls_179:
    v_max3_u32 v32, v32, v33, v34
    v_max_u32 v32, v32, v35
    v_cmp_ne_u32 vcc, -1, v32
    s_and_b32 s6, vcc_lo, vcc_hi
    s_cmp_eq_u32 s6, 0xffffffff
    s_cbranch_scc1 L_k5_ltb_135
    s_sub_u32 s35, s35, 1
    s_cbranch_scc1 L_k5_ltb_135
    s_sleep 2
    buffer_load_dword v32, v30, s[68:71], 0 offen offset:0 sc1
    buffer_load_dword v33, v30, s[68:71], 0 offen offset:256 sc1
    buffer_load_dword v34, v31, s[68:71], 0 offen offset:0 sc1
    buffer_load_dword v35, v31, s[68:71], 0 offen offset:256 sc1
    s_waitcnt vmcnt(0)
    s_branch L_k5_ls_179
    s_branch L_k5_ltb_135
L_k5_pp_136:
    s_cmp_eq_u32 s101, 0
    s_cbranch_scc1 L_k5_ppb_137
    buffer_load_dword v32, v30, s[68:71], 0 offen offset:0 sc1
    buffer_load_dword v33, v30, s[68:71], 0 offen offset:256 sc1
    buffer_load_dword v34, v31, s[68:71], 0 offen offset:0 sc1
    buffer_load_dword v35, v31, s[68:71], 0 offen offset:256 sc1
    s_branch L_k5_ppb_137
L_k5_lt_139:
    s_mov_b32 s99, s101
    s_mov_b32 s101, 0
    s_cmp_eq_u32 s99, 0
    s_cbranch_scc1 L_k5_ltb_140
    s_waitcnt vmcnt(24)
    s_mov_b32 s35, 262144
L_k5_ls_180:
    v_max3_u32 v32, v32, v33, v34
    v_max_u32 v32, v32, v35
    v_cmp_ne_u32 vcc, -1, v32
    s_and_b32 s6, vcc_lo, vcc_hi
    s_cmp_eq_u32 s6, 0xffffffff
    s_cbranch_scc1 L_k5_ltb_140
    s_sub_u32 s35, s35, 1
    s_cbranch_scc1 L_k5_ltb_140
    s_sleep 2
    buffer_load_dword v32, v30, s[68:71], 0 offen offset:0 sc1
    buffer_load_dword v33, v30, s[68:71], 0 offen offset:256 sc1
    buffer_load_dword v34, v31, s[68:71], 0 offen offset:0 sc1
    buffer_load_dword v35, v31, s[68:71], 0 offen offset:256 sc1
    s_waitcnt vmcnt(0)
    s_branch L_k5_ls_180
    s_branch L_k5_ltb_140
L_k5_pp_141:
    s_cmp_eq_u32 s101, 0
    s_cbranch_scc1 L_k5_ppb_142
    buffer_load_dword v32, v30, s[68:71], 0 offen offset:0 sc1
    buffer_load_dword v33, v30, s[68:71], 0 offen offset:256 sc1
    buffer_load_dword v34, v31, s[68:71], 0 offen offset:0 sc1
    buffer_load_dword v35, v31, s[68:71], 0 offen offset:256 sc1
    s_branch L_k5_ppb_142
L_k5_x_120:
    s_waitcnt vmcnt(0)
    s_barrier
    s_add_u32 s68, s62, 0xc0000
    s_addc_u32 s69, s63, 0
    s_mov_b32 s70, 0x6000
    s_mov_b32 s71, 0x00020000
    v_mov_b32 v10, 0
    s_cmp_eq_u32 s3, 0
    s_cselect_b64 exec, 1, 0
    buffer_store_dword v10, v10, s[68:71], s100 offen sc1
    s_mov_b64 exec, -1
    s_sub_u32 s4, s2, 224
    v_lshlrev_b32 v2, 7, v0
    v_add_u32 v3, 0x10000, v2
    s_mul_i32 s6, s4, 114688
    s_add_u32 s8, s52, s6
    s_addc_u32 s9, s53, 0
    s_mov_b32 s10, 0x1c000
    s_mov_b32 s11, 0x00020000
    buffer_load_dword v4, v2, s[8:11], 0 offen
    buffer_load_dword v5, v3, s[8:11], 0 offen
    s_lshl_b32 s100, s4, 2
    s_add_u32 s100, s100, 8192
    s_waitcnt vmcnt(0)
    s_branch L_phase_k6
L_k6_slow_152:
    s_ff1_i32_b32 s6, s99
    s_bitset0_b32 s99, s6
    s_mul_i32 s33, s6, 131072
    s_add_u32 s7, s6, 4
    s_mul_i32 s7, s7, 37
    s_lshr_b32 s7, s7, 8
    s_add_u32 s7, s6, s7
    s_lshl_b32 s7, s7, 7
    s_ff1_i32_b32 s6, s99
    s_bitset0_b32 s99, s6
    s_mul_i32 s66, s6, 131072
    s_add_u32 s32, s6, 4
    s_mul_i32 s32, s32, 37
    s_lshr_b32 s32, s32, 8
    s_add_u32 s32, s6, s32
    s_lshl_b32 s32, s32, 7
    s_ff1_i32_b32 s6, s99
    s_bitset0_b32 s99, s6
    s_mul_i32 s67, s6, 131072
    s_add_u32 s35, s6, 4
    s_mul_i32 s35, s35, 37
    s_lshr_b32 s35, s35, 8
    s_add_u32 s35, s6, s35
    s_lshl_b32 s35, s35, 7
    s_add_u32 m0, s64, 16384
    s_nop 0
    buffer_load_dwordx4 v20, s[12:15], s33 offen lds
    s_add_u32 m0, s64, 20480
    s_nop 0
    buffer_load_dwordx4 v21, s[12:15], s33 offen lds
    s_add_u32 m0, s64, 40960
    s_nop 0
    buffer_load_dwordx4 v20, s[12:15], s66 offen lds
    s_add_u32 m0, s64, 45056
    s_nop 0
    buffer_load_dwordx4 v21, s[12:15], s66 offen lds
    s_add_u32 m0, s64, 65536
    s_nop 0
    buffer_load_dwordx4 v20, s[12:15], s67 offen lds
    s_add_u32 m0, s64, 69632
    s_nop 0
    buffer_load_dwordx4 v21, s[12:15], s67 offen lds
    s_add_u32 m0, s64, 0
    s_nop 0
    buffer_load_dwordx4 v16, s[8:11], s7 offen sc1 lds
    s_add_u32 m0, s64, 4096
    s_nop 0
    buffer_load_dwordx4 v17, s[8:11], s7 offen sc1 lds
    s_add_u32 m0, s64, 8192
    s_nop 0
    buffer_load_dwordx4 v18, s[8:11], s7 offen sc1 lds
    s_add_u32 m0, s64, 12288
    s_nop 0
    buffer_load_dwordx4 v19, s[8:11], s7 offen sc1 lds
    s_add_u32 m0, s64, 24576
    s_nop 0
    buffer_load_dwordx4 v16, s[8:11], s32 offen sc1 lds
    s_add_u32 m0, s64, 28672
    s_nop 0
    buffer_load_dwordx4 v17, s[8:11], s32 offen sc1 lds
    s_add_u32 m0, s64, 32768
    s_nop 0
    buffer_load_dwordx4 v18, s[8:11], s32 offen sc1 lds
    s_add_u32 m0, s64, 36864
    s_nop 0
    buffer_load_dwordx4 v19, s[8:11], s32 offen sc1 lds
    s_add_u32 m0, s64, 49152
    s_nop 0
    buffer_load_dwordx4 v16, s[8:11], s35 offen sc1 lds
    s_add_u32 m0, s64, 53248
    s_nop 0
    buffer_load_dwordx4 v17, s[8:11], s35 offen sc1 lds
    s_add_u32 m0, s64, 57344
    s_nop 0
    buffer_load_dwordx4 v18, s[8:11], s35 offen sc1 lds
    s_add_u32 m0, s64, 61440
    s_nop 0
    buffer_load_dwordx4 v19, s[8:11], s35 offen sc1 lds
    s_branch L_k6_pdone_151
L_k6_lt_154:
    s_mov_b32 s99, s101
    s_mov_b32 s101, 0
    s_cmp_eq_u32 s99, 0
    s_cbranch_scc1 L_k6_ltb_155
    s_waitcnt vmcnt(18)
    s_mov_b32 s35, 262144
L_k6_ls_181:
    v_cmp_ne_u32 vcc, -1, v32
    s_and_b32 s6, vcc_lo, 0xfffffff
    s_cmp_eq_u32 s6, 0xfffffff
    s_cbranch_scc1 L_k6_ltb_155
    s_sub_u32 s35, s35, 1
    s_cbranch_scc1 L_k6_ltb_155
    s_sleep 2
    buffer_load_dword v32, v30, s[68:71], 0 offen sc1
    s_waitcnt vmcnt(0)
    s_branch L_k6_ls_181
    s_branch L_k6_ltb_155
L_k6_pp_156:
    s_cmp_eq_u32 s101, 0
    s_cbranch_scc1 L_k6_ppb_157
    buffer_load_dword v32, v30, s[68:71], 0 offen sc1
    s_branch L_k6_ppb_157
L_k6_lt_158:
    s_mov_b32 s99, s101
    s_mov_b32 s101, 0
    s_cmp_eq_u32 s99, 0
    s_cbranch_scc1 L_k6_ltb_159
    s_waitcnt vmcnt(18)
    s_mov_b32 s35, 262144
L_k6_ls_182:
    v_cmp_ne_u32 vcc, -1, v32
    s_and_b32 s6, vcc_lo, 0xfffffff
    s_cmp_eq_u32 s6, 0xfffffff
    s_cbranch_scc1 L_k6_ltb_159
    s_sub_u32 s35, s35, 1
    s_cbranch_scc1 L_k6_ltb_159
    s_sleep 2
    buffer_load_dword v32, v30, s[68:71], 0 offen sc1
    s_waitcnt vmcnt(0)
    s_branch L_k6_ls_182
    s_branch L_k6_ltb_159
L_k6_pp_160:
    s_cmp_eq_u32 s101, 0
    s_cbranch_scc1 L_k6_ppb_161
    buffer_load_dword v32, v30, s[68:71], 0 offen sc1
    s_branch L_k6_ppb_161
L_k6_lt_163:
    s_mov_b32 s99, s101
    s_mov_b32 s101, 0
    s_cmp_eq_u32 s99, 0
    s_cbranch_scc1 L_k6_ltb_164
    s_waitcnt vmcnt(18)
    s_mov_b32 s35, 262144
L_k6_ls_183:
    v_cmp_ne_u32 vcc, -1, v32
    s_and_b32 s6, vcc_lo, 0xfffffff
    s_cmp_eq_u32 s6, 0xfffffff
    s_cbranch_scc1 L_k6_ltb_164
    s_sub_u32 s35, s35, 1
    s_cbranch_scc1 L_k6_ltb_164
    s_sleep 2
    buffer_load_dword v32, v30, s[68:71], 0 offen sc1
    s_waitcnt vmcnt(0)
    s_branch L_k6_ls_183
    s_branch L_k6_ltb_164
L_k6_pp_165:
    s_cmp_eq_u32 s101, 0
    s_cbranch_scc1 L_k6_ppb_166
    buffer_load_dword v32, v30, s[68:71], 0 offen sc1
    s_branch L_k6_ppb_166
L_code_end:
    s_endpgm
.section .rodata,"a"
.p2align 6
.amdhsa_kernel adaLN_cond__linear_kernel_hedgehog__mixer_gmlp__prompt_kernel
  .amdhsa_next_free_vgpr 256
  .amdhsa_next_free_sgpr 102
  .amdhsa_accum_offset 256
  .amdhsa_group_segment_fixed_size 0
  .amdhsa_kernarg_size 112
  .amdhsa_user_sgpr_count 2
  .amdhsa_user_sgpr_kernarg_segment_ptr 1
  .amdhsa_system_sgpr_workgroup_id_x 1
.end_amdhsa_kernel
```
